```python
import torch

def _softmax(x, axis=-1):
    return torch.softmax(x, dim=axis)
def _gelu(x):
    return torch.nn.functional.gelu(x, approximate="tanh")
def _silu(x):
    return torch.nn.functional.silu(x)
def _sigmoid(x):
    return torch.sigmoid(x)
def _layernorm(x, axis=-1, eps=1e-5):
    m = x.mean(dim=axis, keepdim=True)
    v = x.var(dim=axis, keepdim=True, unbiased=False)
    return (x - m) / torch.sqrt(v + eps)
def _scatter_add(tgt, idx, src, axis=0):
    return tgt.clone().index_add_(axis, idx, src)
def _segment_sum(src, seg, n):
    out = torch.zeros((n,) + src.shape[1:], dtype=src.dtype)
    return out.index_add_(0, seg, src)
def _pad(x, pw):
    flat = tuple(v for pair in reversed(pw) for v in pair)
    return torch.nn.functional.pad(x, flat)

kernel_name = 'interleave_layers__sliding_block__glu_gated_bilinear__prompt'

def setup_inputs():

    _w = (lambda a: (lambda t: t.to(torch.bfloat16) if t.is_floating_point() else t)(torch.as_tensor(a)))
    def _A_setup():
        B, S, D = 1, 2048, 512
        return {
            "x": _w((lambda *s: torch.randn(*s, dtype=torch.bfloat16) * 0.05)(B, S, D)),
            "wqkv": _w((lambda *s: torch.randn(*s, dtype=torch.bfloat16) * 0.05)(D, 3 * D)),
            "wo": _w((lambda *s: torch.randn(*s, dtype=torch.bfloat16) * 0.05)(D, D)),
        }
    _A_in = _A_setup()

    def _B_setup():
        B, S, D, F = 1, 2048, 512, 1792
        return {
            "x": _w((lambda *s: torch.randn(*s, dtype=torch.bfloat16) * 0.05)(B, S, D)),
            "w_gate": _w((lambda *s: torch.randn(*s, dtype=torch.bfloat16) * 0.8)(D, F) * (D ** -0.5)),
            "w_up": _w((lambda *s: torch.randn(*s, dtype=torch.bfloat16) * 0.8)(D, F) * (D ** -0.5)),
            "w_down": _w((lambda *s: torch.randn(*s, dtype=torch.bfloat16) * 0.8)(F, D) * (F ** -0.5)),
        }
    _B_in = _B_setup()

    return {
        "A_x": _A_in["x"],
        "A_wqkv": _A_in["wqkv"],
        "A_wo": _A_in["wo"],
        "B_x": _B_in["x"],
        "B_w_gate": _B_in["w_gate"],
        "B_w_up": _B_in["w_up"],
        "B_w_down": _B_in["w_down"],
    }

def reference(A_x, A_wqkv, A_wo, B_x, B_w_gate, B_w_up, B_w_down):
    def _A_ref(x, wqkv, wo):
        B, S, D = x.shape
        H = 32; Dh = D // H; W = 256
        qkv = (lambda x, *d: x.permute(*d))((x @ wqkv).reshape(B, S, 3, H, Dh), 2, 0, 3, 1, 4)
        q, k, v = qkv[0], qkv[1], qkv[2]
        scores = torch.einsum("bhqd,bhkd->bhqk", q, k) * (Dh ** -0.5)
        idx = torch.arange(S)
        mask = (idx[:, None] - idx[None, :] >= 0) & (idx[:, None] - idx[None, :] < W)
        scores = torch.where(mask[None, None], scores, -1e9)
        p = _softmax(scores, axis=-1)
        o = torch.einsum("bhqk,bhkd->bhqd", p, v)
        return (lambda x, *d: x.permute(*d))(o, 0, 2, 1, 3).reshape(B, S, D) @ wo

    def _B_ref(x, w_gate, w_up, w_down):
        g = torch.einsum("bsd,df->bsf", x, w_gate)
        u = torch.einsum("bsd,df->bsf", x, w_up)
        h = g * u
        return torch.einsum("bsf,fd->bsd", h, w_down)

    x = A_x
    x = x + _A_ref(_layernorm(x, axis=-1), A_wqkv, A_wo)
    x = x + _B_ref(_layernorm(x, axis=-1), B_w_gate, B_w_up, B_w_down)
    x = x + _A_ref(_layernorm(x, axis=-1), A_wqkv, A_wo)
    x = x + _B_ref(_layernorm(x, axis=-1), B_w_gate, B_w_up, B_w_down)
    return x
```

```asm
; @launch grid=(256,1,1) block=(512,1,1) lds=163840
.amdgcn_target "amdgcn-amd-amdhsa--gfx950"
.text
.globl interleave_layers__sliding_block__glu_gated_bilinear__prompt_kernel
.p2align 8
.type interleave_layers__sliding_block__glu_gated_bilinear__prompt_kernel,@function
interleave_layers__sliding_block__glu_gated_bilinear__prompt_kernel:
    s_cmp_ge_u32 s2, 256
    s_cbranch_scc1 L_END
    s_getpc_b64 s[50:51]
L_PC:
    v_lshlrev_b32 v2, 7, v0
    v_min_u32 v2, L_END-interleave_layers__sliding_block__glu_gated_bilinear__prompt_kernel, v2
    s_sub_u32 s50, s50, L_PC-interleave_layers__sliding_block__glu_gated_bilinear__prompt_kernel
    s_subb_u32 s51, s51, 0
    v_mov_b32 v3, s51
    v_add_co_u32 v2, vcc, s50, v2
    s_nop 1
    v_addc_co_u32 v3, vcc, 0, v3, vcc
    s_and_b32 s52, s2, 0x18
    s_cmp_eq_u32 s52, 0
    s_cbranch_scc0 L_nocpf_1
    global_load_dword v255, v[2:3], off
L_nocpf_1:
    s_load_dwordx2 s[8:9], s[0:1], 0
    s_load_dwordx2 s[12:13], s[0:1], 8
    s_load_dwordx2 s[16:17], s[0:1], 16
    s_load_dwordx2 s[20:21], s[0:1], 32
    s_load_dwordx2 s[24:25], s[0:1], 40
    s_load_dwordx2 s[28:29], s[0:1], 48
    s_load_dwordx2 s[32:33], s[0:1], 56
    s_load_dwordx2 s[36:37], s[0:1], 64
    s_load_dwordx2 s[4:5], s[0:1], 72
    v_lshrrev_b32 v1, 6, v0
    v_and_b32 v0, 63, v0
    v_readfirstlane_b32 s42, v1
    s_getreg_b32 s44, hwreg(HW_REG_XCC_ID, 0, 4)
    s_min_u32 s44, s44, 8
    s_mov_b32 s10, 0x200000
    s_mov_b32 s11, 0x20000
    s_mov_b32 s14, 0x180000
    s_mov_b32 s15, 0x20000
    s_mov_b32 s18, 0x80000
    s_mov_b32 s19, 0x20000
    s_mov_b32 s22, 0x1c0000
    s_mov_b32 s23, 0x20000
    s_mov_b32 s26, 0x1c0000
    s_mov_b32 s27, 0x20000
    s_mov_b32 s30, 0x1c0000
    s_mov_b32 s31, 0x20000
    s_mov_b32 s34, 0x200000
    s_mov_b32 s35, 0x20000
    s_mov_b32 s38, 0x100
    s_mov_b32 s39, 0x20000
    s_mov_b32 s6, 0x2900000
    s_mov_b32 s7, 0x20000
    s_waitcnt lgkmcnt(0)
    s_cmp_eq_u32 s42, 0
    s_cbranch_scc0 L_norank_2
    s_lshl_b32 s45, s44, 5
    s_cmp_eq_u32 s44, 8
    s_cselect_b32 s45, 16, s45
    v_mov_b32 v2, s45
    v_mov_b32 v1, 1
    s_and_b32 s46, s44, 7
    s_lshl_b32 s46, s46, 6
    s_add_u32 s46, s46, 41975808
    v_lshlrev_b32 v3, 6, v0
    s_mov_b64 exec, 1
    buffer_atomic_add v1, v2, s[36:39], 0 offen sc0 sc1
    s_mov_b64 exec, 3
    buffer_load_dword v4, v3, s[4:7], s46 offen sc1
    s_waitcnt vmcnt(0)
    v_readfirstlane_b32 s41, v1
    s_mov_b32 s40, s44
    s_mov_b32 s43, 0
    s_cmp_eq_u32 s44, 8
    s_cbranch_scc1 L_ovf_3
    s_cmp_lt_u32 s41, 32
    s_cbranch_scc1 L_rankok_4
L_ovf_3:
    s_mov_b64 exec, 0x1ff
    v_lshlrev_b32 v2, 5, v0
    v_mov_b32 v5, 16
    v_cmp_eq_u32 vcc, 8, v0
    s_nop 1
    v_cndmask_b32 v2, v2, v5, vcc
    s_mov_b32 s45, 0
L_ovl_5:
    buffer_load_dword v1, v2, s[36:39], 0 offen sc1
    s_waitcnt vmcnt(0)
    v_readlane_b32 s50, v1, 0
    v_readlane_b32 s51, v1, 1
    v_readlane_b32 s52, v1, 2
    v_readlane_b32 s53, v1, 3
    v_readlane_b32 s54, v1, 4
    v_readlane_b32 s55, v1, 5
    v_readlane_b32 s56, v1, 6
    v_readlane_b32 s57, v1, 7
    v_readlane_b32 s58, v1, 8
    s_add_u32 s59, s50, s51
    s_add_u32 s59, s59, s52
    s_add_u32 s59, s59, s53
    s_add_u32 s59, s59, s54
    s_add_u32 s59, s59, s55
    s_add_u32 s59, s59, s56
    s_add_u32 s59, s59, s57
    s_add_u32 s59, s59, s58
    s_cmp_ge_u32 s59, 256
    s_cbranch_scc1 L_ovd_6
    s_sleep 8
    s_add_u32 s45, s45, 1
    s_cmp_lt_u32 s45, 200000
    s_cbranch_scc1 L_ovl_5
    v_mov_b32 v6, 1
    v_mov_b32 v7, 20
    buffer_store_dword v6, v7, s[36:39], 0 offen
    s_waitcnt vmcnt(0)
L_ovd_6:
    s_sub_u32 s60, s41, 32
    s_cmp_eq_u32 s44, 8
    s_cselect_b32 s60, s41, s60
    s_sub_i32 s61, s50, 32
    s_max_i32 s61, s61, 0
    s_cmp_gt_u32 s44, 0
    s_cselect_b32 s61, s61, 0
    s_add_u32 s60, s60, s61
    s_sub_i32 s61, s51, 32
    s_max_i32 s61, s61, 0
    s_cmp_gt_u32 s44, 1
    s_cselect_b32 s61, s61, 0
    s_add_u32 s60, s60, s61
    s_sub_i32 s61, s52, 32
    s_max_i32 s61, s61, 0
    s_cmp_gt_u32 s44, 2
    s_cselect_b32 s61, s61, 0
    s_add_u32 s60, s60, s61
    s_sub_i32 s61, s53, 32
    s_max_i32 s61, s61, 0
    s_cmp_gt_u32 s44, 3
    s_cselect_b32 s61, s61, 0
    s_add_u32 s60, s60, s61
    s_sub_i32 s61, s54, 32
    s_max_i32 s61, s61, 0
    s_cmp_gt_u32 s44, 4
    s_cselect_b32 s61, s61, 0
    s_add_u32 s60, s60, s61
    s_sub_i32 s61, s55, 32
    s_max_i32 s61, s61, 0
    s_cmp_gt_u32 s44, 5
    s_cselect_b32 s61, s61, 0
    s_add_u32 s60, s60, s61
    s_sub_i32 s61, s56, 32
    s_max_i32 s61, s61, 0
    s_cmp_gt_u32 s44, 6
    s_cselect_b32 s61, s61, 0
    s_add_u32 s60, s60, s61
    s_sub_i32 s61, s57, 32
    s_max_i32 s61, s61, 0
    s_cmp_gt_u32 s44, 7
    s_cselect_b32 s61, s61, 0
    s_add_u32 s60, s60, s61
    s_mov_b32 s40, 0
    s_mov_b32 s41, 0
    s_mov_b32 s62, 0
    s_sub_i32 s61, 32, s50
    s_max_i32 s61, s61, 0
    s_cmp_lt_u32 s60, s61
    s_cselect_b32 s63, 1, 0
    s_cmp_eq_u32 s62, 0
    s_cselect_b32 s63, s63, 0
    s_add_u32 s64, s50, s60
    s_cmp_eq_u32 s63, 1
    s_cselect_b32 s40, 0, s40
    s_cselect_b32 s41, s64, s41
    s_or_b32 s62, s62, s63
    s_cmp_eq_u32 s62, 0
    s_cselect_b32 s61, s61, 0
    s_sub_u32 s60, s60, s61
    s_sub_i32 s61, 32, s51
    s_max_i32 s61, s61, 0
    s_cmp_lt_u32 s60, s61
    s_cselect_b32 s63, 1, 0
    s_cmp_eq_u32 s62, 0
    s_cselect_b32 s63, s63, 0
    s_add_u32 s64, s51, s60
    s_cmp_eq_u32 s63, 1
    s_cselect_b32 s40, 1, s40
    s_cselect_b32 s41, s64, s41
    s_or_b32 s62, s62, s63
    s_cmp_eq_u32 s62, 0
    s_cselect_b32 s61, s61, 0
    s_sub_u32 s60, s60, s61
    s_sub_i32 s61, 32, s52
    s_max_i32 s61, s61, 0
    s_cmp_lt_u32 s60, s61
    s_cselect_b32 s63, 1, 0
    s_cmp_eq_u32 s62, 0
    s_cselect_b32 s63, s63, 0
    s_add_u32 s64, s52, s60
    s_cmp_eq_u32 s63, 1
    s_cselect_b32 s40, 2, s40
    s_cselect_b32 s41, s64, s41
    s_or_b32 s62, s62, s63
    s_cmp_eq_u32 s62, 0
    s_cselect_b32 s61, s61, 0
    s_sub_u32 s60, s60, s61
    s_sub_i32 s61, 32, s53
    s_max_i32 s61, s61, 0
    s_cmp_lt_u32 s60, s61
    s_cselect_b32 s63, 1, 0
    s_cmp_eq_u32 s62, 0
    s_cselect_b32 s63, s63, 0
    s_add_u32 s64, s53, s60
    s_cmp_eq_u32 s63, 1
    s_cselect_b32 s40, 3, s40
    s_cselect_b32 s41, s64, s41
    s_or_b32 s62, s62, s63
    s_cmp_eq_u32 s62, 0
    s_cselect_b32 s61, s61, 0
    s_sub_u32 s60, s60, s61
    s_sub_i32 s61, 32, s54
    s_max_i32 s61, s61, 0
    s_cmp_lt_u32 s60, s61
    s_cselect_b32 s63, 1, 0
    s_cmp_eq_u32 s62, 0
    s_cselect_b32 s63, s63, 0
    s_add_u32 s64, s54, s60
    s_cmp_eq_u32 s63, 1
    s_cselect_b32 s40, 4, s40
    s_cselect_b32 s41, s64, s41
    s_or_b32 s62, s62, s63
    s_cmp_eq_u32 s62, 0
    s_cselect_b32 s61, s61, 0
    s_sub_u32 s60, s60, s61
    s_sub_i32 s61, 32, s55
    s_max_i32 s61, s61, 0
    s_cmp_lt_u32 s60, s61
    s_cselect_b32 s63, 1, 0
    s_cmp_eq_u32 s62, 0
    s_cselect_b32 s63, s63, 0
    s_add_u32 s64, s55, s60
    s_cmp_eq_u32 s63, 1
    s_cselect_b32 s40, 5, s40
    s_cselect_b32 s41, s64, s41
    s_or_b32 s62, s62, s63
    s_cmp_eq_u32 s62, 0
    s_cselect_b32 s61, s61, 0
    s_sub_u32 s60, s60, s61
    s_sub_i32 s61, 32, s56
    s_max_i32 s61, s61, 0
    s_cmp_lt_u32 s60, s61
    s_cselect_b32 s63, 1, 0
    s_cmp_eq_u32 s62, 0
    s_cselect_b32 s63, s63, 0
    s_add_u32 s64, s56, s60
    s_cmp_eq_u32 s63, 1
    s_cselect_b32 s40, 6, s40
    s_cselect_b32 s41, s64, s41
    s_or_b32 s62, s62, s63
    s_cmp_eq_u32 s62, 0
    s_cselect_b32 s61, s61, 0
    s_sub_u32 s60, s60, s61
    s_sub_i32 s61, 32, s57
    s_max_i32 s61, s61, 0
    s_cmp_lt_u32 s60, s61
    s_cselect_b32 s63, 1, 0
    s_cmp_eq_u32 s62, 0
    s_cselect_b32 s63, s63, 0
    s_add_u32 s64, s57, s60
    s_cmp_eq_u32 s63, 1
    s_cselect_b32 s40, 7, s40
    s_cselect_b32 s41, s64, s41
    s_or_b32 s62, s62, s63
    s_cmp_eq_u32 s62, 0
    s_cselect_b32 s61, s61, 0
    s_sub_u32 s60, s60, s61
    s_mov_b32 s43, 1
    s_lshl_b32 s46, s40, 6
    s_add_u32 s46, s46, 41975808
    s_mov_b64 exec, 3
    buffer_load_dword v4, v3, s[4:7], s46 offen sc1
    s_waitcnt vmcnt(0)
L_rankok_4:
    s_mov_b64 exec, -1
    v_readlane_b32 s46, v4, 0
    v_readlane_b32 s47, v4, 1
    s_add_u32 s46, s46, 2
    s_add_u32 s47, s47, 2
    s_lshl_b32 s48, s43, 8
    s_or_b32 s48, s48, s40
    v_mov_b32 v2, s48
    v_mov_b32 v3, s41
    v_mov_b32 v4, s46
    v_mov_b32 v5, s47
    v_mov_b32 v1, 159776
    ds_write_b128 v1, v[2:5]
    s_branch L_RANKED
L_norank_2:
    s_lshr_b32 s50, s2, 3
    s_and_b32 s50, s50, 31
    v_lshlrev_b32 v3, 7, v0
    s_cmp_eq_u32 s42, 7
    s_cbranch_scc1 L_pfx_7
    s_cmp_ge_u32 s42, 5
    s_cbranch_scc0 L_pfd_8
    s_mul_i32 s51, s50, 12288
    s_sub_u32 s52, s42, 5
    s_lshl_b32 s52, s52, 12
    s_add_u32 s51, s51, s52
    buffer_load_dword v254, v3, s[12:15], s51 offen
    s_branch L_pfd_8
L_pfx_7:
    s_and_b32 s51, s44, 7
    s_lshl_b32 s51, s51, 18
    s_lshl_b32 s52, s50, 13
    s_add_u32 s51, s51, s52
    buffer_load_dword v254, v3, s[8:11], s51 offen
L_pfd_8:
L_RANKED:
    v_mov_b32 v4, 0x3f803f80
    v_mov_b32 v5, v4
    v_mov_b32 v6, v4
    v_mov_b32 v7, v4
    v_mov_b32 v1, 159744
    ds_write_b128 v1, v[4:7]
    ds_write_b128 v1, v[4:7] offset:512
    s_waitcnt lgkmcnt(0)
    s_barrier
    v_mov_b32 v1, 159776
    ds_read_b128 v[2:5], v1
    s_waitcnt lgkmcnt(0)
    v_readfirstlane_b32 s48, v2
    v_readfirstlane_b32 s41, v3
    v_readfirstlane_b32 s97, v4
    v_readfirstlane_b32 s98, v5
    s_and_b32 s40, s48, 0xff
    s_lshr_b32 s43, s48, 8
    s_cmp_ge_u32 s42, 4
    s_cbranch_scc1 L_HELPER
    s_lshr_b32 s50, s41, 2
    s_lshl_b32 s51, s40, 3
    s_add_u32 s50, s50, s51
    s_and_b32 s51, s41, 3
    s_lshl_b32 s52, s51, 3
    s_lshl_b32 s53, s42, 1
    s_add_u32 s52, s52, s53
    s_lshl_b32 s54, s50, 15
    s_lshl_b32 s55, s52, 5
    s_add_u32 s54, s54, s55
    v_and_b32 v1, 31, v0
    v_lshrrev_b32 v2, 5, v0
    v_lshlrev_b32 v3, 10, v1
    v_lshl_add_u32 v3, v2, 4, v3
    buffer_load_dwordx4 v[8:11], v3, s[8:11], s54 offen
    buffer_load_dwordx4 v[12:15], v3, s[8:11], s54 offen offset:32
    v_lshlrev_b32 v4, 4, v0
    s_mul_i32 s56, s50, 32768
    s_lshl_b32 s57, s52, 10
    s_add_u32 s56, s56, s57
    s_add_u32 s56, s56, 0
    s_lshl_b32 s58, s51, 2
    s_add_u32 s58, s58, s42
    s_lshl_b32 s58, s58, 8
    s_lshl_b32 s59, s50, 12
    s_add_u32 s59, s59, s58
    s_add_u32 s59, s59, 14680064
    v_lshlrev_b32 v5, 7, v0
    s_mov_b32 exec_lo, 0xffff
    s_mov_b32 exec_hi, 0x0
    buffer_load_dword v30, v5, s[4:7], s56 offen sc1
    s_mov_b64 exec, -1
    s_mov_b32 exec_lo, 0x3
    s_mov_b32 exec_hi, 0x0
    buffer_load_dword v31, v5, s[4:7], s59 offen sc1
    s_mov_b64 exec, -1
    s_waitcnt vmcnt(0)
    v_permlane32_swap_b32 v8, v10
    v_permlane32_swap_b32 v9, v11
    v_permlane32_swap_b32 v12, v14
    v_permlane32_swap_b32 v13, v15
    buffer_store_dwordx4 v[8:11], v4, s[4:7], s56 offen
    buffer_store_dwordx4 v[12:15], v4, s[4:7], s56 offen offset:1024
    v_mov_b32 v17, 0x3f803f80
    v_mov_b32 v18, 0
    v_mov_b32 v19, 0
    v_dot2_f32_bf16 v18, v8, v17, v18
    v_dot2_f32_bf16 v19, v8, v8, v19
    v_dot2_f32_bf16 v18, v9, v17, v18
    v_dot2_f32_bf16 v19, v9, v9, v19
    v_dot2_f32_bf16 v18, v10, v17, v18
    v_dot2_f32_bf16 v19, v10, v10, v19
    v_dot2_f32_bf16 v18, v11, v17, v18
    v_dot2_f32_bf16 v19, v11, v11, v19
    v_dot2_f32_bf16 v18, v12, v17, v18
    v_dot2_f32_bf16 v19, v12, v12, v19
    v_dot2_f32_bf16 v18, v13, v17, v18
    v_dot2_f32_bf16 v19, v13, v13, v19
    v_dot2_f32_bf16 v18, v14, v17, v18
    v_dot2_f32_bf16 v19, v14, v14, v19
    v_dot2_f32_bf16 v18, v15, v17, v18
    v_dot2_f32_bf16 v19, v15, v15, v19
    s_nop 2
    v_permlane32_swap_b32 v18, v19
    v_add_f32 v18, v18, v19
    v_mov_b32 v19, v18
    s_nop 1
    v_permlane32_swap_b32 v18, v19
    v_mov_b32 v20, v18
    v_mov_b32 v21, v19
    s_nop 0
    v_permlane16_swap_b32 v18, v20
    v_permlane16_swap_b32 v19, v21
    s_mov_b32 exec_lo, 0xffff
    s_mov_b32 exec_hi, 0x0
    buffer_store_dwordx4 v[18:21], v4, s[4:7], s59 offen
    s_mov_b64 exec, -1
    s_barrier
    s_waitcnt vmcnt(0)
    s_lshl_b32 s46, s40, 9
    s_add_u32 s47, s46, 41984000
    s_add_u32 s46, s46, 41979904
    s_lshl_b32 s48, s41, 2
    s_add_u32 s48, s48, s42
    s_lshl_b32 s48, s48, 2
    v_mov_b32 v5, s48
    s_mov_b64 exec, 1
    s_cmp_eq_u32 s43, 0
    s_cbranch_scc0 L_x0sl_9
    v_mov_b32 v6, s97
    buffer_store_dword v6, v5, s[4:7], s46 offen
    s_branch L_x0sd_10
L_x0sl_9:
    s_add_u32 s49, s97, 1
    v_mov_b32 v6, s49
    buffer_wbl2 sc1
    s_waitcnt vmcnt(0)
    buffer_store_dword v6, v5, s[4:7], s47 offen sc1
L_x0sd_10:
    s_mov_b64 exec, -1
    s_mov_b32 s96, 0
    s_mov_b32 s94, 0
    s_mov_b32 s95, 0
    s_mov_b32 s93, 0
L_LOOP:
    s_lshl_b32 s50, s40, 3
    s_add_u32 s51, s50, 7
    s_sub_u32 s51, s51, s42
    s_add_u32 s50, s50, s42
    s_mul_i32 s52, s50, 32768
    s_add_u32 s52, s52, 0
    s_add_u32 s52, s52, s94
    s_mul_i32 s53, s51, 32768
    s_add_u32 s53, s53, 0
    s_add_u32 s53, s53, s94
    v_lshlrev_b32 v8, 4, v0
    s_cmp_eq_u32 s96, 0
    s_cbranch_scc0 L_w12a_11
    s_lshl_b32 s46, s40, 9
    s_add_u32 s47, s46, 41984000
    s_add_u32 s46, s46, 41979904
    s_lshl_b32 s48, s41, 2
    s_add_u32 s48, s48, s42
    s_lshl_b32 s48, s48, 2
    v_lshlrev_b32 v5, 3, v0
    s_mov_b32 s45, 0
    s_cmp_eq_u32 s43, 0
    s_cbranch_scc0 L_x0B_14
L_x0A_13:
    buffer_load_dwordx2 v[6:7], v5, s[4:7], s46 offen sc1
    s_waitcnt vmcnt(0)
    v_cmp_eq_u32 vcc, s97, v6
    v_cmp_eq_u32 s[66:67], s97, v7
    s_and_b64 vcc, vcc, s[66:67]
    s_cmp_eq_u64 vcc, exec
    s_cbranch_scc1 L_x0d_15
    s_add_u32 s45, s45, 1
    s_and_b32 s49, s45, 31
    s_cmp_eq_u32 s49, 0
    s_cbranch_scc0 L_x0A_13
    buffer_load_dwordx2 v[6:7], v5, s[4:7], s47 offen sc1
    s_waitcnt vmcnt(0)
    v_subrev_u32 v6, s97, v6
    v_subrev_u32 v7, s97, v7
    v_min_u32 v6, v6, v7
    v_cmp_gt_u32 vcc, 2, v6
    s_cmp_lg_u64 vcc, 0
    s_cbranch_scc1 L_x0s_16
    s_cmp_lt_u32 s45, 200000
    s_cbranch_scc1 L_x0A_13
    v_mov_b32 v6, 107
    v_mov_b32 v7, 20
    buffer_store_dword v6, v7, s[36:39], 0 offen
    s_waitcnt vmcnt(0)
    s_branch L_x0d_15
L_x0s_16:
    s_mov_b32 s43, 1
    buffer_wbl2 sc1
    s_waitcnt vmcnt(0)
    v_mov_b32 v4, s48
    v_mov_b32 v6, s97
    s_mov_b64 exec, 1
    buffer_store_dword v6, v4, s[4:7], s47 offen sc1
    s_mov_b64 exec, -1
L_x0B_14:
    buffer_load_dwordx2 v[6:7], v5, s[4:7], s47 offen sc1
    s_waitcnt vmcnt(0)
    v_subrev_u32 v6, s97, v6
    v_subrev_u32 v7, s97, v7
    v_max_u32 v6, v6, v7
    v_cmp_gt_u32 vcc, 2, v6
    s_cmp_eq_u64 vcc, exec
    s_cbranch_scc1 L_x0ok_17
    s_sleep 4
    s_add_u32 s45, s45, 1
    s_cmp_lt_u32 s45, 200000
    s_cbranch_scc1 L_x0B_14
    v_mov_b32 v6, 108
    v_mov_b32 v7, 20
    buffer_store_dword v6, v7, s[36:39], 0 offen
    s_waitcnt vmcnt(0)
L_x0ok_17:
    buffer_inv sc1
    s_waitcnt vmcnt(0)
L_x0d_15:
    s_cmp_eq_u32 s43, 0
    s_cselect_b32 s93, 0, 16777216
    v_mov_b32 v4, 159792
    v_mov_b32 v5, s93
    ds_write_b32 v4, v5
    s_waitcnt lgkmcnt(0)
    s_branch L_w12b_12
L_w12a_11:
    s_lshl_b32 s46, s40, 8
    s_add_u32 s46, s46, 41949184
    v_lshlrev_b32 v5, 2, v0
    s_mov_b32 exec_lo, 0xffffffff
    s_mov_b32 exec_hi, 0x0
    s_mov_b32 s45, 0
L_poll_18:
    buffer_load_dword v6, v5, s[4:7], s46 offen sc1
    s_waitcnt vmcnt(0)
    v_subrev_u32 v6, s97, v6
    v_cmp_gt_u32 vcc, 2, v6
    s_cmp_eq_u64 vcc, exec
    s_cbranch_scc1 L_polldone_19
    s_add_u32 s45, s45, 1
    s_cmp_lt_u32 s45, 200000
    s_cbranch_scc1 L_poll_18
    v_mov_b32 v6, 103
    v_mov_b32 v7, 20
    buffer_store_dword v6, v7, s[36:39], 0 offen
    s_waitcnt vmcnt(0)
L_polldone_19:
    s_mov_b64 exec, -1
    s_cmp_eq_u32 s43, 0
    s_cbranch_scc1 L_noinv_20
    buffer_inv sc1
    s_waitcnt vmcnt(0)
L_noinv_20:
L_w12b_12:
    s_add_u32 s54, s52, 0
    s_add_u32 s55, s53, 0
    buffer_load_dwordx4 v[128:131], v8, s[4:7], s54 offen offset:0 sc1
    buffer_load_dwordx4 v[132:135], v8, s[4:7], s55 offen offset:0 sc1
    buffer_load_dwordx4 v[136:139], v8, s[4:7], s54 offen offset:1024 sc1
    buffer_load_dwordx4 v[140:143], v8, s[4:7], s55 offen offset:1024 sc1
    buffer_load_dwordx4 v[144:147], v8, s[4:7], s54 offen offset:2048 sc1
    buffer_load_dwordx4 v[148:151], v8, s[4:7], s55 offen offset:2048 sc1
    buffer_load_dwordx4 v[152:155], v8, s[4:7], s54 offen offset:3072 sc1
    buffer_load_dwordx4 v[156:159], v8, s[4:7], s55 offen offset:3072 sc1
    v_lshrrev_b32 v4, 5, v0
    v_lshlrev_b32 v4, 2, v4
    v_bfe_u32 v1, v0, 2, 2
    v_add_u32 v1, v1, v4
    v_bfe_u32 v2, v0, 4, 1
    v_and_b32 v3, 3, v0
    v_lshlrev_b32 v3, 3, v3
    v_lshlrev_b32 v9, 6, v1
    v_lshl_add_u32 v9, v2, 5, v9
    v_add_u32 v9, v9, v3
    v_lshl_add_u32 v10, v1, 5, v3
    v_add_u32 v10, 32768, v10
    s_barrier
    ds_read_b64_tr_b16 v[32:33], v9 offset:0
    ds_read_b64_tr_b16 v[34:35], v9 offset:512
    ds_read_b64_tr_b16 v[36:37], v10 offset:0
    ds_read_b64_tr_b16 v[38:39], v10 offset:256
    ds_read_b64_tr_b16 v[40:41], v9 offset:1024
    ds_read_b64_tr_b16 v[42:43], v9 offset:1536
    ds_read_b64_tr_b16 v[44:45], v10 offset:512
    ds_read_b64_tr_b16 v[46:47], v10 offset:768
    v_and_b32 v29, 31, v0
    v_lshrrev_b32 v31, 5, v0
    v_lshlrev_b32 v31, 2, v31
    v_sub_u32 v29, v29, v31
    v_mov_b32 v31, 0xf149f2ca
    v_cmp_le_i32_e64 s[64:65], 0, v29
    v_cmp_le_i32_e64 s[66:67], 1, v29
    v_cmp_le_i32_e64 vcc, 2, v29
    v_cndmask_b32_e64 v224, v31, 0, s[64:65]
    v_cndmask_b32_e64 v225, v31, 0, s[66:67]
    v_cndmask_b32_e64 v226, v31, 0, vcc
    v_cmp_le_i32_e64 s[64:65], 3, v29
    v_cmp_le_i32_e64 s[66:67], 8, v29
    v_cmp_le_i32_e64 vcc, 9, v29
    v_cndmask_b32_e64 v227, v31, 0, s[64:65]
    v_cndmask_b32_e64 v228, v31, 0, s[66:67]
    v_cndmask_b32_e64 v229, v31, 0, vcc
    v_cmp_le_i32_e64 s[64:65], 10, v29
    v_cmp_le_i32_e64 s[66:67], 11, v29
    v_cmp_le_i32_e64 vcc, 16, v29
    v_cndmask_b32_e64 v230, v31, 0, s[64:65]
    v_cndmask_b32_e64 v231, v31, 0, s[66:67]
    v_cndmask_b32_e64 v232, v31, 0, vcc
    v_cmp_le_i32_e64 s[64:65], 17, v29
    v_cmp_le_i32_e64 s[66:67], 18, v29
    v_cmp_le_i32_e64 vcc, 19, v29
    v_cndmask_b32_e64 v233, v31, 0, s[64:65]
    v_cndmask_b32_e64 v234, v31, 0, s[66:67]
    v_cndmask_b32_e64 v235, v31, 0, vcc
    v_cmp_le_i32_e64 s[64:65], 24, v29
    v_cmp_le_i32_e64 s[66:67], 25, v29
    v_cmp_le_i32_e64 vcc, 26, v29
    v_cndmask_b32_e64 v236, v31, 0, s[64:65]
    v_cndmask_b32_e64 v237, v31, 0, s[66:67]
    v_cndmask_b32_e64 v238, v31, 0, vcc
    v_cmp_le_i32_e64 s[64:65], 27, v29
    s_nop 1
    v_cndmask_b32_e64 v239, v31, 0, s[64:65]
    v_mov_b32 v50, 0
    v_mov_b32 v51, 0
    v_mov_b32 v58, 0
    v_mov_b32 v59, 0
    v_mov_b32 v54, 0
    v_mov_b32 v55, 0
    v_mov_b32 v62, 0
    v_mov_b32 v63, 0
    s_lshl_b32 s62, s50, 12
    s_add_u32 s62, s62, 14680064
    s_add_u32 s62, s62, s94
    s_lshl_b32 s63, s51, 12
    s_add_u32 s63, s63, 14680064
    s_add_u32 s63, s63, s94
    v_and_b32 v5, 31, v0
    v_lshlrev_b32 v5, 3, v5
    v_add_u32 v5, 161792, v5
    s_lshl_b32 s56, s42, 8
    s_add_u32 s56, s56, 160768
    v_and_b32 v4, 31, v0
    v_lshl_add_u32 v4, v4, 2, s56
    s_waitcnt vmcnt(7)
    s_waitcnt lgkmcnt(4)
    v_mfma_f32_32x32x16_bf16 v[64:79], v[32:35], v[128:131], 0
    ds_read_b64_tr_b16 v[240:241], v9 offset:2048
    ds_read_b64_tr_b16 v[242:243], v9 offset:2560
    s_add_u32 s54, s52, 4096
    s_add_u32 s55, s53, 4096
    buffer_load_dwordx4 v[160:163], v8, s[4:7], s54 offen offset:0 sc1
    v_mfma_f32_32x32x16_bf16 v[96:111], v[128:131], v[36:39], 0
    ds_read_b64_tr_b16 v[244:245], v10 offset:1024
    ds_read_b64_tr_b16 v[246:247], v10 offset:1280
    buffer_load_dwordx4 v[164:167], v8, s[4:7], s55 offen offset:0 sc1
    s_waitcnt vmcnt(8)
    v_mfma_f32_32x32x16_bf16 v[80:95], v[32:35], v[132:135], 0
    buffer_load_dwordx4 v[168:171], v8, s[4:7], s54 offen offset:1024 sc1
    v_mfma_f32_32x32x16_bf16 v[112:127], v[132:135], v[36:39], 0
    buffer_load_dwordx4 v[172:175], v8, s[4:7], s55 offen offset:1024 sc1
    s_waitcnt vmcnt(9)
    s_waitcnt lgkmcnt(4)
    v_mfma_f32_32x32x16_bf16 v[64:79], v[40:43], v[136:139], v[64:79]
    ds_read_b64_tr_b16 v[32:33], v9 offset:3072
    ds_read_b64_tr_b16 v[34:35], v9 offset:3584
    buffer_load_dwordx4 v[176:179], v8, s[4:7], s54 offen offset:2048 sc1
    v_mfma_f32_32x32x16_bf16 v[96:111], v[136:139], v[44:47], v[96:111]
    ds_read_b64_tr_b16 v[36:37], v10 offset:1536
    ds_read_b64_tr_b16 v[38:39], v10 offset:1792
    buffer_load_dwordx4 v[180:183], v8, s[4:7], s55 offen offset:2048 sc1
    s_waitcnt vmcnt(10)
    v_mfma_f32_32x32x16_bf16 v[80:95], v[40:43], v[140:143], v[80:95]
    buffer_load_dwordx4 v[184:187], v8, s[4:7], s54 offen offset:3072 sc1
    v_mfma_f32_32x32x16_bf16 v[112:127], v[140:143], v[44:47], v[112:127]
    buffer_load_dwordx4 v[188:191], v8, s[4:7], s55 offen offset:3072 sc1
    s_waitcnt vmcnt(11)
    s_waitcnt lgkmcnt(4)
    v_mfma_f32_32x32x16_bf16 v[64:79], v[240:243], v[144:147], v[64:79]
    ds_read_b64_tr_b16 v[40:41], v9 offset:4096
    ds_read_b64_tr_b16 v[42:43], v9 offset:4608
    s_add_u32 s54, s52, 8192
    s_add_u32 s55, s53, 8192
    buffer_load_dwordx4 v[128:131], v8, s[4:7], s54 offen offset:0 sc1
    v_mfma_f32_32x32x16_bf16 v[96:111], v[144:147], v[244:247], v[96:111]
    ds_read_b64_tr_b16 v[44:45], v10 offset:2048
    ds_read_b64_tr_b16 v[46:47], v10 offset:2304
    buffer_load_dwordx4 v[132:135], v8, s[4:7], s55 offen offset:0 sc1
    s_waitcnt vmcnt(12)
    v_mfma_f32_32x32x16_bf16 v[80:95], v[240:243], v[148:151], v[80:95]
    buffer_load_dwordx4 v[136:139], v8, s[4:7], s54 offen offset:1024 sc1
    v_mfma_f32_32x32x16_bf16 v[112:127], v[148:151], v[244:247], v[112:127]
    buffer_load_dwordx4 v[140:143], v8, s[4:7], s55 offen offset:1024 sc1
    s_waitcnt vmcnt(13)
    s_waitcnt lgkmcnt(4)
    v_mfma_f32_32x32x16_bf16 v[64:79], v[32:35], v[152:155], v[64:79]
    ds_read_b64_tr_b16 v[240:241], v9 offset:5120
    ds_read_b64_tr_b16 v[242:243], v9 offset:5632
    v_mfma_f32_32x32x16_bf16 v[96:111], v[152:155], v[36:39], v[96:111]
    ds_read_b64_tr_b16 v[244:245], v10 offset:2560
    ds_read_b64_tr_b16 v[246:247], v10 offset:2816
    s_waitcnt vmcnt(12)
    v_mfma_f32_32x32x16_bf16 v[80:95], v[32:35], v[156:159], v[80:95]
    buffer_load_dwordx4 v[144:147], v8, s[4:7], s54 offen offset:2048 sc1
    v_mfma_f32_32x32x16_bf16 v[112:127], v[156:159], v[36:39], v[112:127]
    buffer_load_dwordx4 v[148:151], v8, s[4:7], s55 offen offset:2048 sc1
    s_waitcnt vmcnt(13)
    s_waitcnt lgkmcnt(4)
    v_mfma_f32_32x32x16_bf16 v[64:79], v[40:43], v[160:163], v[64:79]
    ds_read_b64_tr_b16 v[32:33], v9 offset:6144
    ds_read_b64_tr_b16 v[34:35], v9 offset:6656
    v_mfma_f32_32x32x16_bf16 v[96:111], v[160:163], v[44:47], v[96:111]
    ds_read_b64_tr_b16 v[36:37], v10 offset:3072
    ds_read_b64_tr_b16 v[38:39], v10 offset:3328
    s_waitcnt vmcnt(12)
    v_mfma_f32_32x32x16_bf16 v[80:95], v[40:43], v[164:167], v[80:95]
    buffer_load_dwordx4 v[152:155], v8, s[4:7], s54 offen offset:3072 sc1
    v_mfma_f32_32x32x16_bf16 v[112:127], v[164:167], v[44:47], v[112:127]
    buffer_load_dwordx4 v[156:159], v8, s[4:7], s55 offen offset:3072 sc1
    s_waitcnt vmcnt(13)
    s_waitcnt lgkmcnt(4)
    v_mfma_f32_32x32x16_bf16 v[64:79], v[240:243], v[168:171], v[64:79]
    ds_read_b64_tr_b16 v[40:41], v9 offset:7168
    ds_read_b64_tr_b16 v[42:43], v9 offset:7680
    v_mfma_f32_32x32x16_bf16 v[96:111], v[168:171], v[244:247], v[96:111]
    ds_read_b64_tr_b16 v[44:45], v10 offset:3584
    ds_read_b64_tr_b16 v[46:47], v10 offset:3840
    s_waitcnt vmcnt(12)
    v_mfma_f32_32x32x16_bf16 v[80:95], v[240:243], v[172:175], v[80:95]
    s_add_u32 s54, s52, 12288
    s_add_u32 s55, s53, 12288
    buffer_load_dwordx4 v[160:163], v8, s[4:7], s54 offen offset:0 sc1
    v_mfma_f32_32x32x16_bf16 v[112:127], v[172:175], v[244:247], v[112:127]
    buffer_load_dwordx4 v[164:167], v8, s[4:7], s55 offen offset:0 sc1
    s_barrier
    s_waitcnt vmcnt(13)
    s_waitcnt lgkmcnt(4)
    v_mfma_f32_32x32x16_bf16 v[64:79], v[32:35], v[176:179], v[64:79]
    ds_read_b64_tr_b16 v[240:241], v9 offset:8192
    ds_read_b64_tr_b16 v[242:243], v9 offset:8704
    v_mfma_f32_32x32x16_bf16 v[96:111], v[176:179], v[36:39], v[96:111]
    ds_read_b64_tr_b16 v[244:245], v10 offset:4096
    ds_read_b64_tr_b16 v[246:247], v10 offset:4352
    s_waitcnt vmcnt(12)
    v_mfma_f32_32x32x16_bf16 v[80:95], v[32:35], v[180:183], v[80:95]
    buffer_load_dwordx4 v[168:171], v8, s[4:7], s54 offen offset:1024 sc1
    v_mfma_f32_32x32x16_bf16 v[112:127], v[180:183], v[36:39], v[112:127]
    buffer_load_dwordx4 v[172:175], v8, s[4:7], s55 offen offset:1024 sc1
    s_waitcnt vmcnt(13)
    s_waitcnt lgkmcnt(4)
    v_mfma_f32_32x32x16_bf16 v[64:79], v[40:43], v[184:187], v[64:79]
    ds_read_b64_tr_b16 v[32:33], v9 offset:9216
    ds_read_b64_tr_b16 v[34:35], v9 offset:9728
    v_mfma_f32_32x32x16_bf16 v[96:111], v[184:187], v[44:47], v[96:111]
    ds_read_b64_tr_b16 v[36:37], v10 offset:4608
    ds_read_b64_tr_b16 v[38:39], v10 offset:4864
    s_waitcnt vmcnt(12)
    v_mfma_f32_32x32x16_bf16 v[80:95], v[40:43], v[188:191], v[80:95]
    buffer_load_dwordx4 v[176:179], v8, s[4:7], s54 offen offset:2048 sc1
    v_mfma_f32_32x32x16_bf16 v[112:127], v[188:191], v[44:47], v[112:127]
    buffer_load_dwordx4 v[180:183], v8, s[4:7], s55 offen offset:2048 sc1
    s_waitcnt vmcnt(13)
    s_waitcnt lgkmcnt(4)
    v_mfma_f32_32x32x16_bf16 v[64:79], v[240:243], v[128:131], v[64:79]
    ds_read_b64_tr_b16 v[40:41], v9 offset:10240
    ds_read_b64_tr_b16 v[42:43], v9 offset:10752
    v_mfma_f32_32x32x16_bf16 v[96:111], v[128:131], v[244:247], v[96:111]
    ds_read_b64_tr_b16 v[44:45], v10 offset:5120
    ds_read_b64_tr_b16 v[46:47], v10 offset:5376
    s_waitcnt vmcnt(12)
    v_mfma_f32_32x32x16_bf16 v[80:95], v[240:243], v[132:135], v[80:95]
    buffer_load_dwordx4 v[184:187], v8, s[4:7], s54 offen offset:3072 sc1
    v_mfma_f32_32x32x16_bf16 v[112:127], v[132:135], v[244:247], v[112:127]
    buffer_load_dwordx4 v[188:191], v8, s[4:7], s55 offen offset:3072 sc1
    s_waitcnt vmcnt(13)
    s_waitcnt lgkmcnt(4)
    v_mfma_f32_32x32x16_bf16 v[64:79], v[32:35], v[136:139], v[64:79]
    ds_read_b64_tr_b16 v[240:241], v9 offset:11264
    ds_read_b64_tr_b16 v[242:243], v9 offset:11776
    v_mfma_f32_32x32x16_bf16 v[96:111], v[136:139], v[36:39], v[96:111]
    ds_read_b64_tr_b16 v[244:245], v10 offset:5632
    ds_read_b64_tr_b16 v[246:247], v10 offset:5888
    s_waitcnt vmcnt(12)
    v_mfma_f32_32x32x16_bf16 v[80:95], v[32:35], v[140:143], v[80:95]
    s_add_u32 s54, s52, 16384
    s_add_u32 s55, s53, 16384
    buffer_load_dwordx4 v[128:131], v8, s[4:7], s54 offen offset:0 sc1
    v_mfma_f32_32x32x16_bf16 v[112:127], v[140:143], v[36:39], v[112:127]
    buffer_load_dwordx4 v[132:135], v8, s[4:7], s55 offen offset:0 sc1
    s_waitcnt vmcnt(13)
    s_waitcnt lgkmcnt(4)
    v_mfma_f32_32x32x16_bf16 v[64:79], v[40:43], v[144:147], v[64:79]
    ds_read_b64_tr_b16 v[32:33], v9 offset:12288
    ds_read_b64_tr_b16 v[34:35], v9 offset:12800
    v_mfma_f32_32x32x16_bf16 v[96:111], v[144:147], v[44:47], v[96:111]
    ds_read_b64_tr_b16 v[36:37], v10 offset:6144
    ds_read_b64_tr_b16 v[38:39], v10 offset:6400
    s_waitcnt vmcnt(12)
    v_mfma_f32_32x32x16_bf16 v[80:95], v[40:43], v[148:151], v[80:95]
    buffer_load_dwordx4 v[136:139], v8, s[4:7], s54 offen offset:1024 sc1
    v_mfma_f32_32x32x16_bf16 v[112:127], v[148:151], v[44:47], v[112:127]
    buffer_load_dwordx4 v[140:143], v8, s[4:7], s55 offen offset:1024 sc1
    s_waitcnt vmcnt(13)
    s_waitcnt lgkmcnt(4)
    v_mfma_f32_32x32x16_bf16 v[64:79], v[240:243], v[152:155], v[64:79]
    ds_read_b64_tr_b16 v[40:41], v9 offset:13312
    ds_read_b64_tr_b16 v[42:43], v9 offset:13824
    v_mfma_f32_32x32x16_bf16 v[96:111], v[152:155], v[244:247], v[96:111]
    ds_read_b64_tr_b16 v[44:45], v10 offset:6656
    ds_read_b64_tr_b16 v[46:47], v10 offset:6912
    s_waitcnt vmcnt(12)
    v_mfma_f32_32x32x16_bf16 v[80:95], v[240:243], v[156:159], v[80:95]
    buffer_load_dwordx4 v[144:147], v8, s[4:7], s54 offen offset:2048 sc1
    v_mfma_f32_32x32x16_bf16 v[112:127], v[156:159], v[244:247], v[112:127]
    buffer_load_dwordx4 v[148:151], v8, s[4:7], s55 offen offset:2048 sc1
    s_waitcnt vmcnt(13)
    s_waitcnt lgkmcnt(4)
    v_mfma_f32_32x32x16_bf16 v[64:79], v[32:35], v[160:163], v[64:79]
    ds_read_b64_tr_b16 v[240:241], v9 offset:14336
    ds_read_b64_tr_b16 v[242:243], v9 offset:14848
    v_mfma_f32_32x32x16_bf16 v[96:111], v[160:163], v[36:39], v[96:111]
    ds_read_b64_tr_b16 v[244:245], v10 offset:7168
    ds_read_b64_tr_b16 v[246:247], v10 offset:7424
    s_waitcnt vmcnt(12)
    v_mfma_f32_32x32x16_bf16 v[80:95], v[32:35], v[164:167], v[80:95]
    buffer_load_dwordx4 v[152:155], v8, s[4:7], s54 offen offset:3072 sc1
    v_mfma_f32_32x32x16_bf16 v[112:127], v[164:167], v[36:39], v[112:127]
    buffer_load_dwordx4 v[156:159], v8, s[4:7], s55 offen offset:3072 sc1
    s_waitcnt vmcnt(13)
    s_waitcnt lgkmcnt(4)
    v_mfma_f32_32x32x16_bf16 v[64:79], v[40:43], v[168:171], v[64:79]
    ds_read_b64_tr_b16 v[32:33], v9 offset:15360
    ds_read_b64_tr_b16 v[34:35], v9 offset:15872
    v_mfma_f32_32x32x16_bf16 v[96:111], v[168:171], v[44:47], v[96:111]
    ds_read_b64_tr_b16 v[36:37], v10 offset:7680
    ds_read_b64_tr_b16 v[38:39], v10 offset:7936
    s_waitcnt vmcnt(12)
    v_mfma_f32_32x32x16_bf16 v[80:95], v[40:43], v[172:175], v[80:95]
    s_add_u32 s54, s52, 20480
    s_add_u32 s55, s53, 20480
    buffer_load_dwordx4 v[160:163], v8, s[4:7], s54 offen offset:0 sc1
    v_mfma_f32_32x32x16_bf16 v[112:127], v[172:175], v[44:47], v[112:127]
    buffer_load_dwordx4 v[164:167], v8, s[4:7], s55 offen offset:0 sc1
    s_barrier
    s_waitcnt vmcnt(13)
    s_waitcnt lgkmcnt(4)
    v_mfma_f32_32x32x16_bf16 v[64:79], v[240:243], v[176:179], v[64:79]
    ds_read_b64_tr_b16 v[40:41], v9 offset:16384
    ds_read_b64_tr_b16 v[42:43], v9 offset:16896
    v_mfma_f32_32x32x16_bf16 v[96:111], v[176:179], v[244:247], v[96:111]
    ds_read_b64_tr_b16 v[44:45], v10 offset:8192
    ds_read_b64_tr_b16 v[46:47], v10 offset:8448
    s_waitcnt vmcnt(12)
    v_mfma_f32_32x32x16_bf16 v[80:95], v[240:243], v[180:183], v[80:95]
    buffer_load_dwordx4 v[168:171], v8, s[4:7], s54 offen offset:1024 sc1
    v_mfma_f32_32x32x16_bf16 v[112:127], v[180:183], v[244:247], v[112:127]
    buffer_load_dwordx4 v[172:175], v8, s[4:7], s55 offen offset:1024 sc1
    s_waitcnt vmcnt(13)
    s_waitcnt lgkmcnt(4)
    v_mfma_f32_32x32x16_bf16 v[64:79], v[32:35], v[184:187], v[64:79]
    ds_read_b64_tr_b16 v[240:241], v9 offset:17408
    ds_read_b64_tr_b16 v[242:243], v9 offset:17920
    v_mfma_f32_32x32x16_bf16 v[96:111], v[184:187], v[36:39], v[96:111]
    ds_read_b64_tr_b16 v[244:245], v10 offset:8704
    ds_read_b64_tr_b16 v[246:247], v10 offset:8960
    s_waitcnt vmcnt(12)
    v_mfma_f32_32x32x16_bf16 v[80:95], v[32:35], v[188:191], v[80:95]
    buffer_load_dwordx4 v[176:179], v8, s[4:7], s54 offen offset:2048 sc1
    v_mfma_f32_32x32x16_bf16 v[112:127], v[188:191], v[36:39], v[112:127]
    buffer_load_dwordx4 v[180:183], v8, s[4:7], s55 offen offset:2048 sc1
    s_waitcnt vmcnt(13)
    s_waitcnt lgkmcnt(4)
    v_mfma_f32_32x32x16_bf16 v[64:79], v[40:43], v[128:131], v[64:79]
    ds_read_b64_tr_b16 v[32:33], v9 offset:18432
    ds_read_b64_tr_b16 v[34:35], v9 offset:18944
    v_mfma_f32_32x32x16_bf16 v[96:111], v[128:131], v[44:47], v[96:111]
    ds_read_b64_tr_b16 v[36:37], v10 offset:9216
    ds_read_b64_tr_b16 v[38:39], v10 offset:9472
    s_waitcnt vmcnt(12)
    v_mfma_f32_32x32x16_bf16 v[80:95], v[40:43], v[132:135], v[80:95]
    buffer_load_dwordx4 v[184:187], v8, s[4:7], s54 offen offset:3072 sc1
    v_mfma_f32_32x32x16_bf16 v[112:127], v[132:135], v[44:47], v[112:127]
    buffer_load_dwordx4 v[188:191], v8, s[4:7], s55 offen offset:3072 sc1
    s_waitcnt vmcnt(13)
    s_waitcnt lgkmcnt(4)
    v_mfma_f32_32x32x16_bf16 v[64:79], v[240:243], v[136:139], v[64:79]
    ds_read_b64_tr_b16 v[40:41], v9 offset:19456
    ds_read_b64_tr_b16 v[42:43], v9 offset:19968
    v_mfma_f32_32x32x16_bf16 v[96:111], v[136:139], v[244:247], v[96:111]
    ds_read_b64_tr_b16 v[44:45], v10 offset:9728
    ds_read_b64_tr_b16 v[46:47], v10 offset:9984
    s_waitcnt vmcnt(12)
    v_mfma_f32_32x32x16_bf16 v[80:95], v[240:243], v[140:143], v[80:95]
    s_add_u32 s54, s52, 24576
    s_add_u32 s55, s53, 24576
    buffer_load_dwordx4 v[128:131], v8, s[4:7], s54 offen offset:0 sc1
    v_mfma_f32_32x32x16_bf16 v[112:127], v[140:143], v[244:247], v[112:127]
    buffer_load_dwordx4 v[132:135], v8, s[4:7], s55 offen offset:0 sc1
    s_waitcnt vmcnt(13)
    s_waitcnt lgkmcnt(4)
    v_mfma_f32_32x32x16_bf16 v[64:79], v[32:35], v[144:147], v[64:79]
    ds_read_b64_tr_b16 v[240:241], v9 offset:20480
    ds_read_b64_tr_b16 v[242:243], v9 offset:20992
    v_mfma_f32_32x32x16_bf16 v[96:111], v[144:147], v[36:39], v[96:111]
    ds_read_b64_tr_b16 v[244:245], v10 offset:10240
    ds_read_b64_tr_b16 v[246:247], v10 offset:10496
    s_waitcnt vmcnt(12)
    v_mfma_f32_32x32x16_bf16 v[80:95], v[32:35], v[148:151], v[80:95]
    buffer_load_dwordx4 v[136:139], v8, s[4:7], s54 offen offset:1024 sc1
    v_mfma_f32_32x32x16_bf16 v[112:127], v[148:151], v[36:39], v[112:127]
    buffer_load_dwordx4 v[140:143], v8, s[4:7], s55 offen offset:1024 sc1
    s_waitcnt vmcnt(13)
    s_waitcnt lgkmcnt(4)
    v_mfma_f32_32x32x16_bf16 v[64:79], v[40:43], v[152:155], v[64:79]
    ds_read_b64_tr_b16 v[32:33], v9 offset:21504
    ds_read_b64_tr_b16 v[34:35], v9 offset:22016
    v_mfma_f32_32x32x16_bf16 v[96:111], v[152:155], v[44:47], v[96:111]
    ds_read_b64_tr_b16 v[36:37], v10 offset:10752
    ds_read_b64_tr_b16 v[38:39], v10 offset:11008
    s_waitcnt vmcnt(12)
    v_mfma_f32_32x32x16_bf16 v[80:95], v[40:43], v[156:159], v[80:95]
    buffer_load_dwordx4 v[144:147], v8, s[4:7], s54 offen offset:2048 sc1
    v_mfma_f32_32x32x16_bf16 v[112:127], v[156:159], v[44:47], v[112:127]
    buffer_load_dwordx4 v[148:151], v8, s[4:7], s55 offen offset:2048 sc1
    s_waitcnt vmcnt(13)
    s_waitcnt lgkmcnt(4)
    v_mfma_f32_32x32x16_bf16 v[64:79], v[240:243], v[160:163], v[64:79]
    ds_read_b64_tr_b16 v[40:41], v9 offset:22528
    ds_read_b64_tr_b16 v[42:43], v9 offset:23040
    v_mfma_f32_32x32x16_bf16 v[96:111], v[160:163], v[244:247], v[96:111]
    ds_read_b64_tr_b16 v[44:45], v10 offset:11264
    ds_read_b64_tr_b16 v[46:47], v10 offset:11520
    s_waitcnt vmcnt(12)
    v_mfma_f32_32x32x16_bf16 v[80:95], v[240:243], v[164:167], v[80:95]
    buffer_load_dwordx4 v[152:155], v8, s[4:7], s54 offen offset:3072 sc1
    v_mfma_f32_32x32x16_bf16 v[112:127], v[164:167], v[244:247], v[112:127]
    buffer_load_dwordx4 v[156:159], v8, s[4:7], s55 offen offset:3072 sc1
    s_waitcnt vmcnt(13)
    s_waitcnt lgkmcnt(4)
    v_mfma_f32_32x32x16_bf16 v[64:79], v[32:35], v[168:171], v[64:79]
    ds_read_b64_tr_b16 v[240:241], v9 offset:23552
    ds_read_b64_tr_b16 v[242:243], v9 offset:24064
    v_mfma_f32_32x32x16_bf16 v[96:111], v[168:171], v[36:39], v[96:111]
    ds_read_b64_tr_b16 v[244:245], v10 offset:11776
    ds_read_b64_tr_b16 v[246:247], v10 offset:12032
    s_waitcnt vmcnt(12)
    v_mfma_f32_32x32x16_bf16 v[80:95], v[32:35], v[172:175], v[80:95]
    s_add_u32 s54, s52, 28672
    s_add_u32 s55, s53, 28672
    buffer_load_dwordx4 v[160:163], v8, s[4:7], s54 offen offset:0 sc1
    v_mfma_f32_32x32x16_bf16 v[112:127], v[172:175], v[36:39], v[112:127]
    buffer_load_dwordx4 v[164:167], v8, s[4:7], s55 offen offset:0 sc1
    s_waitcnt vmcnt(13)
    s_waitcnt lgkmcnt(4)
    v_mfma_f32_32x32x16_bf16 v[64:79], v[40:43], v[176:179], v[64:79]
    ds_read_b64_tr_b16 v[32:33], v9 offset:24576
    ds_read_b64_tr_b16 v[34:35], v9 offset:25088
    v_mfma_f32_32x32x16_bf16 v[96:111], v[176:179], v[44:47], v[96:111]
    ds_read_b64_tr_b16 v[36:37], v10 offset:12288
    ds_read_b64_tr_b16 v[38:39], v10 offset:12544
    s_waitcnt vmcnt(12)
    v_mfma_f32_32x32x16_bf16 v[80:95], v[40:43], v[180:183], v[80:95]
    buffer_load_dwordx4 v[168:171], v8, s[4:7], s54 offen offset:1024 sc1
    v_mfma_f32_32x32x16_bf16 v[112:127], v[180:183], v[44:47], v[112:127]
    buffer_load_dwordx4 v[172:175], v8, s[4:7], s55 offen offset:1024 sc1
    s_waitcnt vmcnt(13)
    s_waitcnt lgkmcnt(4)
    v_mfma_f32_32x32x16_bf16 v[64:79], v[240:243], v[184:187], v[64:79]
    ds_read_b64_tr_b16 v[40:41], v9 offset:25600
    ds_read_b64_tr_b16 v[42:43], v9 offset:26112
    v_mfma_f32_32x32x16_bf16 v[96:111], v[184:187], v[244:247], v[96:111]
    ds_read_b64_tr_b16 v[44:45], v10 offset:12800
    ds_read_b64_tr_b16 v[46:47], v10 offset:13056
    s_waitcnt vmcnt(12)
    v_mfma_f32_32x32x16_bf16 v[80:95], v[240:243], v[188:191], v[80:95]
    buffer_load_dwordx4 v[176:179], v8, s[4:7], s54 offen offset:2048 sc1
    v_mfma_f32_32x32x16_bf16 v[112:127], v[188:191], v[244:247], v[112:127]
    buffer_load_dwordx4 v[180:183], v8, s[4:7], s55 offen offset:2048 sc1
    s_waitcnt vmcnt(13)
    s_waitcnt lgkmcnt(4)
    v_mfma_f32_32x32x16_bf16 v[64:79], v[32:35], v[128:131], v[64:79]
    ds_read_b64_tr_b16 v[240:241], v9 offset:26624
    ds_read_b64_tr_b16 v[242:243], v9 offset:27136
    v_mfma_f32_32x32x16_bf16 v[96:111], v[128:131], v[36:39], v[96:111]
    ds_read_b64_tr_b16 v[244:245], v10 offset:13312
    ds_read_b64_tr_b16 v[246:247], v10 offset:13568
    s_waitcnt vmcnt(12)
    v_mfma_f32_32x32x16_bf16 v[80:95], v[32:35], v[132:135], v[80:95]
    buffer_load_dwordx4 v[184:187], v8, s[4:7], s54 offen offset:3072 sc1
    buffer_load_dwordx4 v[192:195], v8, s[4:7], s62 offen offset:0 sc1
    v_mfma_f32_32x32x16_bf16 v[112:127], v[132:135], v[36:39], v[112:127]
    buffer_load_dwordx4 v[188:191], v8, s[4:7], s55 offen offset:3072 sc1
    buffer_load_dwordx4 v[196:199], v8, s[4:7], s62 offen offset:1024 sc1
    s_waitcnt vmcnt(15)
    s_waitcnt lgkmcnt(4)
    v_mfma_f32_32x32x16_bf16 v[64:79], v[40:43], v[136:139], v[64:79]
    ds_read_b64_tr_b16 v[32:33], v9 offset:27648
    ds_read_b64_tr_b16 v[34:35], v9 offset:28160
    buffer_load_dwordx4 v[208:211], v8, s[4:7], s63 offen offset:0 sc1
    v_mfma_f32_32x32x16_bf16 v[96:111], v[136:139], v[44:47], v[96:111]
    ds_read_b64_tr_b16 v[36:37], v10 offset:13824
    ds_read_b64_tr_b16 v[38:39], v10 offset:14080
    s_waitcnt vmcnt(15)
    v_mfma_f32_32x32x16_bf16 v[80:95], v[40:43], v[140:143], v[80:95]
    buffer_load_dwordx4 v[200:203], v8, s[4:7], s62 offen offset:2048 sc1
    v_mfma_f32_32x32x16_bf16 v[112:127], v[140:143], v[44:47], v[112:127]
    buffer_load_dwordx4 v[204:207], v8, s[4:7], s62 offen offset:3072 sc1
    s_waitcnt vmcnt(16)
    s_waitcnt lgkmcnt(4)
    v_mfma_f32_32x32x16_bf16 v[64:79], v[240:243], v[144:147], v[64:79]
    ds_read_b64_tr_b16 v[40:41], v9 offset:28672
    ds_read_b64_tr_b16 v[42:43], v9 offset:29184
    buffer_load_dwordx4 v[220:223], v8, s[4:7], s63 offen offset:3072 sc1
    v_mfma_f32_32x32x16_bf16 v[96:111], v[144:147], v[244:247], v[96:111]
    ds_read_b64_tr_b16 v[44:45], v10 offset:14336
    ds_read_b64_tr_b16 v[46:47], v10 offset:14592
    s_waitcnt vmcnt(16)
    v_mfma_f32_32x32x16_bf16 v[80:95], v[240:243], v[148:151], v[80:95]
    buffer_load_dwordx4 v[212:215], v8, s[4:7], s63 offen offset:1024 sc1
    v_mfma_f32_32x32x16_bf16 v[112:127], v[148:151], v[244:247], v[112:127]
    buffer_load_dwordx4 v[216:219], v8, s[4:7], s63 offen offset:2048 sc1
    s_waitcnt vmcnt(17)
    s_waitcnt lgkmcnt(4)
    v_mfma_f32_32x32x16_bf16 v[64:79], v[32:35], v[152:155], v[64:79]
    ds_read_b64_tr_b16 v[240:241], v9 offset:29696
    ds_read_b64_tr_b16 v[242:243], v9 offset:30208
    v_mfma_f32_32x32x16_bf16 v[96:111], v[152:155], v[36:39], v[96:111]
    ds_read_b64_tr_b16 v[244:245], v10 offset:14848
    ds_read_b64_tr_b16 v[246:247], v10 offset:15104
    s_waitcnt vmcnt(16)
    v_mfma_f32_32x32x16_bf16 v[80:95], v[32:35], v[156:159], v[80:95]
    v_mfma_f32_32x32x16_bf16 v[112:127], v[156:159], v[36:39], v[112:127]
    s_waitcnt vmcnt(15)
    s_waitcnt lgkmcnt(4)
    v_mfma_f32_32x32x16_bf16 v[64:79], v[40:43], v[160:163], v[64:79]
    ds_read_b64_tr_b16 v[32:33], v9 offset:30720
    ds_read_b64_tr_b16 v[34:35], v9 offset:31232
    v_mfma_f32_32x32x16_bf16 v[96:111], v[160:163], v[44:47], v[96:111]
    ds_read_b64_tr_b16 v[36:37], v10 offset:15360
    ds_read_b64_tr_b16 v[38:39], v10 offset:15616
    s_waitcnt vmcnt(14)
    v_mfma_f32_32x32x16_bf16 v[80:95], v[40:43], v[164:167], v[80:95]
    v_mfma_f32_32x32x16_bf16 v[112:127], v[164:167], v[44:47], v[112:127]
    s_waitcnt vmcnt(13)
    s_waitcnt lgkmcnt(4)
    v_mfma_f32_32x32x16_bf16 v[64:79], v[240:243], v[168:171], v[64:79]
    ds_read_b64_tr_b16 v[40:41], v9 offset:31744
    ds_read_b64_tr_b16 v[42:43], v9 offset:32256
    s_waitcnt vmcnt(3)
    v_pk_add_f32 v[192:193], v[192:193], v[196:197]
    v_pk_add_f32 v[194:195], v[194:195], v[198:199]
    v_mfma_f32_32x32x16_bf16 v[96:111], v[168:171], v[244:247], v[96:111]
    ds_read_b64_tr_b16 v[44:45], v10 offset:15872
    ds_read_b64_tr_b16 v[46:47], v10 offset:16128
    v_pk_add_f32 v[200:201], v[200:201], v[204:205]
    v_pk_add_f32 v[202:203], v[202:203], v[206:207]
    v_pk_add_f32 v[192:193], v[192:193], v[200:201]
    v_mfma_f32_32x32x16_bf16 v[80:95], v[240:243], v[172:175], v[80:95]
    v_pk_add_f32 v[194:195], v[194:195], v[202:203]
    s_nop 1
    v_permlane16_swap_b32 v192, v194
    v_permlane16_swap_b32 v193, v195
    v_add_f32 v20, v192, v194
    v_add_f32 v21, v193, v195
    v_mfma_f32_32x32x16_bf16 v[112:127], v[172:175], v[244:247], v[112:127]
    s_barrier
    ds_read_b64 v[56:57], v5
    ds_read_b64 v[60:61], v5 offset:256
    s_waitcnt lgkmcnt(6)
    v_mfma_f32_32x32x16_bf16 v[64:79], v[32:35], v[176:179], v[64:79]
    s_waitcnt vmcnt(0)
    v_pk_add_f32 v[208:209], v[208:209], v[212:213]
    v_pk_add_f32 v[210:211], v[210:211], v[214:215]
    v_pk_add_f32 v[216:217], v[216:217], v[220:221]
    v_pk_add_f32 v[218:219], v[218:219], v[222:223]
    v_mfma_f32_32x32x16_bf16 v[96:111], v[176:179], v[36:39], v[96:111]
    v_pk_add_f32 v[208:209], v[208:209], v[216:217]
    v_pk_add_f32 v[210:211], v[210:211], v[218:219]
    s_nop 1
    v_permlane16_swap_b32 v208, v210
    v_permlane16_swap_b32 v209, v211
    v_add_f32 v22, v208, v210
    v_mfma_f32_32x32x16_bf16 v[80:95], v[32:35], v[180:183], v[80:95]
    v_add_f32 v23, v209, v211
    v_permlane32_swap_b32 v20, v21
    s_nop 0
    v_permlane32_swap_b32 v22, v23
    v_add_f32 v20, v20, v21
    v_add_f32 v22, v22, v23
    v_mfma_f32_32x32x16_bf16 v[112:127], v[180:183], v[36:39], v[112:127]
    v_mov_b32 v21, v20
    v_mov_b32 v23, v22
    s_nop 0
    v_permlane32_swap_b32 v20, v21
    v_permlane32_swap_b32 v22, v23
    v_mul_f32 v12, 0xbb000000, v20
    s_waitcnt lgkmcnt(2)
    v_mfma_f32_32x32x16_bf16 v[64:79], v[40:43], v[184:187], v[64:79]
    v_mul_f32 v14, 0xbb000000, v22
    v_mul_f32 v21, 0x3b000000, v21
    v_mul_f32 v23, 0x3b000000, v23
    v_fma_f32 v21, -v12, v12, v21
    v_fma_f32 v23, -v14, v14, v23
    v_mfma_f32_32x32x16_bf16 v[96:111], v[184:187], v[44:47], v[96:111]
    v_max_f32 v21, 0, v21
    v_max_f32 v23, 0, v23
    v_add_f32 v21, 0x3727c5ac, v21
    v_add_f32 v23, 0x3727c5ac, v23
    v_rsq_f32 v16, v21
    v_mfma_f32_32x32x16_bf16 v[80:95], v[40:43], v[188:191], v[80:95]
    v_rsq_f32 v18, v23
    v_cmp_gt_u32 vcc, 32, v0
    v_cvt_pk_bf16_f32 v20, v12, v12
    v_cvt_pk_bf16_f32 v22, v14, v14
    v_lshlrev_b32 v20, 16, v20
    v_mfma_f32_32x32x16_bf16 v[112:127], v[188:191], v[44:47], v[112:127]
    v_lshlrev_b32 v22, 16, v22
    v_sub_f32 v21, v12, v20
    v_sub_f32 v23, v14, v22
    v_cvt_pk_bf16_f32 v20, v20, v21
    v_cvt_pk_bf16_f32 v22, v22, v23
    v_cndmask_b32 v48, 0, v20, vcc
    v_cndmask_b32 v52, 0, v22, vcc
    v_mov_b32 v49, v48
    v_mov_b32 v53, v52
    ds_write_b32 v4, v16
    ds_write_b32 v4, v18 offset:128
    s_waitcnt lgkmcnt(2)
    v_mfma_f32_32x32x16_bf16 v[64:79], v[56:59], v[48:51], v[64:79]
    v_mfma_f32_32x32x16_bf16 v[96:111], v[48:51], v[60:63], v[96:111]
    v_mfma_f32_32x32x16_bf16 v[80:95], v[56:59], v[52:55], v[80:95]
    v_mfma_f32_32x32x16_bf16 v[112:127], v[52:55], v[60:63], v[112:127]
    s_lshl_b32 s56, s42, 8
    s_add_u32 s56, s56, 160768
    v_lshrrev_b32 v4, 5, v0
    v_lshl_add_u32 v4, v4, 4, s56
    ds_read_b128 v[128:131], v4 offset:0
    ds_read_b128 v[132:135], v4 offset:32
    ds_read_b128 v[136:139], v4 offset:64
    ds_read_b128 v[140:143], v4 offset:96
    ds_read_b128 v[144:147], v4 offset:128
    ds_read_b128 v[148:151], v4 offset:160
    ds_read_b128 v[152:155], v4 offset:192
    ds_read_b128 v[156:159], v4 offset:224
    s_lshl_b32 s56, s42, 11
    s_add_u32 s56, s56, 131072
    s_sub_u32 s57, 7, s42
    s_lshl_b32 s57, s57, 11
    s_add_u32 s57, s57, 131072
    v_lshrrev_b32 v5, 5, v0
    v_lshlrev_b32 v5, 4, v5
    v_and_b32 v6, 15, v0
    v_add_u32 v5, v5, v6
    v_lshlrev_b32 v5, 4, v5
    v_add_u32 v5, 1024, v5
    v_mul_f32 v20, 0x3eb8aa3b, v16
    v_pk_mul_f32 v[64:65], v[64:65], v[20:21] op_sel_hi:[1,0]
    v_pk_mul_f32 v[66:67], v[66:67], v[20:21] op_sel_hi:[1,0]
    v_pk_mul_f32 v[68:69], v[68:69], v[20:21] op_sel_hi:[1,0]
    v_pk_mul_f32 v[70:71], v[70:71], v[20:21] op_sel_hi:[1,0]
    v_pk_mul_f32 v[72:73], v[72:73], v[16:17] op_sel_hi:[1,0]
    v_pk_mul_f32 v[74:75], v[74:75], v[16:17] op_sel_hi:[1,0]
    v_pk_mul_f32 v[76:77], v[76:77], v[16:17] op_sel_hi:[1,0]
    v_pk_mul_f32 v[78:79], v[78:79], v[16:17] op_sel_hi:[1,0]
    v_cvt_pk_bf16_f32 v160, v64, v65
    v_cvt_pk_bf16_f32 v161, v66, v67
    v_cvt_pk_bf16_f32 v162, v68, v69
    v_cvt_pk_bf16_f32 v163, v70, v71
    v_cvt_pk_bf16_f32 v168, v72, v73
    v_cvt_pk_bf16_f32 v169, v74, v75
    v_cvt_pk_bf16_f32 v170, v76, v77
    v_cvt_pk_bf16_f32 v171, v78, v79
    v_add_u32 v22, s56, v8
    ds_write_b128 v22, v[168:171]
    v_mul_f32 v20, 0x3eb8aa3b, v18
    v_pk_mul_f32 v[80:81], v[80:81], v[20:21] op_sel_hi:[1,0]
    v_pk_mul_f32 v[82:83], v[82:83], v[20:21] op_sel_hi:[1,0]
    v_pk_mul_f32 v[84:85], v[84:85], v[20:21] op_sel_hi:[1,0]
    v_pk_mul_f32 v[86:87], v[86:87], v[20:21] op_sel_hi:[1,0]
    v_pk_mul_f32 v[88:89], v[88:89], v[18:19] op_sel_hi:[1,0]
    v_pk_mul_f32 v[90:91], v[90:91], v[18:19] op_sel_hi:[1,0]
    v_pk_mul_f32 v[92:93], v[92:93], v[18:19] op_sel_hi:[1,0]
    v_pk_mul_f32 v[94:95], v[94:95], v[18:19] op_sel_hi:[1,0]
    v_cvt_pk_bf16_f32 v164, v80, v81
    v_cvt_pk_bf16_f32 v165, v82, v83
    v_cvt_pk_bf16_f32 v166, v84, v85
    v_cvt_pk_bf16_f32 v167, v86, v87
    v_cvt_pk_bf16_f32 v172, v88, v89
    v_cvt_pk_bf16_f32 v173, v90, v91
    v_cvt_pk_bf16_f32 v174, v92, v93
    v_cvt_pk_bf16_f32 v175, v94, v95
    v_add_u32 v23, s57, v8
    ds_write_b128 v23, v[172:175]
    s_waitcnt lgkmcnt(2)
    v_pk_mul_f32 v[96:97], v[96:97], v[128:129]
    v_pk_mul_f32 v[98:99], v[98:99], v[130:131]
    v_pk_mul_f32 v[100:101], v[100:101], v[132:133]
    v_pk_mul_f32 v[102:103], v[102:103], v[134:135]
    v_pk_mul_f32 v[104:105], v[104:105], v[136:137]
    v_pk_mul_f32 v[106:107], v[106:107], v[138:139]
    v_pk_mul_f32 v[108:109], v[108:109], v[140:141]
    v_pk_mul_f32 v[110:111], v[110:111], v[142:143]
    v_cvt_pk_bf16_f32 v176, v96, v97
    v_cvt_pk_bf16_f32 v177, v98, v99
    v_cvt_pk_bf16_f32 v178, v100, v101
    v_cvt_pk_bf16_f32 v179, v102, v103
    v_cvt_pk_bf16_f32 v180, v104, v105
    v_cvt_pk_bf16_f32 v181, v106, v107
    v_cvt_pk_bf16_f32 v182, v108, v109
    v_cvt_pk_bf16_f32 v183, v110, v111
    v_add_u32 v24, s56, v5
    v_pk_mul_f32 v[112:113], v[112:113], v[144:145]
    v_pk_mul_f32 v[114:115], v[114:115], v[146:147]
    v_pk_mul_f32 v[116:117], v[116:117], v[148:149]
    v_pk_mul_f32 v[118:119], v[118:119], v[150:151]
    v_pk_mul_f32 v[120:121], v[120:121], v[152:153]
    v_pk_mul_f32 v[122:123], v[122:123], v[154:155]
    v_pk_mul_f32 v[124:125], v[124:125], v[156:157]
    v_pk_mul_f32 v[126:127], v[126:127], v[158:159]
    v_cvt_pk_bf16_f32 v184, v112, v113
    v_cvt_pk_bf16_f32 v185, v114, v115
    v_cvt_pk_bf16_f32 v186, v116, v117
    v_cvt_pk_bf16_f32 v187, v118, v119
    v_cvt_pk_bf16_f32 v188, v120, v121
    v_cvt_pk_bf16_f32 v189, v122, v123
    v_cvt_pk_bf16_f32 v190, v124, v125
    v_cvt_pk_bf16_f32 v191, v126, v127
    v_add_u32 v25, s57, v5
    s_mov_b32 exec_lo, 0xffff
    s_mov_b32 exec_hi, 0xffff
    ds_write_b128 v24, v[176:179]
    ds_write_b128 v24, v[180:183] offset:512
    ds_write_b128 v25, v[184:187]
    ds_write_b128 v25, v[188:191] offset:512
    s_mov_b64 exec, -1
    s_waitcnt lgkmcnt(0)
    s_barrier
    v_and_b32 v4, 16, v0
    v_cmp_eq_u32 s[64:65], 0, v4
    v_mov_b32 v7, 2048
    s_nop 0
    v_cndmask_b32_e64 v28, 0, v7, s[64:65]
    v_mov_b32 v30, 159744
    v_add_u32 v4, 131072, v8
    v_add_u32 v29, 131072, v5
    v_cndmask_b32_e64 v29, v30, v29, s[64:65]
    s_cmp_eq_u32 s42, 1
    s_cbranch_scc1 L_att1_22
    s_cmp_eq_u32 s42, 2
    s_cbranch_scc1 L_att2_23
    s_cmp_eq_u32 s42, 3
    s_cbranch_scc1 L_att3_24
L_att0_21:
    ds_read_b128 v[128:131], v4 offset:0
    ds_read_b128 v[132:135], v4 offset:2048
    ds_read_b128 v[136:139], v4 offset:4096
    ds_read_b128 v[140:143], v4 offset:6144
    ds_read_b128 v[144:147], v4 offset:8192
    ds_read_b128 v[148:151], v4 offset:10240
    ds_read_b128 v[152:155], v4 offset:12288
    ds_read_b128 v[156:159], v4 offset:14336
    s_waitcnt lgkmcnt(7)
    v_mfma_f32_32x32x16_bf16 v[96:111], v[128:131], v[164:167], 0
    v_mfma_f32_32x32x16_bf16 v[112:127], v[128:131], v[160:163], v[224:239]
    v_mad_u32_u24 v6, v28, 0, v29
    ds_read_b128 v[168:171], v6
    ds_read_b128 v[172:175], v6 offset:512
    v_mad_u32_u24 v6, v28, 0, v29
    ds_read_b128 v[176:179], v6
    ds_read_b128 v[180:183], v6 offset:512
    s_waitcnt lgkmcnt(10)
    v_mfma_f32_32x32x16_bf16 v[192:207], v[132:135], v[164:167], 0
    s_nop 2
    v_max3_f32 v22, v96, v97, v98
    v_max3_f32 v23, v99, v100, v101
    v_max3_f32 v22, v22, v102, v103
    v_max3_f32 v23, v23, v104, v105
    v_max3_f32 v22, v22, v106, v107
    v_max3_f32 v23, v23, v108, v109
    v_max3_f32 v22, v22, v110, v111
    s_waitcnt lgkmcnt(9)
    v_mfma_f32_32x32x16_bf16 v[96:111], v[136:139], v[164:167], 0
    v_max3_f32 v20, v112, v113, v114
    v_max3_f32 v21, v115, v116, v117
    v_max3_f32 v20, v20, v118, v119
    v_max3_f32 v21, v21, v120, v121
    v_max3_f32 v20, v20, v122, v123
    v_max3_f32 v21, v21, v124, v125
    v_max3_f32 v20, v20, v126, v127
    s_waitcnt lgkmcnt(8)
    v_mfma_f32_32x32x16_bf16 v[112:127], v[140:143], v[164:167], 0
    v_max3_f32 v22, v22, v192, v193
    v_max3_f32 v23, v23, v194, v195
    v_max3_f32 v22, v22, v196, v197
    v_max3_f32 v23, v23, v198, v199
    v_max3_f32 v22, v22, v200, v201
    v_max3_f32 v23, v23, v202, v203
    v_max3_f32 v22, v22, v204, v205
    v_max3_f32 v23, v23, v206, v207
    s_waitcnt lgkmcnt(7)
    v_mfma_f32_32x32x16_bf16 v[192:207], v[144:147], v[164:167], 0
    v_max3_f32 v22, v22, v96, v97
    v_max3_f32 v23, v23, v98, v99
    v_max3_f32 v22, v22, v100, v101
    v_max3_f32 v23, v23, v102, v103
    v_max3_f32 v22, v22, v104, v105
    v_max3_f32 v23, v23, v106, v107
    v_max3_f32 v22, v22, v108, v109
    v_max3_f32 v23, v23, v110, v111
    s_waitcnt lgkmcnt(6)
    v_mfma_f32_32x32x16_bf16 v[96:111], v[148:151], v[164:167], 0
    v_max3_f32 v22, v22, v112, v113
    v_max3_f32 v23, v23, v114, v115
    v_max3_f32 v22, v22, v116, v117
    v_max3_f32 v23, v23, v118, v119
    v_max3_f32 v22, v22, v120, v121
    v_max3_f32 v23, v23, v122, v123
    v_max3_f32 v22, v22, v124, v125
    v_max3_f32 v23, v23, v126, v127
    s_waitcnt lgkmcnt(5)
    v_mfma_f32_32x32x16_bf16 v[112:127], v[152:155], v[164:167], 0
    v_max3_f32 v22, v22, v192, v193
    v_max3_f32 v23, v23, v194, v195
    v_max3_f32 v22, v22, v196, v197
    v_max3_f32 v23, v23, v198, v199
    v_max3_f32 v22, v22, v200, v201
    v_max3_f32 v23, v23, v202, v203
    v_max3_f32 v22, v22, v204, v205
    v_max3_f32 v23, v23, v206, v207
    s_waitcnt lgkmcnt(4)
    v_mfma_f32_32x32x16_bf16 v[192:207], v[156:159], v[164:167], v[224:239]
    v_max3_f32 v22, v22, v96, v97
    v_max3_f32 v23, v23, v98, v99
    v_max3_f32 v22, v22, v100, v101
    v_max3_f32 v23, v23, v102, v103
    v_max3_f32 v22, v22, v104, v105
    v_max3_f32 v23, v23, v106, v107
    v_max3_f32 v22, v22, v108, v109
    v_max3_f32 v23, v23, v110, v111
    v_max3_f32 v22, v22, v112, v113
    v_max3_f32 v23, v23, v114, v115
    v_max3_f32 v22, v22, v116, v117
    v_max3_f32 v23, v23, v118, v119
    v_max3_f32 v22, v22, v120, v121
    v_max3_f32 v23, v23, v122, v123
    v_max3_f32 v22, v22, v124, v125
    v_max3_f32 v23, v23, v126, v127
    v_max3_f32 v22, v22, v192, v193
    v_max3_f32 v23, v23, v194, v195
    v_max3_f32 v22, v22, v196, v197
    v_max3_f32 v23, v23, v198, v199
    v_max3_f32 v22, v22, v200, v201
    v_max3_f32 v23, v23, v202, v203
    v_max3_f32 v22, v22, v204, v205
    v_max3_f32 v23, v23, v206, v207
    v_max_f32 v20, v20, v21
    v_max_f32 v22, v22, v23
    v_mov_b32 v21, v20
    v_mov_b32 v23, v22
    s_nop 0
    v_permlane32_swap_b32 v20, v21
    v_permlane32_swap_b32 v22, v23
    v_max_f32 v12, v20, v21
    v_max_f32 v14, v22, v23
    v_sub_f32 v20, 0, v12
    v_sub_f32 v22, 0, v14
    v_mov_b32 v21, v20
    v_mov_b32 v23, v22
    v_pk_mov_b32 v[48:49], v[22:23], v[22:23] op_sel:[0,0]
    v_pk_mov_b32 v[50:51], v[22:23], v[22:23] op_sel:[0,0]
    v_pk_mov_b32 v[52:53], v[22:23], v[22:23] op_sel:[0,0]
    v_pk_mov_b32 v[54:55], v[22:23], v[22:23] op_sel:[0,0]
    v_pk_mov_b32 v[56:57], v[22:23], v[22:23] op_sel:[0,0]
    v_pk_mov_b32 v[58:59], v[22:23], v[22:23] op_sel:[0,0]
    v_pk_mov_b32 v[60:61], v[22:23], v[22:23] op_sel:[0,0]
    v_pk_mov_b32 v[62:63], v[22:23], v[22:23] op_sel:[0,0]
    v_pk_add_f32 v[192:193], v[224:225], v[20:21]
    v_pk_add_f32 v[194:195], v[226:227], v[20:21]
    v_pk_add_f32 v[196:197], v[228:229], v[20:21]
    v_pk_add_f32 v[198:199], v[230:231], v[20:21]
    v_pk_add_f32 v[200:201], v[232:233], v[20:21]
    v_pk_add_f32 v[202:203], v[234:235], v[20:21]
    v_pk_add_f32 v[204:205], v[236:237], v[20:21]
    v_pk_add_f32 v[206:207], v[238:239], v[20:21]
    v_mfma_f32_32x32x16_bf16 v[96:111], v[128:131], v[164:167], v[48:63]
    s_nop 0
    v_mfma_f32_32x32x16_bf16 v[112:127], v[128:131], v[160:163], v[192:207]
    v_pk_add_f32 v[208:209], v[224:225], v[22:23]
    v_pk_add_f32 v[210:211], v[226:227], v[22:23]
    v_pk_add_f32 v[212:213], v[228:229], v[22:23]
    v_pk_add_f32 v[214:215], v[230:231], v[22:23]
    v_pk_add_f32 v[216:217], v[232:233], v[22:23]
    v_pk_add_f32 v[218:219], v[234:235], v[22:23]
    v_pk_add_f32 v[220:221], v[236:237], v[22:23]
    v_pk_add_f32 v[222:223], v[238:239], v[22:23]
    s_nop 1
    v_exp_f32 v96, v96
    v_exp_f32 v97, v97
    v_exp_f32 v98, v98
    v_exp_f32 v99, v99
    v_exp_f32 v100, v100
    v_exp_f32 v101, v101
    v_exp_f32 v102, v102
    v_exp_f32 v103, v103
    v_cvt_pk_bf16_f32 v184, v96, v97
    v_cvt_pk_bf16_f32 v185, v98, v99
    v_cvt_pk_bf16_f32 v186, v100, v101
    v_cvt_pk_bf16_f32 v187, v102, v103
    v_exp_f32 v104, v104
    v_exp_f32 v105, v105
    s_waitcnt lgkmcnt(2)
    v_mfma_f32_32x32x16_bf16 v[80:95], v[168:171], v[184:187], 0
    v_exp_f32 v106, v106
    v_exp_f32 v107, v107
    v_exp_f32 v108, v108
    v_exp_f32 v109, v109
    v_exp_f32 v110, v110
    v_exp_f32 v111, v111
    v_cvt_pk_bf16_f32 v188, v104, v105
    v_cvt_pk_bf16_f32 v189, v106, v107
    v_cvt_pk_bf16_f32 v190, v108, v109
    v_cvt_pk_bf16_f32 v191, v110, v111
    v_mfma_f32_32x32x16_bf16 v[96:111], v[132:135], v[164:167], v[48:63]
    v_mad_u32_u24 v6, v28, 1, v29
    v_mfma_f32_32x32x16_bf16 v[80:95], v[172:175], v[188:191], v[80:95]
    ds_read_b128 v[168:171], v6
    ds_read_b128 v[172:175], v6 offset:512
    v_exp_f32 v112, v112
    v_exp_f32 v113, v113
    v_exp_f32 v114, v114
    v_exp_f32 v115, v115
    v_exp_f32 v116, v116
    v_exp_f32 v117, v117
    v_exp_f32 v118, v118
    v_exp_f32 v119, v119
    v_cvt_pk_bf16_f32 v184, v112, v113
    v_cvt_pk_bf16_f32 v185, v114, v115
    v_cvt_pk_bf16_f32 v186, v116, v117
    v_cvt_pk_bf16_f32 v187, v118, v119
    v_exp_f32 v120, v120
    v_exp_f32 v121, v121
    s_waitcnt lgkmcnt(2)
    v_mfma_f32_32x32x16_bf16 v[64:79], v[176:179], v[184:187], 0
    v_exp_f32 v122, v122
    v_exp_f32 v123, v123
    v_exp_f32 v124, v124
    v_exp_f32 v125, v125
    v_exp_f32 v126, v126
    v_exp_f32 v127, v127
    v_cvt_pk_bf16_f32 v188, v120, v121
    v_cvt_pk_bf16_f32 v189, v122, v123
    v_cvt_pk_bf16_f32 v190, v124, v125
    v_cvt_pk_bf16_f32 v191, v126, v127
    v_mfma_f32_32x32x16_bf16 v[112:127], v[136:139], v[164:167], v[48:63]
    v_mad_u32_u24 v6, v28, 2, v29
    v_mfma_f32_32x32x16_bf16 v[64:79], v[180:183], v[188:191], v[64:79]
    ds_read_b128 v[176:179], v6
    ds_read_b128 v[180:183], v6 offset:512
    v_exp_f32 v96, v96
    v_exp_f32 v97, v97
    v_exp_f32 v98, v98
    v_exp_f32 v99, v99
    v_exp_f32 v100, v100
    v_exp_f32 v101, v101
    v_exp_f32 v102, v102
    v_exp_f32 v103, v103
    v_cvt_pk_bf16_f32 v184, v96, v97
    v_cvt_pk_bf16_f32 v185, v98, v99
    v_cvt_pk_bf16_f32 v186, v100, v101
    v_cvt_pk_bf16_f32 v187, v102, v103
    v_exp_f32 v104, v104
    v_exp_f32 v105, v105
    s_waitcnt lgkmcnt(2)
    v_mfma_f32_32x32x16_bf16 v[80:95], v[168:171], v[184:187], v[80:95]
    v_exp_f32 v106, v106
    v_exp_f32 v107, v107
    v_exp_f32 v108, v108
    v_exp_f32 v109, v109
    v_exp_f32 v110, v110
    v_exp_f32 v111, v111
    v_cvt_pk_bf16_f32 v188, v104, v105
    v_cvt_pk_bf16_f32 v189, v106, v107
    v_cvt_pk_bf16_f32 v190, v108, v109
    v_cvt_pk_bf16_f32 v191, v110, v111
    v_mfma_f32_32x32x16_bf16 v[96:111], v[140:143], v[164:167], v[48:63]
    v_mad_u32_u24 v6, v28, 3, v29
    v_mfma_f32_32x32x16_bf16 v[80:95], v[172:175], v[188:191], v[80:95]
    ds_read_b128 v[168:171], v6
    ds_read_b128 v[172:175], v6 offset:512
    v_exp_f32 v112, v112
    v_exp_f32 v113, v113
    v_exp_f32 v114, v114
    v_exp_f32 v115, v115
    v_exp_f32 v116, v116
    v_exp_f32 v117, v117
    v_exp_f32 v118, v118
    v_exp_f32 v119, v119
    v_cvt_pk_bf16_f32 v184, v112, v113
    v_cvt_pk_bf16_f32 v185, v114, v115
    v_cvt_pk_bf16_f32 v186, v116, v117
    v_cvt_pk_bf16_f32 v187, v118, v119
    v_exp_f32 v120, v120
    v_exp_f32 v121, v121
    s_waitcnt lgkmcnt(2)
    v_mfma_f32_32x32x16_bf16 v[80:95], v[176:179], v[184:187], v[80:95]
    v_exp_f32 v122, v122
    v_exp_f32 v123, v123
    v_exp_f32 v124, v124
    v_exp_f32 v125, v125
    v_exp_f32 v126, v126
    v_exp_f32 v127, v127
    v_cvt_pk_bf16_f32 v188, v120, v121
    v_cvt_pk_bf16_f32 v189, v122, v123
    v_cvt_pk_bf16_f32 v190, v124, v125
    v_cvt_pk_bf16_f32 v191, v126, v127
    v_mfma_f32_32x32x16_bf16 v[112:127], v[144:147], v[164:167], v[48:63]
    v_mad_u32_u24 v6, v28, 4, v29
    v_mfma_f32_32x32x16_bf16 v[80:95], v[180:183], v[188:191], v[80:95]
    ds_read_b128 v[176:179], v6
    ds_read_b128 v[180:183], v6 offset:512
    v_exp_f32 v96, v96
    v_exp_f32 v97, v97
    v_exp_f32 v98, v98
    v_exp_f32 v99, v99
    v_exp_f32 v100, v100
    v_exp_f32 v101, v101
    v_exp_f32 v102, v102
    v_exp_f32 v103, v103
    v_cvt_pk_bf16_f32 v184, v96, v97
    v_cvt_pk_bf16_f32 v185, v98, v99
    v_cvt_pk_bf16_f32 v186, v100, v101
    v_cvt_pk_bf16_f32 v187, v102, v103
    v_exp_f32 v104, v104
    v_exp_f32 v105, v105
    s_waitcnt lgkmcnt(2)
    v_mfma_f32_32x32x16_bf16 v[80:95], v[168:171], v[184:187], v[80:95]
    v_exp_f32 v106, v106
    v_exp_f32 v107, v107
    v_exp_f32 v108, v108
    v_exp_f32 v109, v109
    v_exp_f32 v110, v110
    v_exp_f32 v111, v111
    v_cvt_pk_bf16_f32 v188, v104, v105
    v_cvt_pk_bf16_f32 v189, v106, v107
    v_cvt_pk_bf16_f32 v190, v108, v109
    v_cvt_pk_bf16_f32 v191, v110, v111
    v_mfma_f32_32x32x16_bf16 v[96:111], v[148:151], v[164:167], v[48:63]
    v_mad_u32_u24 v6, v28, 5, v29
    v_mfma_f32_32x32x16_bf16 v[80:95], v[172:175], v[188:191], v[80:95]
    ds_read_b128 v[168:171], v6
    ds_read_b128 v[172:175], v6 offset:512
    v_exp_f32 v112, v112
    v_exp_f32 v113, v113
    v_exp_f32 v114, v114
    v_exp_f32 v115, v115
    v_exp_f32 v116, v116
    v_exp_f32 v117, v117
    v_exp_f32 v118, v118
    v_exp_f32 v119, v119
    v_cvt_pk_bf16_f32 v184, v112, v113
    v_cvt_pk_bf16_f32 v185, v114, v115
    v_cvt_pk_bf16_f32 v186, v116, v117
    v_cvt_pk_bf16_f32 v187, v118, v119
    v_exp_f32 v120, v120
    v_exp_f32 v121, v121
    s_waitcnt lgkmcnt(2)
    v_mfma_f32_32x32x16_bf16 v[80:95], v[176:179], v[184:187], v[80:95]
    v_exp_f32 v122, v122
    v_exp_f32 v123, v123
    v_exp_f32 v124, v124
    v_exp_f32 v125, v125
    v_exp_f32 v126, v126
    v_exp_f32 v127, v127
    v_cvt_pk_bf16_f32 v188, v120, v121
    v_cvt_pk_bf16_f32 v189, v122, v123
    v_cvt_pk_bf16_f32 v190, v124, v125
    v_cvt_pk_bf16_f32 v191, v126, v127
    v_mfma_f32_32x32x16_bf16 v[112:127], v[152:155], v[164:167], v[48:63]
    v_mad_u32_u24 v6, v28, 6, v29
    v_mfma_f32_32x32x16_bf16 v[80:95], v[180:183], v[188:191], v[80:95]
    ds_read_b128 v[176:179], v6
    ds_read_b128 v[180:183], v6 offset:512
    v_exp_f32 v96, v96
    v_exp_f32 v97, v97
    v_exp_f32 v98, v98
    v_exp_f32 v99, v99
    v_exp_f32 v100, v100
    v_exp_f32 v101, v101
    v_exp_f32 v102, v102
    v_exp_f32 v103, v103
    v_cvt_pk_bf16_f32 v184, v96, v97
    v_cvt_pk_bf16_f32 v185, v98, v99
    v_cvt_pk_bf16_f32 v186, v100, v101
    v_cvt_pk_bf16_f32 v187, v102, v103
    v_exp_f32 v104, v104
    v_exp_f32 v105, v105
    s_waitcnt lgkmcnt(2)
    v_mfma_f32_32x32x16_bf16 v[80:95], v[168:171], v[184:187], v[80:95]
    v_exp_f32 v106, v106
    v_exp_f32 v107, v107
    v_exp_f32 v108, v108
    v_exp_f32 v109, v109
    v_exp_f32 v110, v110
    v_exp_f32 v111, v111
    v_cvt_pk_bf16_f32 v188, v104, v105
    v_cvt_pk_bf16_f32 v189, v106, v107
    v_cvt_pk_bf16_f32 v190, v108, v109
    v_cvt_pk_bf16_f32 v191, v110, v111
    v_mfma_f32_32x32x16_bf16 v[96:111], v[156:159], v[164:167], v[208:223]
    v_mad_u32_u24 v6, v28, 7, v29
    v_mfma_f32_32x32x16_bf16 v[80:95], v[172:175], v[188:191], v[80:95]
    ds_read_b128 v[168:171], v6
    ds_read_b128 v[172:175], v6 offset:512
    v_exp_f32 v112, v112
    v_exp_f32 v113, v113
    v_exp_f32 v114, v114
    v_exp_f32 v115, v115
    v_exp_f32 v116, v116
    v_exp_f32 v117, v117
    v_exp_f32 v118, v118
    v_exp_f32 v119, v119
    v_cvt_pk_bf16_f32 v184, v112, v113
    v_cvt_pk_bf16_f32 v185, v114, v115
    v_cvt_pk_bf16_f32 v186, v116, v117
    v_cvt_pk_bf16_f32 v187, v118, v119
    v_exp_f32 v120, v120
    v_exp_f32 v121, v121
    s_waitcnt lgkmcnt(2)
    v_mfma_f32_32x32x16_bf16 v[80:95], v[176:179], v[184:187], v[80:95]
    v_exp_f32 v122, v122
    v_exp_f32 v123, v123
    v_exp_f32 v124, v124
    v_exp_f32 v125, v125
    v_exp_f32 v126, v126
    v_exp_f32 v127, v127
    v_cvt_pk_bf16_f32 v188, v120, v121
    v_cvt_pk_bf16_f32 v189, v122, v123
    v_cvt_pk_bf16_f32 v190, v124, v125
    v_cvt_pk_bf16_f32 v191, v126, v127
    s_nop 1
    v_mfma_f32_32x32x16_bf16 v[80:95], v[180:183], v[188:191], v[80:95]
    v_exp_f32 v96, v96
    v_exp_f32 v97, v97
    v_exp_f32 v98, v98
    v_exp_f32 v99, v99
    v_exp_f32 v100, v100
    v_exp_f32 v101, v101
    v_exp_f32 v102, v102
    v_exp_f32 v103, v103
    v_cvt_pk_bf16_f32 v184, v96, v97
    v_cvt_pk_bf16_f32 v185, v98, v99
    v_cvt_pk_bf16_f32 v186, v100, v101
    v_cvt_pk_bf16_f32 v187, v102, v103
    v_exp_f32 v104, v104
    v_exp_f32 v105, v105
    s_waitcnt lgkmcnt(0)
    v_mfma_f32_32x32x16_bf16 v[80:95], v[168:171], v[184:187], v[80:95]
    v_exp_f32 v106, v106
    v_exp_f32 v107, v107
    v_exp_f32 v108, v108
    v_exp_f32 v109, v109
    v_exp_f32 v110, v110
    v_exp_f32 v111, v111
    v_cvt_pk_bf16_f32 v188, v104, v105
    v_cvt_pk_bf16_f32 v189, v106, v107
    v_cvt_pk_bf16_f32 v190, v108, v109
    v_cvt_pk_bf16_f32 v191, v110, v111
    s_nop 1
    v_mfma_f32_32x32x16_bf16 v[80:95], v[172:175], v[188:191], v[80:95]
    s_branch L_attd_25
L_att1_22:
    ds_read_b128 v[128:131], v4 offset:0
    ds_read_b128 v[132:135], v4 offset:2048
    ds_read_b128 v[136:139], v4 offset:4096
    ds_read_b128 v[140:143], v4 offset:6144
    ds_read_b128 v[144:147], v4 offset:8192
    ds_read_b128 v[148:151], v4 offset:10240
    ds_read_b128 v[152:155], v4 offset:12288
    s_waitcnt lgkmcnt(6)
    v_mfma_f32_32x32x16_bf16 v[96:111], v[128:131], v[164:167], 0
    v_mfma_f32_32x32x16_bf16 v[112:127], v[128:131], v[160:163], 0
    v_mad_u32_u24 v6, v28, 0, v29
    ds_read_b128 v[168:171], v6
    ds_read_b128 v[172:175], v6 offset:512
    v_mad_u32_u24 v6, v28, 0, v29
    ds_read_b128 v[176:179], v6
    ds_read_b128 v[180:183], v6 offset:512
    s_waitcnt lgkmcnt(9)
    v_mfma_f32_32x32x16_bf16 v[192:207], v[132:135], v[164:167], 0
    s_nop 2
    v_max3_f32 v22, v96, v97, v98
    v_max3_f32 v23, v99, v100, v101
    v_max3_f32 v22, v22, v102, v103
    v_max3_f32 v23, v23, v104, v105
    v_max3_f32 v22, v22, v106, v107
    v_max3_f32 v23, v23, v108, v109
    v_max3_f32 v22, v22, v110, v111
    v_mfma_f32_32x32x16_bf16 v[96:111], v[132:135], v[160:163], v[224:239]
    v_max3_f32 v20, v112, v113, v114
    v_max3_f32 v21, v115, v116, v117
    v_max3_f32 v20, v20, v118, v119
    v_max3_f32 v21, v21, v120, v121
    v_max3_f32 v20, v20, v122, v123
    v_max3_f32 v21, v21, v124, v125
    v_max3_f32 v20, v20, v126, v127
    s_waitcnt lgkmcnt(8)
    v_mfma_f32_32x32x16_bf16 v[112:127], v[136:139], v[164:167], 0
    v_max3_f32 v22, v22, v192, v193
    v_max3_f32 v23, v23, v194, v195
    v_max3_f32 v22, v22, v196, v197
    v_max3_f32 v23, v23, v198, v199
    v_max3_f32 v22, v22, v200, v201
    v_max3_f32 v23, v23, v202, v203
    v_max3_f32 v22, v22, v204, v205
    v_max3_f32 v23, v23, v206, v207
    s_waitcnt lgkmcnt(7)
    v_mfma_f32_32x32x16_bf16 v[192:207], v[140:143], v[164:167], 0
    v_max3_f32 v20, v20, v96, v97
    v_max3_f32 v21, v21, v98, v99
    v_max3_f32 v20, v20, v100, v101
    v_max3_f32 v21, v21, v102, v103
    v_max3_f32 v20, v20, v104, v105
    v_max3_f32 v21, v21, v106, v107
    v_max3_f32 v20, v20, v108, v109
    v_max3_f32 v21, v21, v110, v111
    s_waitcnt lgkmcnt(6)
    v_mfma_f32_32x32x16_bf16 v[96:111], v[144:147], v[164:167], 0
    v_max3_f32 v22, v22, v112, v113
    v_max3_f32 v23, v23, v114, v115
    v_max3_f32 v22, v22, v116, v117
    v_max3_f32 v23, v23, v118, v119
    v_max3_f32 v22, v22, v120, v121
    v_max3_f32 v23, v23, v122, v123
    v_max3_f32 v22, v22, v124, v125
    v_max3_f32 v23, v23, v126, v127
    s_waitcnt lgkmcnt(5)
    v_mfma_f32_32x32x16_bf16 v[112:127], v[148:151], v[164:167], 0
    v_max3_f32 v22, v22, v192, v193
    v_max3_f32 v23, v23, v194, v195
    v_max3_f32 v22, v22, v196, v197
    v_max3_f32 v23, v23, v198, v199
    v_max3_f32 v22, v22, v200, v201
    v_max3_f32 v23, v23, v202, v203
    v_max3_f32 v22, v22, v204, v205
    v_max3_f32 v23, v23, v206, v207
    s_waitcnt lgkmcnt(4)
    v_mfma_f32_32x32x16_bf16 v[192:207], v[152:155], v[164:167], v[224:239]
    v_max3_f32 v22, v22, v96, v97
    v_max3_f32 v23, v23, v98, v99
    v_max3_f32 v22, v22, v100, v101
    v_max3_f32 v23, v23, v102, v103
    v_max3_f32 v22, v22, v104, v105
    v_max3_f32 v23, v23, v106, v107
    v_max3_f32 v22, v22, v108, v109
    v_max3_f32 v23, v23, v110, v111
    v_max3_f32 v22, v22, v112, v113
    v_max3_f32 v23, v23, v114, v115
    v_max3_f32 v22, v22, v116, v117
    v_max3_f32 v23, v23, v118, v119
    v_max3_f32 v22, v22, v120, v121
    v_max3_f32 v23, v23, v122, v123
    v_max3_f32 v22, v22, v124, v125
    v_max3_f32 v23, v23, v126, v127
    v_max3_f32 v22, v22, v192, v193
    v_max3_f32 v23, v23, v194, v195
    v_max3_f32 v22, v22, v196, v197
    v_max3_f32 v23, v23, v198, v199
    v_max3_f32 v22, v22, v200, v201
    v_max3_f32 v23, v23, v202, v203
    v_max3_f32 v22, v22, v204, v205
    v_max3_f32 v23, v23, v206, v207
    v_max_f32 v20, v20, v21
    v_max_f32 v22, v22, v23
    v_mov_b32 v21, v20
    v_mov_b32 v23, v22
    s_nop 0
    v_permlane32_swap_b32 v20, v21
    v_permlane32_swap_b32 v22, v23
    v_max_f32 v12, v20, v21
    v_max_f32 v14, v22, v23
    v_sub_f32 v20, 0, v12
    v_sub_f32 v22, 0, v14
    v_mov_b32 v21, v20
    v_mov_b32 v23, v22
    v_pk_mov_b32 v[48:49], v[22:23], v[22:23] op_sel:[0,0]
    v_pk_mov_b32 v[50:51], v[22:23], v[22:23] op_sel:[0,0]
    v_pk_mov_b32 v[52:53], v[22:23], v[22:23] op_sel:[0,0]
    v_pk_mov_b32 v[54:55], v[22:23], v[22:23] op_sel:[0,0]
    v_pk_mov_b32 v[56:57], v[22:23], v[22:23] op_sel:[0,0]
    v_pk_mov_b32 v[58:59], v[22:23], v[22:23] op_sel:[0,0]
    v_pk_mov_b32 v[60:61], v[22:23], v[22:23] op_sel:[0,0]
    v_pk_mov_b32 v[62:63], v[22:23], v[22:23] op_sel:[0,0]
    v_pk_mov_b32 v[32:33], v[20:21], v[20:21] op_sel:[0,0]
    v_pk_mov_b32 v[34:35], v[20:21], v[20:21] op_sel:[0,0]
    v_pk_mov_b32 v[36:37], v[20:21], v[20:21] op_sel:[0,0]
    v_pk_mov_b32 v[38:39], v[20:21], v[20:21] op_sel:[0,0]
    v_pk_mov_b32 v[40:41], v[20:21], v[20:21] op_sel:[0,0]
    v_pk_mov_b32 v[42:43], v[20:21], v[20:21] op_sel:[0,0]
    v_pk_mov_b32 v[44:45], v[20:21], v[20:21] op_sel:[0,0]
    v_pk_mov_b32 v[46:47], v[20:21], v[20:21] op_sel:[0,0]
    v_mfma_f32_32x32x16_bf16 v[96:111], v[128:131], v[164:167], v[48:63]
    s_nop 0
    v_mfma_f32_32x32x16_bf16 v[112:127], v[128:131], v[160:163], v[32:47]
    v_pk_add_f32 v[192:193], v[224:225], v[20:21]
    v_pk_add_f32 v[194:195], v[226:227], v[20:21]
    v_pk_add_f32 v[196:197], v[228:229], v[20:21]
    v_pk_add_f32 v[198:199], v[230:231], v[20:21]
    v_pk_add_f32 v[200:201], v[232:233], v[20:21]
    v_pk_add_f32 v[202:203], v[234:235], v[20:21]
    v_pk_add_f32 v[204:205], v[236:237], v[20:21]
    v_pk_add_f32 v[206:207], v[238:239], v[20:21]
    v_pk_add_f32 v[208:209], v[224:225], v[22:23]
    v_pk_add_f32 v[210:211], v[226:227], v[22:23]
    v_pk_add_f32 v[212:213], v[228:229], v[22:23]
    v_pk_add_f32 v[214:215], v[230:231], v[22:23]
    v_pk_add_f32 v[216:217], v[232:233], v[22:23]
    v_pk_add_f32 v[218:219], v[234:235], v[22:23]
    v_pk_add_f32 v[220:221], v[236:237], v[22:23]
    v_pk_add_f32 v[222:223], v[238:239], v[22:23]
    v_exp_f32 v96, v96
    v_exp_f32 v97, v97
    v_exp_f32 v98, v98
    v_exp_f32 v99, v99
    v_exp_f32 v100, v100
    v_exp_f32 v101, v101
    v_exp_f32 v102, v102
    v_exp_f32 v103, v103
    v_cvt_pk_bf16_f32 v184, v96, v97
    v_cvt_pk_bf16_f32 v185, v98, v99
    v_cvt_pk_bf16_f32 v186, v100, v101
    v_cvt_pk_bf16_f32 v187, v102, v103
    v_exp_f32 v104, v104
    v_exp_f32 v105, v105
    s_waitcnt lgkmcnt(2)
    v_mfma_f32_32x32x16_bf16 v[80:95], v[168:171], v[184:187], 0
    v_exp_f32 v106, v106
    v_exp_f32 v107, v107
    v_exp_f32 v108, v108
    v_exp_f32 v109, v109
    v_exp_f32 v110, v110
    v_exp_f32 v111, v111
    v_cvt_pk_bf16_f32 v188, v104, v105
    v_cvt_pk_bf16_f32 v189, v106, v107
    v_cvt_pk_bf16_f32 v190, v108, v109
    v_cvt_pk_bf16_f32 v191, v110, v111
    v_mfma_f32_32x32x16_bf16 v[96:111], v[132:135], v[164:167], v[48:63]
    v_mad_u32_u24 v6, v28, 1, v29
    v_mfma_f32_32x32x16_bf16 v[80:95], v[172:175], v[188:191], v[80:95]
    ds_read_b128 v[168:171], v6
    ds_read_b128 v[172:175], v6 offset:512
    v_exp_f32 v112, v112
    v_exp_f32 v113, v113
    v_exp_f32 v114, v114
    v_exp_f32 v115, v115
    v_exp_f32 v116, v116
    v_exp_f32 v117, v117
    v_exp_f32 v118, v118
    v_exp_f32 v119, v119
    v_cvt_pk_bf16_f32 v184, v112, v113
    v_cvt_pk_bf16_f32 v185, v114, v115
    v_cvt_pk_bf16_f32 v186, v116, v117
    v_cvt_pk_bf16_f32 v187, v118, v119
    v_exp_f32 v120, v120
    v_exp_f32 v121, v121
    s_waitcnt lgkmcnt(2)
    v_mfma_f32_32x32x16_bf16 v[64:79], v[176:179], v[184:187], 0
    v_exp_f32 v122, v122
    v_exp_f32 v123, v123
    v_exp_f32 v124, v124
    v_exp_f32 v125, v125
    v_exp_f32 v126, v126
    v_exp_f32 v127, v127
    v_cvt_pk_bf16_f32 v188, v120, v121
    v_cvt_pk_bf16_f32 v189, v122, v123
    v_cvt_pk_bf16_f32 v190, v124, v125
    v_cvt_pk_bf16_f32 v191, v126, v127
    v_mfma_f32_32x32x16_bf16 v[112:127], v[132:135], v[160:163], v[192:207]
    v_mad_u32_u24 v6, v28, 1, v29
    v_mfma_f32_32x32x16_bf16 v[64:79], v[180:183], v[188:191], v[64:79]
    ds_read_b128 v[176:179], v6
    ds_read_b128 v[180:183], v6 offset:512
    v_exp_f32 v96, v96
    v_exp_f32 v97, v97
    v_exp_f32 v98, v98
    v_exp_f32 v99, v99
    v_exp_f32 v100, v100
    v_exp_f32 v101, v101
    v_exp_f32 v102, v102
    v_exp_f32 v103, v103
    v_cvt_pk_bf16_f32 v184, v96, v97
    v_cvt_pk_bf16_f32 v185, v98, v99
    v_cvt_pk_bf16_f32 v186, v100, v101
    v_cvt_pk_bf16_f32 v187, v102, v103
    v_exp_f32 v104, v104
    v_exp_f32 v105, v105
    s_waitcnt lgkmcnt(2)
    v_mfma_f32_32x32x16_bf16 v[80:95], v[168:171], v[184:187], v[80:95]
    v_exp_f32 v106, v106
    v_exp_f32 v107, v107
    v_exp_f32 v108, v108
    v_exp_f32 v109, v109
    v_exp_f32 v110, v110
    v_exp_f32 v111, v111
    v_cvt_pk_bf16_f32 v188, v104, v105
    v_cvt_pk_bf16_f32 v189, v106, v107
    v_cvt_pk_bf16_f32 v190, v108, v109
    v_cvt_pk_bf16_f32 v191, v110, v111
    v_mfma_f32_32x32x16_bf16 v[96:111], v[136:139], v[164:167], v[48:63]
    v_mad_u32_u24 v6, v28, 2, v29
    v_mfma_f32_32x32x16_bf16 v[80:95], v[172:175], v[188:191], v[80:95]
    ds_read_b128 v[168:171], v6
    ds_read_b128 v[172:175], v6 offset:512
    v_exp_f32 v112, v112
    v_exp_f32 v113, v113
    v_exp_f32 v114, v114
    v_exp_f32 v115, v115
    v_exp_f32 v116, v116
    v_exp_f32 v117, v117
    v_exp_f32 v118, v118
    v_exp_f32 v119, v119
    v_cvt_pk_bf16_f32 v184, v112, v113
    v_cvt_pk_bf16_f32 v185, v114, v115
    v_cvt_pk_bf16_f32 v186, v116, v117
    v_cvt_pk_bf16_f32 v187, v118, v119
    v_exp_f32 v120, v120
    v_exp_f32 v121, v121
    s_waitcnt lgkmcnt(2)
    v_mfma_f32_32x32x16_bf16 v[64:79], v[176:179], v[184:187], v[64:79]
    v_exp_f32 v122, v122
    v_exp_f32 v123, v123
    v_exp_f32 v124, v124
    v_exp_f32 v125, v125
    v_exp_f32 v126, v126
    v_exp_f32 v127, v127
    v_cvt_pk_bf16_f32 v188, v120, v121
    v_cvt_pk_bf16_f32 v189, v122, v123
    v_cvt_pk_bf16_f32 v190, v124, v125
    v_cvt_pk_bf16_f32 v191, v126, v127
    v_mfma_f32_32x32x16_bf16 v[112:127], v[140:143], v[164:167], v[48:63]
    v_mad_u32_u24 v6, v28, 3, v29
    v_mfma_f32_32x32x16_bf16 v[64:79], v[180:183], v[188:191], v[64:79]
    ds_read_b128 v[176:179], v6
    ds_read_b128 v[180:183], v6 offset:512
    v_exp_f32 v96, v96
    v_exp_f32 v97, v97
    v_exp_f32 v98, v98
    v_exp_f32 v99, v99
    v_exp_f32 v100, v100
    v_exp_f32 v101, v101
    v_exp_f32 v102, v102
    v_exp_f32 v103, v103
    v_cvt_pk_bf16_f32 v184, v96, v97
    v_cvt_pk_bf16_f32 v185, v98, v99
    v_cvt_pk_bf16_f32 v186, v100, v101
    v_cvt_pk_bf16_f32 v187, v102, v103
    v_exp_f32 v104, v104
    v_exp_f32 v105, v105
    s_waitcnt lgkmcnt(2)
    v_mfma_f32_32x32x16_bf16 v[80:95], v[168:171], v[184:187], v[80:95]
    v_exp_f32 v106, v106
    v_exp_f32 v107, v107
    v_exp_f32 v108, v108
    v_exp_f32 v109, v109
    v_exp_f32 v110, v110
    v_exp_f32 v111, v111
    v_cvt_pk_bf16_f32 v188, v104, v105
    v_cvt_pk_bf16_f32 v189, v106, v107
    v_cvt_pk_bf16_f32 v190, v108, v109
    v_cvt_pk_bf16_f32 v191, v110, v111
    v_mfma_f32_32x32x16_bf16 v[96:111], v[144:147], v[164:167], v[48:63]
    v_mad_u32_u24 v6, v28, 4, v29
    v_mfma_f32_32x32x16_bf16 v[80:95], v[172:175], v[188:191], v[80:95]
    ds_read_b128 v[168:171], v6
    ds_read_b128 v[172:175], v6 offset:512
    v_exp_f32 v112, v112
    v_exp_f32 v113, v113
    v_exp_f32 v114, v114
    v_exp_f32 v115, v115
    v_exp_f32 v116, v116
    v_exp_f32 v117, v117
    v_exp_f32 v118, v118
    v_exp_f32 v119, v119
    v_cvt_pk_bf16_f32 v184, v112, v113
    v_cvt_pk_bf16_f32 v185, v114, v115
    v_cvt_pk_bf16_f32 v186, v116, v117
    v_cvt_pk_bf16_f32 v187, v118, v119
    v_exp_f32 v120, v120
    v_exp_f32 v121, v121
    s_waitcnt lgkmcnt(2)
    v_mfma_f32_32x32x16_bf16 v[80:95], v[176:179], v[184:187], v[80:95]
    v_exp_f32 v122, v122
    v_exp_f32 v123, v123
    v_exp_f32 v124, v124
    v_exp_f32 v125, v125
    v_exp_f32 v126, v126
    v_exp_f32 v127, v127
    v_cvt_pk_bf16_f32 v188, v120, v121
    v_cvt_pk_bf16_f32 v189, v122, v123
    v_cvt_pk_bf16_f32 v190, v124, v125
    v_cvt_pk_bf16_f32 v191, v126, v127
    v_mfma_f32_32x32x16_bf16 v[112:127], v[148:151], v[164:167], v[48:63]
    v_mad_u32_u24 v6, v28, 5, v29
    v_mfma_f32_32x32x16_bf16 v[80:95], v[180:183], v[188:191], v[80:95]
    ds_read_b128 v[176:179], v6
    ds_read_b128 v[180:183], v6 offset:512
    v_exp_f32 v96, v96
    v_exp_f32 v97, v97
    v_exp_f32 v98, v98
    v_exp_f32 v99, v99
    v_exp_f32 v100, v100
    v_exp_f32 v101, v101
    v_exp_f32 v102, v102
    v_exp_f32 v103, v103
    v_cvt_pk_bf16_f32 v184, v96, v97
    v_cvt_pk_bf16_f32 v185, v98, v99
    v_cvt_pk_bf16_f32 v186, v100, v101
    v_cvt_pk_bf16_f32 v187, v102, v103
    v_exp_f32 v104, v104
    v_exp_f32 v105, v105
    s_waitcnt lgkmcnt(2)
    v_mfma_f32_32x32x16_bf16 v[80:95], v[168:171], v[184:187], v[80:95]
    v_exp_f32 v106, v106
    v_exp_f32 v107, v107
    v_exp_f32 v108, v108
    v_exp_f32 v109, v109
    v_exp_f32 v110, v110
    v_exp_f32 v111, v111
    v_cvt_pk_bf16_f32 v188, v104, v105
    v_cvt_pk_bf16_f32 v189, v106, v107
    v_cvt_pk_bf16_f32 v190, v108, v109
    v_cvt_pk_bf16_f32 v191, v110, v111
    v_mfma_f32_32x32x16_bf16 v[96:111], v[152:155], v[164:167], v[208:223]
    v_mad_u32_u24 v6, v28, 6, v29
    v_mfma_f32_32x32x16_bf16 v[80:95], v[172:175], v[188:191], v[80:95]
    ds_read_b128 v[168:171], v6
    ds_read_b128 v[172:175], v6 offset:512
    v_exp_f32 v112, v112
    v_exp_f32 v113, v113
    v_exp_f32 v114, v114
    v_exp_f32 v115, v115
    v_exp_f32 v116, v116
    v_exp_f32 v117, v117
    v_exp_f32 v118, v118
    v_exp_f32 v119, v119
    v_cvt_pk_bf16_f32 v184, v112, v113
    v_cvt_pk_bf16_f32 v185, v114, v115
    v_cvt_pk_bf16_f32 v186, v116, v117
    v_cvt_pk_bf16_f32 v187, v118, v119
    v_exp_f32 v120, v120
    v_exp_f32 v121, v121
    s_waitcnt lgkmcnt(2)
    v_mfma_f32_32x32x16_bf16 v[80:95], v[176:179], v[184:187], v[80:95]
    v_exp_f32 v122, v122
    v_exp_f32 v123, v123
    v_exp_f32 v124, v124
    v_exp_f32 v125, v125
    v_exp_f32 v126, v126
    v_exp_f32 v127, v127
    v_cvt_pk_bf16_f32 v188, v120, v121
    v_cvt_pk_bf16_f32 v189, v122, v123
    v_cvt_pk_bf16_f32 v190, v124, v125
    v_cvt_pk_bf16_f32 v191, v126, v127
    s_nop 1
    v_mfma_f32_32x32x16_bf16 v[80:95], v[180:183], v[188:191], v[80:95]
    v_exp_f32 v96, v96
    v_exp_f32 v97, v97
    v_exp_f32 v98, v98
    v_exp_f32 v99, v99
    v_exp_f32 v100, v100
    v_exp_f32 v101, v101
    v_exp_f32 v102, v102
    v_exp_f32 v103, v103
    v_cvt_pk_bf16_f32 v184, v96, v97
    v_cvt_pk_bf16_f32 v185, v98, v99
    v_cvt_pk_bf16_f32 v186, v100, v101
    v_cvt_pk_bf16_f32 v187, v102, v103
    v_exp_f32 v104, v104
    v_exp_f32 v105, v105
    s_waitcnt lgkmcnt(0)
    v_mfma_f32_32x32x16_bf16 v[80:95], v[168:171], v[184:187], v[80:95]
    v_exp_f32 v106, v106
    v_exp_f32 v107, v107
    v_exp_f32 v108, v108
    v_exp_f32 v109, v109
    v_exp_f32 v110, v110
    v_exp_f32 v111, v111
    v_cvt_pk_bf16_f32 v188, v104, v105
    v_cvt_pk_bf16_f32 v189, v106, v107
    v_cvt_pk_bf16_f32 v190, v108, v109
    v_cvt_pk_bf16_f32 v191, v110, v111
    s_nop 1
    v_mfma_f32_32x32x16_bf16 v[80:95], v[172:175], v[188:191], v[80:95]
    s_branch L_attd_25
L_att2_23:
    ds_read_b128 v[128:131], v4 offset:0
    ds_read_b128 v[132:135], v4 offset:2048
    ds_read_b128 v[136:139], v4 offset:4096
    ds_read_b128 v[140:143], v4 offset:6144
    ds_read_b128 v[144:147], v4 offset:8192
    ds_read_b128 v[148:151], v4 offset:10240
    s_waitcnt lgkmcnt(5)
    v_mfma_f32_32x32x16_bf16 v[96:111], v[128:131], v[164:167], 0
    v_mfma_f32_32x32x16_bf16 v[112:127], v[128:131], v[160:163], 0
    v_mad_u32_u24 v6, v28, 0, v29
    ds_read_b128 v[168:171], v6
    ds_read_b128 v[172:175], v6 offset:512
    v_mad_u32_u24 v6, v28, 0, v29
    ds_read_b128 v[176:179], v6
    ds_read_b128 v[180:183], v6 offset:512
    s_waitcnt lgkmcnt(8)
    v_mfma_f32_32x32x16_bf16 v[192:207], v[132:135], v[164:167], 0
    s_nop 2
    v_max3_f32 v22, v96, v97, v98
    v_max3_f32 v23, v99, v100, v101
    v_max3_f32 v22, v22, v102, v103
    v_max3_f32 v23, v23, v104, v105
    v_max3_f32 v22, v22, v106, v107
    v_max3_f32 v23, v23, v108, v109
    v_max3_f32 v22, v22, v110, v111
    v_mfma_f32_32x32x16_bf16 v[96:111], v[132:135], v[160:163], 0
    v_max3_f32 v20, v112, v113, v114
    v_max3_f32 v21, v115, v116, v117
    v_max3_f32 v20, v20, v118, v119
    v_max3_f32 v21, v21, v120, v121
    v_max3_f32 v20, v20, v122, v123
    v_max3_f32 v21, v21, v124, v125
    v_max3_f32 v20, v20, v126, v127
    s_waitcnt lgkmcnt(7)
    v_mfma_f32_32x32x16_bf16 v[112:127], v[136:139], v[164:167], 0
    v_max3_f32 v22, v22, v192, v193
    v_max3_f32 v23, v23, v194, v195
    v_max3_f32 v22, v22, v196, v197
    v_max3_f32 v23, v23, v198, v199
    v_max3_f32 v22, v22, v200, v201
    v_max3_f32 v23, v23, v202, v203
    v_max3_f32 v22, v22, v204, v205
    v_max3_f32 v23, v23, v206, v207
    v_mfma_f32_32x32x16_bf16 v[192:207], v[136:139], v[160:163], v[224:239]
    v_max3_f32 v20, v20, v96, v97
    v_max3_f32 v21, v21, v98, v99
    v_max3_f32 v20, v20, v100, v101
    v_max3_f32 v21, v21, v102, v103
    v_max3_f32 v20, v20, v104, v105
    v_max3_f32 v21, v21, v106, v107
    v_max3_f32 v20, v20, v108, v109
    v_max3_f32 v21, v21, v110, v111
    s_waitcnt lgkmcnt(6)
    v_mfma_f32_32x32x16_bf16 v[96:111], v[140:143], v[164:167], 0
    v_max3_f32 v22, v22, v112, v113
    v_max3_f32 v23, v23, v114, v115
    v_max3_f32 v22, v22, v116, v117
    v_max3_f32 v23, v23, v118, v119
    v_max3_f32 v22, v22, v120, v121
    v_max3_f32 v23, v23, v122, v123
    v_max3_f32 v22, v22, v124, v125
    v_max3_f32 v23, v23, v126, v127
    s_waitcnt lgkmcnt(5)
    v_mfma_f32_32x32x16_bf16 v[112:127], v[144:147], v[164:167], 0
    v_max3_f32 v20, v20, v192, v193
    v_max3_f32 v21, v21, v194, v195
    v_max3_f32 v20, v20, v196, v197
    v_max3_f32 v21, v21, v198, v199
    v_max3_f32 v20, v20, v200, v201
    v_max3_f32 v21, v21, v202, v203
    v_max3_f32 v20, v20, v204, v205
    v_max3_f32 v21, v21, v206, v207
    s_waitcnt lgkmcnt(4)
    v_mfma_f32_32x32x16_bf16 v[192:207], v[148:151], v[164:167], v[224:239]
    v_max3_f32 v22, v22, v96, v97
    v_max3_f32 v23, v23, v98, v99
    v_max3_f32 v22, v22, v100, v101
    v_max3_f32 v23, v23, v102, v103
    v_max3_f32 v22, v22, v104, v105
    v_max3_f32 v23, v23, v106, v107
    v_max3_f32 v22, v22, v108, v109
    v_max3_f32 v23, v23, v110, v111
    v_max3_f32 v22, v22, v112, v113
    v_max3_f32 v23, v23, v114, v115
    v_max3_f32 v22, v22, v116, v117
    v_max3_f32 v23, v23, v118, v119
    v_max3_f32 v22, v22, v120, v121
    v_max3_f32 v23, v23, v122, v123
    v_max3_f32 v22, v22, v124, v125
    v_max3_f32 v23, v23, v126, v127
    v_max3_f32 v22, v22, v192, v193
    v_max3_f32 v23, v23, v194, v195
    v_max3_f32 v22, v22, v196, v197
    v_max3_f32 v23, v23, v198, v199
    v_max3_f32 v22, v22, v200, v201
    v_max3_f32 v23, v23, v202, v203
    v_max3_f32 v22, v22, v204, v205
    v_max3_f32 v23, v23, v206, v207
    v_max_f32 v20, v20, v21
    v_max_f32 v22, v22, v23
    v_mov_b32 v21, v20
    v_mov_b32 v23, v22
    s_nop 0
    v_permlane32_swap_b32 v20, v21
    v_permlane32_swap_b32 v22, v23
    v_max_f32 v12, v20, v21
    v_max_f32 v14, v22, v23
    v_sub_f32 v20, 0, v12
    v_sub_f32 v22, 0, v14
    v_mov_b32 v21, v20
    v_mov_b32 v23, v22
    v_pk_mov_b32 v[48:49], v[22:23], v[22:23] op_sel:[0,0]
    v_pk_mov_b32 v[50:51], v[22:23], v[22:23] op_sel:[0,0]
    v_pk_mov_b32 v[52:53], v[22:23], v[22:23] op_sel:[0,0]
    v_pk_mov_b32 v[54:55], v[22:23], v[22:23] op_sel:[0,0]
    v_pk_mov_b32 v[56:57], v[22:23], v[22:23] op_sel:[0,0]
    v_pk_mov_b32 v[58:59], v[22:23], v[22:23] op_sel:[0,0]
    v_pk_mov_b32 v[60:61], v[22:23], v[22:23] op_sel:[0,0]
    v_pk_mov_b32 v[62:63], v[22:23], v[22:23] op_sel:[0,0]
    v_pk_mov_b32 v[32:33], v[20:21], v[20:21] op_sel:[0,0]
    v_pk_mov_b32 v[34:35], v[20:21], v[20:21] op_sel:[0,0]
    v_pk_mov_b32 v[36:37], v[20:21], v[20:21] op_sel:[0,0]
    v_pk_mov_b32 v[38:39], v[20:21], v[20:21] op_sel:[0,0]
    v_pk_mov_b32 v[40:41], v[20:21], v[20:21] op_sel:[0,0]
    v_pk_mov_b32 v[42:43], v[20:21], v[20:21] op_sel:[0,0]
    v_pk_mov_b32 v[44:45], v[20:21], v[20:21] op_sel:[0,0]
    v_pk_mov_b32 v[46:47], v[20:21], v[20:21] op_sel:[0,0]
    v_mfma_f32_32x32x16_bf16 v[96:111], v[128:131], v[164:167], v[48:63]
    s_nop 0
    v_mfma_f32_32x32x16_bf16 v[112:127], v[128:131], v[160:163], v[32:47]
    v_pk_add_f32 v[192:193], v[224:225], v[20:21]
    v_pk_add_f32 v[194:195], v[226:227], v[20:21]
    v_pk_add_f32 v[196:197], v[228:229], v[20:21]
    v_pk_add_f32 v[198:199], v[230:231], v[20:21]
    v_pk_add_f32 v[200:201], v[232:233], v[20:21]
    v_pk_add_f32 v[202:203], v[234:235], v[20:21]
    v_pk_add_f32 v[204:205], v[236:237], v[20:21]
    v_pk_add_f32 v[206:207], v[238:239], v[20:21]
    v_pk_add_f32 v[208:209], v[224:225], v[22:23]
    v_pk_add_f32 v[210:211], v[226:227], v[22:23]
    v_pk_add_f32 v[212:213], v[228:229], v[22:23]
    v_pk_add_f32 v[214:215], v[230:231], v[22:23]
    v_pk_add_f32 v[216:217], v[232:233], v[22:23]
    v_pk_add_f32 v[218:219], v[234:235], v[22:23]
    v_pk_add_f32 v[220:221], v[236:237], v[22:23]
    v_pk_add_f32 v[222:223], v[238:239], v[22:23]
    v_exp_f32 v96, v96
    v_exp_f32 v97, v97
    v_exp_f32 v98, v98
    v_exp_f32 v99, v99
    v_exp_f32 v100, v100
    v_exp_f32 v101, v101
    v_exp_f32 v102, v102
    v_exp_f32 v103, v103
    v_cvt_pk_bf16_f32 v184, v96, v97
    v_cvt_pk_bf16_f32 v185, v98, v99
    v_cvt_pk_bf16_f32 v186, v100, v101
    v_cvt_pk_bf16_f32 v187, v102, v103
    v_exp_f32 v104, v104
    v_exp_f32 v105, v105
    s_waitcnt lgkmcnt(2)
    v_mfma_f32_32x32x16_bf16 v[80:95], v[168:171], v[184:187], 0
    v_exp_f32 v106, v106
    v_exp_f32 v107, v107
    v_exp_f32 v108, v108
    v_exp_f32 v109, v109
    v_exp_f32 v110, v110
    v_exp_f32 v111, v111
    v_cvt_pk_bf16_f32 v188, v104, v105
    v_cvt_pk_bf16_f32 v189, v106, v107
    v_cvt_pk_bf16_f32 v190, v108, v109
    v_cvt_pk_bf16_f32 v191, v110, v111
    v_mfma_f32_32x32x16_bf16 v[96:111], v[132:135], v[164:167], v[48:63]
    v_mad_u32_u24 v6, v28, 1, v29
    v_mfma_f32_32x32x16_bf16 v[80:95], v[172:175], v[188:191], v[80:95]
    ds_read_b128 v[168:171], v6
    ds_read_b128 v[172:175], v6 offset:512
    v_exp_f32 v112, v112
    v_exp_f32 v113, v113
    v_exp_f32 v114, v114
    v_exp_f32 v115, v115
    v_exp_f32 v116, v116
    v_exp_f32 v117, v117
    v_exp_f32 v118, v118
    v_exp_f32 v119, v119
    v_cvt_pk_bf16_f32 v184, v112, v113
    v_cvt_pk_bf16_f32 v185, v114, v115
    v_cvt_pk_bf16_f32 v186, v116, v117
    v_cvt_pk_bf16_f32 v187, v118, v119
    v_exp_f32 v120, v120
    v_exp_f32 v121, v121
    s_waitcnt lgkmcnt(2)
    v_mfma_f32_32x32x16_bf16 v[64:79], v[176:179], v[184:187], 0
    v_exp_f32 v122, v122
    v_exp_f32 v123, v123
    v_exp_f32 v124, v124
    v_exp_f32 v125, v125
    v_exp_f32 v126, v126
    v_exp_f32 v127, v127
    v_cvt_pk_bf16_f32 v188, v120, v121
    v_cvt_pk_bf16_f32 v189, v122, v123
    v_cvt_pk_bf16_f32 v190, v124, v125
    v_cvt_pk_bf16_f32 v191, v126, v127
    v_mfma_f32_32x32x16_bf16 v[112:127], v[132:135], v[160:163], v[32:47]
    v_mad_u32_u24 v6, v28, 1, v29
    v_mfma_f32_32x32x16_bf16 v[64:79], v[180:183], v[188:191], v[64:79]
    ds_read_b128 v[176:179], v6
    ds_read_b128 v[180:183], v6 offset:512
    v_exp_f32 v96, v96
    v_exp_f32 v97, v97
    v_exp_f32 v98, v98
    v_exp_f32 v99, v99
    v_exp_f32 v100, v100
    v_exp_f32 v101, v101
    v_exp_f32 v102, v102
    v_exp_f32 v103, v103
    v_cvt_pk_bf16_f32 v184, v96, v97
    v_cvt_pk_bf16_f32 v185, v98, v99
    v_cvt_pk_bf16_f32 v186, v100, v101
    v_cvt_pk_bf16_f32 v187, v102, v103
    v_exp_f32 v104, v104
    v_exp_f32 v105, v105
    s_waitcnt lgkmcnt(2)
    v_mfma_f32_32x32x16_bf16 v[80:95], v[168:171], v[184:187], v[80:95]
    v_exp_f32 v106, v106
    v_exp_f32 v107, v107
    v_exp_f32 v108, v108
    v_exp_f32 v109, v109
    v_exp_f32 v110, v110
    v_exp_f32 v111, v111
    v_cvt_pk_bf16_f32 v188, v104, v105
    v_cvt_pk_bf16_f32 v189, v106, v107
    v_cvt_pk_bf16_f32 v190, v108, v109
    v_cvt_pk_bf16_f32 v191, v110, v111
    v_mfma_f32_32x32x16_bf16 v[96:111], v[136:139], v[164:167], v[48:63]
    v_mad_u32_u24 v6, v28, 2, v29
    v_mfma_f32_32x32x16_bf16 v[80:95], v[172:175], v[188:191], v[80:95]
    ds_read_b128 v[168:171], v6
    ds_read_b128 v[172:175], v6 offset:512
    v_exp_f32 v112, v112
    v_exp_f32 v113, v113
    v_exp_f32 v114, v114
    v_exp_f32 v115, v115
    v_exp_f32 v116, v116
    v_exp_f32 v117, v117
    v_exp_f32 v118, v118
    v_exp_f32 v119, v119
    v_cvt_pk_bf16_f32 v184, v112, v113
    v_cvt_pk_bf16_f32 v185, v114, v115
    v_cvt_pk_bf16_f32 v186, v116, v117
    v_cvt_pk_bf16_f32 v187, v118, v119
    v_exp_f32 v120, v120
    v_exp_f32 v121, v121
    s_waitcnt lgkmcnt(2)
    v_mfma_f32_32x32x16_bf16 v[64:79], v[176:179], v[184:187], v[64:79]
    v_exp_f32 v122, v122
    v_exp_f32 v123, v123
    v_exp_f32 v124, v124
    v_exp_f32 v125, v125
    v_exp_f32 v126, v126
    v_exp_f32 v127, v127
    v_cvt_pk_bf16_f32 v188, v120, v121
    v_cvt_pk_bf16_f32 v189, v122, v123
    v_cvt_pk_bf16_f32 v190, v124, v125
    v_cvt_pk_bf16_f32 v191, v126, v127
    v_mfma_f32_32x32x16_bf16 v[112:127], v[136:139], v[160:163], v[192:207]
    v_mad_u32_u24 v6, v28, 2, v29
    v_mfma_f32_32x32x16_bf16 v[64:79], v[180:183], v[188:191], v[64:79]
    ds_read_b128 v[176:179], v6
    ds_read_b128 v[180:183], v6 offset:512
    v_exp_f32 v96, v96
    v_exp_f32 v97, v97
    v_exp_f32 v98, v98
    v_exp_f32 v99, v99
    v_exp_f32 v100, v100
    v_exp_f32 v101, v101
    v_exp_f32 v102, v102
    v_exp_f32 v103, v103
    v_cvt_pk_bf16_f32 v184, v96, v97
    v_cvt_pk_bf16_f32 v185, v98, v99
    v_cvt_pk_bf16_f32 v186, v100, v101
    v_cvt_pk_bf16_f32 v187, v102, v103
    v_exp_f32 v104, v104
    v_exp_f32 v105, v105
    s_waitcnt lgkmcnt(2)
    v_mfma_f32_32x32x16_bf16 v[80:95], v[168:171], v[184:187], v[80:95]
    v_exp_f32 v106, v106
    v_exp_f32 v107, v107
    v_exp_f32 v108, v108
    v_exp_f32 v109, v109
    v_exp_f32 v110, v110
    v_exp_f32 v111, v111
    v_cvt_pk_bf16_f32 v188, v104, v105
    v_cvt_pk_bf16_f32 v189, v106, v107
    v_cvt_pk_bf16_f32 v190, v108, v109
    v_cvt_pk_bf16_f32 v191, v110, v111
    v_mfma_f32_32x32x16_bf16 v[96:111], v[140:143], v[164:167], v[48:63]
    v_mad_u32_u24 v6, v28, 3, v29
    v_mfma_f32_32x32x16_bf16 v[80:95], v[172:175], v[188:191], v[80:95]
    ds_read_b128 v[168:171], v6
    ds_read_b128 v[172:175], v6 offset:512
    v_exp_f32 v112, v112
    v_exp_f32 v113, v113
    v_exp_f32 v114, v114
    v_exp_f32 v115, v115
    v_exp_f32 v116, v116
    v_exp_f32 v117, v117
    v_exp_f32 v118, v118
    v_exp_f32 v119, v119
    v_cvt_pk_bf16_f32 v184, v112, v113
    v_cvt_pk_bf16_f32 v185, v114, v115
    v_cvt_pk_bf16_f32 v186, v116, v117
    v_cvt_pk_bf16_f32 v187, v118, v119
    v_exp_f32 v120, v120
    v_exp_f32 v121, v121
    s_waitcnt lgkmcnt(2)
    v_mfma_f32_32x32x16_bf16 v[64:79], v[176:179], v[184:187], v[64:79]
    v_exp_f32 v122, v122
    v_exp_f32 v123, v123
    v_exp_f32 v124, v124
    v_exp_f32 v125, v125
    v_exp_f32 v126, v126
    v_exp_f32 v127, v127
    v_cvt_pk_bf16_f32 v188, v120, v121
    v_cvt_pk_bf16_f32 v189, v122, v123
    v_cvt_pk_bf16_f32 v190, v124, v125
    v_cvt_pk_bf16_f32 v191, v126, v127
    v_mfma_f32_32x32x16_bf16 v[112:127], v[144:147], v[164:167], v[48:63]
    v_mad_u32_u24 v6, v28, 4, v29
    v_mfma_f32_32x32x16_bf16 v[64:79], v[180:183], v[188:191], v[64:79]
    ds_read_b128 v[176:179], v6
    ds_read_b128 v[180:183], v6 offset:512
    v_exp_f32 v96, v96
    v_exp_f32 v97, v97
    v_exp_f32 v98, v98
    v_exp_f32 v99, v99
    v_exp_f32 v100, v100
    v_exp_f32 v101, v101
    v_exp_f32 v102, v102
    v_exp_f32 v103, v103
    v_cvt_pk_bf16_f32 v184, v96, v97
    v_cvt_pk_bf16_f32 v185, v98, v99
    v_cvt_pk_bf16_f32 v186, v100, v101
    v_cvt_pk_bf16_f32 v187, v102, v103
    v_exp_f32 v104, v104
    v_exp_f32 v105, v105
    s_waitcnt lgkmcnt(2)
    v_mfma_f32_32x32x16_bf16 v[80:95], v[168:171], v[184:187], v[80:95]
    v_exp_f32 v106, v106
    v_exp_f32 v107, v107
    v_exp_f32 v108, v108
    v_exp_f32 v109, v109
    v_exp_f32 v110, v110
    v_exp_f32 v111, v111
    v_cvt_pk_bf16_f32 v188, v104, v105
    v_cvt_pk_bf16_f32 v189, v106, v107
    v_cvt_pk_bf16_f32 v190, v108, v109
    v_cvt_pk_bf16_f32 v191, v110, v111
    v_mfma_f32_32x32x16_bf16 v[96:111], v[148:151], v[164:167], v[208:223]
    v_mad_u32_u24 v6, v28, 5, v29
    v_mfma_f32_32x32x16_bf16 v[80:95], v[172:175], v[188:191], v[80:95]
    ds_read_b128 v[168:171], v6
    ds_read_b128 v[172:175], v6 offset:512
    v_exp_f32 v112, v112
    v_exp_f32 v113, v113
    v_exp_f32 v114, v114
    v_exp_f32 v115, v115
    v_exp_f32 v116, v116
    v_exp_f32 v117, v117
    v_exp_f32 v118, v118
    v_exp_f32 v119, v119
    v_cvt_pk_bf16_f32 v184, v112, v113
    v_cvt_pk_bf16_f32 v185, v114, v115
    v_cvt_pk_bf16_f32 v186, v116, v117
    v_cvt_pk_bf16_f32 v187, v118, v119
    v_exp_f32 v120, v120
    v_exp_f32 v121, v121
    s_waitcnt lgkmcnt(2)
    v_mfma_f32_32x32x16_bf16 v[80:95], v[176:179], v[184:187], v[80:95]
    v_exp_f32 v122, v122
    v_exp_f32 v123, v123
    v_exp_f32 v124, v124
    v_exp_f32 v125, v125
    v_exp_f32 v126, v126
    v_exp_f32 v127, v127
    v_cvt_pk_bf16_f32 v188, v120, v121
    v_cvt_pk_bf16_f32 v189, v122, v123
    v_cvt_pk_bf16_f32 v190, v124, v125
    v_cvt_pk_bf16_f32 v191, v126, v127
    s_nop 1
    v_mfma_f32_32x32x16_bf16 v[80:95], v[180:183], v[188:191], v[80:95]
    v_exp_f32 v96, v96
    v_exp_f32 v97, v97
    v_exp_f32 v98, v98
    v_exp_f32 v99, v99
    v_exp_f32 v100, v100
    v_exp_f32 v101, v101
    v_exp_f32 v102, v102
    v_exp_f32 v103, v103
    v_cvt_pk_bf16_f32 v184, v96, v97
    v_cvt_pk_bf16_f32 v185, v98, v99
    v_cvt_pk_bf16_f32 v186, v100, v101
    v_cvt_pk_bf16_f32 v187, v102, v103
    v_exp_f32 v104, v104
    v_exp_f32 v105, v105
    s_waitcnt lgkmcnt(0)
    v_mfma_f32_32x32x16_bf16 v[80:95], v[168:171], v[184:187], v[80:95]
    v_exp_f32 v106, v106
    v_exp_f32 v107, v107
    v_exp_f32 v108, v108
    v_exp_f32 v109, v109
    v_exp_f32 v110, v110
    v_exp_f32 v111, v111
    v_cvt_pk_bf16_f32 v188, v104, v105
    v_cvt_pk_bf16_f32 v189, v106, v107
    v_cvt_pk_bf16_f32 v190, v108, v109
    v_cvt_pk_bf16_f32 v191, v110, v111
    s_nop 1
    v_mfma_f32_32x32x16_bf16 v[80:95], v[172:175], v[188:191], v[80:95]
    s_branch L_attd_25
L_att3_24:
    ds_read_b128 v[128:131], v4 offset:0
    ds_read_b128 v[132:135], v4 offset:2048
    ds_read_b128 v[136:139], v4 offset:4096
    ds_read_b128 v[140:143], v4 offset:6144
    ds_read_b128 v[144:147], v4 offset:8192
    s_waitcnt lgkmcnt(4)
    v_mfma_f32_32x32x16_bf16 v[96:111], v[128:131], v[164:167], 0
    v_mfma_f32_32x32x16_bf16 v[112:127], v[128:131], v[160:163], 0
    v_mad_u32_u24 v6, v28, 0, v29
    ds_read_b128 v[168:171], v6
    ds_read_b128 v[172:175], v6 offset:512
    v_mad_u32_u24 v6, v28, 0, v29
    ds_read_b128 v[176:179], v6
    ds_read_b128 v[180:183], v6 offset:512
    s_waitcnt lgkmcnt(7)
    v_mfma_f32_32x32x16_bf16 v[192:207], v[132:135], v[164:167], 0
    s_nop 2
    v_max3_f32 v22, v96, v97, v98
    v_max3_f32 v23, v99, v100, v101
    v_max3_f32 v22, v22, v102, v103
    v_max3_f32 v23, v23, v104, v105
    v_max3_f32 v22, v22, v106, v107
    v_max3_f32 v23, v23, v108, v109
    v_max3_f32 v22, v22, v110, v111
    v_mfma_f32_32x32x16_bf16 v[96:111], v[132:135], v[160:163], 0
    v_max3_f32 v20, v112, v113, v114
    v_max3_f32 v21, v115, v116, v117
    v_max3_f32 v20, v20, v118, v119
    v_max3_f32 v21, v21, v120, v121
    v_max3_f32 v20, v20, v122, v123
    v_max3_f32 v21, v21, v124, v125
    v_max3_f32 v20, v20, v126, v127
    s_waitcnt lgkmcnt(6)
    v_mfma_f32_32x32x16_bf16 v[112:127], v[136:139], v[164:167], 0
    v_max3_f32 v22, v22, v192, v193
    v_max3_f32 v23, v23, v194, v195
    v_max3_f32 v22, v22, v196, v197
    v_max3_f32 v23, v23, v198, v199
    v_max3_f32 v22, v22, v200, v201
    v_max3_f32 v23, v23, v202, v203
    v_max3_f32 v22, v22, v204, v205
    v_max3_f32 v23, v23, v206, v207
    v_mfma_f32_32x32x16_bf16 v[192:207], v[136:139], v[160:163], 0
    v_max3_f32 v20, v20, v96, v97
    v_max3_f32 v21, v21, v98, v99
    v_max3_f32 v20, v20, v100, v101
    v_max3_f32 v21, v21, v102, v103
    v_max3_f32 v20, v20, v104, v105
    v_max3_f32 v21, v21, v106, v107
    v_max3_f32 v20, v20, v108, v109
    v_max3_f32 v21, v21, v110, v111
    s_waitcnt lgkmcnt(5)
    v_mfma_f32_32x32x16_bf16 v[96:111], v[140:143], v[164:167], 0
    v_max3_f32 v22, v22, v112, v113
    v_max3_f32 v23, v23, v114, v115
    v_max3_f32 v22, v22, v116, v117
    v_max3_f32 v23, v23, v118, v119
    v_max3_f32 v22, v22, v120, v121
    v_max3_f32 v23, v23, v122, v123
    v_max3_f32 v22, v22, v124, v125
    v_max3_f32 v23, v23, v126, v127
    v_mfma_f32_32x32x16_bf16 v[112:127], v[140:143], v[160:163], v[224:239]
    v_max3_f32 v20, v20, v192, v193
    v_max3_f32 v21, v21, v194, v195
    v_max3_f32 v20, v20, v196, v197
    v_max3_f32 v21, v21, v198, v199
    v_max3_f32 v20, v20, v200, v201
    v_max3_f32 v21, v21, v202, v203
    v_max3_f32 v20, v20, v204, v205
    v_max3_f32 v21, v21, v206, v207
    s_waitcnt lgkmcnt(4)
    v_mfma_f32_32x32x16_bf16 v[192:207], v[144:147], v[164:167], v[224:239]
    v_max3_f32 v22, v22, v96, v97
    v_max3_f32 v23, v23, v98, v99
    v_max3_f32 v22, v22, v100, v101
    v_max3_f32 v23, v23, v102, v103
    v_max3_f32 v22, v22, v104, v105
    v_max3_f32 v23, v23, v106, v107
    v_max3_f32 v22, v22, v108, v109
    v_max3_f32 v23, v23, v110, v111
    v_max3_f32 v20, v20, v112, v113
    v_max3_f32 v21, v21, v114, v115
    v_max3_f32 v20, v20, v116, v117
    v_max3_f32 v21, v21, v118, v119
    v_max3_f32 v20, v20, v120, v121
    v_max3_f32 v21, v21, v122, v123
    v_max3_f32 v20, v20, v124, v125
    v_max3_f32 v21, v21, v126, v127
    v_max3_f32 v22, v22, v192, v193
    v_max3_f32 v23, v23, v194, v195
    v_max3_f32 v22, v22, v196, v197
    v_max3_f32 v23, v23, v198, v199
    v_max3_f32 v22, v22, v200, v201
    v_max3_f32 v23, v23, v202, v203
    v_max3_f32 v22, v22, v204, v205
    v_max3_f32 v23, v23, v206, v207
    v_max_f32 v20, v20, v21
    v_max_f32 v22, v22, v23
    v_mov_b32 v21, v20
    v_mov_b32 v23, v22
    s_nop 0
    v_permlane32_swap_b32 v20, v21
    v_permlane32_swap_b32 v22, v23
    v_max_f32 v12, v20, v21
    v_max_f32 v14, v22, v23
    v_sub_f32 v20, 0, v12
    v_sub_f32 v22, 0, v14
    v_mov_b32 v21, v20
    v_mov_b32 v23, v22
    v_pk_mov_b32 v[48:49], v[22:23], v[22:23] op_sel:[0,0]
    v_pk_mov_b32 v[50:51], v[22:23], v[22:23] op_sel:[0,0]
    v_pk_mov_b32 v[52:53], v[22:23], v[22:23] op_sel:[0,0]
    v_pk_mov_b32 v[54:55], v[22:23], v[22:23] op_sel:[0,0]
    v_pk_mov_b32 v[56:57], v[22:23], v[22:23] op_sel:[0,0]
    v_pk_mov_b32 v[58:59], v[22:23], v[22:23] op_sel:[0,0]
    v_pk_mov_b32 v[60:61], v[22:23], v[22:23] op_sel:[0,0]
    v_pk_mov_b32 v[62:63], v[22:23], v[22:23] op_sel:[0,0]
    v_pk_mov_b32 v[32:33], v[20:21], v[20:21] op_sel:[0,0]
    v_pk_mov_b32 v[34:35], v[20:21], v[20:21] op_sel:[0,0]
    v_pk_mov_b32 v[36:37], v[20:21], v[20:21] op_sel:[0,0]
    v_pk_mov_b32 v[38:39], v[20:21], v[20:21] op_sel:[0,0]
    v_pk_mov_b32 v[40:41], v[20:21], v[20:21] op_sel:[0,0]
    v_pk_mov_b32 v[42:43], v[20:21], v[20:21] op_sel:[0,0]
    v_pk_mov_b32 v[44:45], v[20:21], v[20:21] op_sel:[0,0]
    v_pk_mov_b32 v[46:47], v[20:21], v[20:21] op_sel:[0,0]
    v_mfma_f32_32x32x16_bf16 v[96:111], v[128:131], v[164:167], v[48:63]
    s_nop 0
    v_mfma_f32_32x32x16_bf16 v[112:127], v[128:131], v[160:163], v[32:47]
    v_pk_add_f32 v[192:193], v[224:225], v[20:21]
    v_pk_add_f32 v[194:195], v[226:227], v[20:21]
    v_pk_add_f32 v[196:197], v[228:229], v[20:21]
    v_pk_add_f32 v[198:199], v[230:231], v[20:21]
    v_pk_add_f32 v[200:201], v[232:233], v[20:21]
    v_pk_add_f32 v[202:203], v[234:235], v[20:21]
    v_pk_add_f32 v[204:205], v[236:237], v[20:21]
    v_pk_add_f32 v[206:207], v[238:239], v[20:21]
    v_pk_add_f32 v[208:209], v[224:225], v[22:23]
    v_pk_add_f32 v[210:211], v[226:227], v[22:23]
    v_pk_add_f32 v[212:213], v[228:229], v[22:23]
    v_pk_add_f32 v[214:215], v[230:231], v[22:23]
    v_pk_add_f32 v[216:217], v[232:233], v[22:23]
    v_pk_add_f32 v[218:219], v[234:235], v[22:23]
    v_pk_add_f32 v[220:221], v[236:237], v[22:23]
    v_pk_add_f32 v[222:223], v[238:239], v[22:23]
    v_exp_f32 v96, v96
    v_exp_f32 v97, v97
    v_exp_f32 v98, v98
    v_exp_f32 v99, v99
    v_exp_f32 v100, v100
    v_exp_f32 v101, v101
    v_exp_f32 v102, v102
    v_exp_f32 v103, v103
    v_cvt_pk_bf16_f32 v184, v96, v97
    v_cvt_pk_bf16_f32 v185, v98, v99
    v_cvt_pk_bf16_f32 v186, v100, v101
    v_cvt_pk_bf16_f32 v187, v102, v103
    v_exp_f32 v104, v104
    v_exp_f32 v105, v105
    s_waitcnt lgkmcnt(2)
    v_mfma_f32_32x32x16_bf16 v[80:95], v[168:171], v[184:187], 0
    v_exp_f32 v106, v106
    v_exp_f32 v107, v107
    v_exp_f32 v108, v108
    v_exp_f32 v109, v109
    v_exp_f32 v110, v110
    v_exp_f32 v111, v111
    v_cvt_pk_bf16_f32 v188, v104, v105
    v_cvt_pk_bf16_f32 v189, v106, v107
    v_cvt_pk_bf16_f32 v190, v108, v109
    v_cvt_pk_bf16_f32 v191, v110, v111
    v_mfma_f32_32x32x16_bf16 v[96:111], v[132:135], v[164:167], v[48:63]
    v_mad_u32_u24 v6, v28, 1, v29
    v_mfma_f32_32x32x16_bf16 v[80:95], v[172:175], v[188:191], v[80:95]
    ds_read_b128 v[168:171], v6
    ds_read_b128 v[172:175], v6 offset:512
    v_exp_f32 v112, v112
    v_exp_f32 v113, v113
    v_exp_f32 v114, v114
    v_exp_f32 v115, v115
    v_exp_f32 v116, v116
    v_exp_f32 v117, v117
    v_exp_f32 v118, v118
    v_exp_f32 v119, v119
    v_cvt_pk_bf16_f32 v184, v112, v113
    v_cvt_pk_bf16_f32 v185, v114, v115
    v_cvt_pk_bf16_f32 v186, v116, v117
    v_cvt_pk_bf16_f32 v187, v118, v119
    v_exp_f32 v120, v120
    v_exp_f32 v121, v121
    s_waitcnt lgkmcnt(2)
    v_mfma_f32_32x32x16_bf16 v[64:79], v[176:179], v[184:187], 0
    v_exp_f32 v122, v122
    v_exp_f32 v123, v123
    v_exp_f32 v124, v124
    v_exp_f32 v125, v125
    v_exp_f32 v126, v126
    v_exp_f32 v127, v127
    v_cvt_pk_bf16_f32 v188, v120, v121
    v_cvt_pk_bf16_f32 v189, v122, v123
    v_cvt_pk_bf16_f32 v190, v124, v125
    v_cvt_pk_bf16_f32 v191, v126, v127
    v_mfma_f32_32x32x16_bf16 v[112:127], v[132:135], v[160:163], v[32:47]
    v_mad_u32_u24 v6, v28, 1, v29
    v_mfma_f32_32x32x16_bf16 v[64:79], v[180:183], v[188:191], v[64:79]
    ds_read_b128 v[176:179], v6
    ds_read_b128 v[180:183], v6 offset:512
    v_exp_f32 v96, v96
    v_exp_f32 v97, v97
    v_exp_f32 v98, v98
    v_exp_f32 v99, v99
    v_exp_f32 v100, v100
    v_exp_f32 v101, v101
    v_exp_f32 v102, v102
    v_exp_f32 v103, v103
    v_cvt_pk_bf16_f32 v184, v96, v97
    v_cvt_pk_bf16_f32 v185, v98, v99
    v_cvt_pk_bf16_f32 v186, v100, v101
    v_cvt_pk_bf16_f32 v187, v102, v103
    v_exp_f32 v104, v104
    v_exp_f32 v105, v105
    s_waitcnt lgkmcnt(2)
    v_mfma_f32_32x32x16_bf16 v[80:95], v[168:171], v[184:187], v[80:95]
    v_exp_f32 v106, v106
    v_exp_f32 v107, v107
    v_exp_f32 v108, v108
    v_exp_f32 v109, v109
    v_exp_f32 v110, v110
    v_exp_f32 v111, v111
    v_cvt_pk_bf16_f32 v188, v104, v105
    v_cvt_pk_bf16_f32 v189, v106, v107
    v_cvt_pk_bf16_f32 v190, v108, v109
    v_cvt_pk_bf16_f32 v191, v110, v111
    v_mfma_f32_32x32x16_bf16 v[96:111], v[136:139], v[164:167], v[48:63]
    v_mad_u32_u24 v6, v28, 2, v29
    v_mfma_f32_32x32x16_bf16 v[80:95], v[172:175], v[188:191], v[80:95]
    ds_read_b128 v[168:171], v6
    ds_read_b128 v[172:175], v6 offset:512
    v_exp_f32 v112, v112
    v_exp_f32 v113, v113
    v_exp_f32 v114, v114
    v_exp_f32 v115, v115
    v_exp_f32 v116, v116
    v_exp_f32 v117, v117
    v_exp_f32 v118, v118
    v_exp_f32 v119, v119
    v_cvt_pk_bf16_f32 v184, v112, v113
    v_cvt_pk_bf16_f32 v185, v114, v115
    v_cvt_pk_bf16_f32 v186, v116, v117
    v_cvt_pk_bf16_f32 v187, v118, v119
    v_exp_f32 v120, v120
    v_exp_f32 v121, v121
    s_waitcnt lgkmcnt(2)
    v_mfma_f32_32x32x16_bf16 v[64:79], v[176:179], v[184:187], v[64:79]
    v_exp_f32 v122, v122
    v_exp_f32 v123, v123
    v_exp_f32 v124, v124
    v_exp_f32 v125, v125
    v_exp_f32 v126, v126
    v_exp_f32 v127, v127
    v_cvt_pk_bf16_f32 v188, v120, v121
    v_cvt_pk_bf16_f32 v189, v122, v123
    v_cvt_pk_bf16_f32 v190, v124, v125
    v_cvt_pk_bf16_f32 v191, v126, v127
    v_mfma_f32_32x32x16_bf16 v[112:127], v[136:139], v[160:163], v[32:47]
    v_mad_u32_u24 v6, v28, 2, v29
    v_mfma_f32_32x32x16_bf16 v[64:79], v[180:183], v[188:191], v[64:79]
    ds_read_b128 v[176:179], v6
    ds_read_b128 v[180:183], v6 offset:512
    v_exp_f32 v96, v96
    v_exp_f32 v97, v97
    v_exp_f32 v98, v98
    v_exp_f32 v99, v99
    v_exp_f32 v100, v100
    v_exp_f32 v101, v101
    v_exp_f32 v102, v102
    v_exp_f32 v103, v103
    v_cvt_pk_bf16_f32 v184, v96, v97
    v_cvt_pk_bf16_f32 v185, v98, v99
    v_cvt_pk_bf16_f32 v186, v100, v101
    v_cvt_pk_bf16_f32 v187, v102, v103
    v_exp_f32 v104, v104
    v_exp_f32 v105, v105
    s_waitcnt lgkmcnt(2)
    v_mfma_f32_32x32x16_bf16 v[80:95], v[168:171], v[184:187], v[80:95]
    v_exp_f32 v106, v106
    v_exp_f32 v107, v107
    v_exp_f32 v108, v108
    v_exp_f32 v109, v109
    v_exp_f32 v110, v110
    v_exp_f32 v111, v111
    v_cvt_pk_bf16_f32 v188, v104, v105
    v_cvt_pk_bf16_f32 v189, v106, v107
    v_cvt_pk_bf16_f32 v190, v108, v109
    v_cvt_pk_bf16_f32 v191, v110, v111
    v_mfma_f32_32x32x16_bf16 v[96:111], v[140:143], v[164:167], v[48:63]
    v_mad_u32_u24 v6, v28, 3, v29
    v_mfma_f32_32x32x16_bf16 v[80:95], v[172:175], v[188:191], v[80:95]
    ds_read_b128 v[168:171], v6
    ds_read_b128 v[172:175], v6 offset:512
    v_exp_f32 v112, v112
    v_exp_f32 v113, v113
    v_exp_f32 v114, v114
    v_exp_f32 v115, v115
    v_exp_f32 v116, v116
    v_exp_f32 v117, v117
    v_exp_f32 v118, v118
    v_exp_f32 v119, v119
    v_cvt_pk_bf16_f32 v184, v112, v113
    v_cvt_pk_bf16_f32 v185, v114, v115
    v_cvt_pk_bf16_f32 v186, v116, v117
    v_cvt_pk_bf16_f32 v187, v118, v119
    v_exp_f32 v120, v120
    v_exp_f32 v121, v121
    s_waitcnt lgkmcnt(2)
    v_mfma_f32_32x32x16_bf16 v[64:79], v[176:179], v[184:187], v[64:79]
    v_exp_f32 v122, v122
    v_exp_f32 v123, v123
    v_exp_f32 v124, v124
    v_exp_f32 v125, v125
    v_exp_f32 v126, v126
    v_exp_f32 v127, v127
    v_cvt_pk_bf16_f32 v188, v120, v121
    v_cvt_pk_bf16_f32 v189, v122, v123
    v_cvt_pk_bf16_f32 v190, v124, v125
    v_cvt_pk_bf16_f32 v191, v126, v127
    v_mfma_f32_32x32x16_bf16 v[112:127], v[140:143], v[160:163], v[192:207]
    v_mad_u32_u24 v6, v28, 3, v29
    v_mfma_f32_32x32x16_bf16 v[64:79], v[180:183], v[188:191], v[64:79]
    ds_read_b128 v[176:179], v6
    ds_read_b128 v[180:183], v6 offset:512
    v_exp_f32 v96, v96
    v_exp_f32 v97, v97
    v_exp_f32 v98, v98
    v_exp_f32 v99, v99
    v_exp_f32 v100, v100
    v_exp_f32 v101, v101
    v_exp_f32 v102, v102
    v_exp_f32 v103, v103
    v_cvt_pk_bf16_f32 v184, v96, v97
    v_cvt_pk_bf16_f32 v185, v98, v99
    v_cvt_pk_bf16_f32 v186, v100, v101
    v_cvt_pk_bf16_f32 v187, v102, v103
    v_exp_f32 v104, v104
    v_exp_f32 v105, v105
    s_waitcnt lgkmcnt(2)
    v_mfma_f32_32x32x16_bf16 v[80:95], v[168:171], v[184:187], v[80:95]
    v_exp_f32 v106, v106
    v_exp_f32 v107, v107
    v_exp_f32 v108, v108
    v_exp_f32 v109, v109
    v_exp_f32 v110, v110
    v_exp_f32 v111, v111
    v_cvt_pk_bf16_f32 v188, v104, v105
    v_cvt_pk_bf16_f32 v189, v106, v107
    v_cvt_pk_bf16_f32 v190, v108, v109
    v_cvt_pk_bf16_f32 v191, v110, v111
    v_mfma_f32_32x32x16_bf16 v[96:111], v[144:147], v[164:167], v[208:223]
    v_mad_u32_u24 v6, v28, 4, v29
    v_mfma_f32_32x32x16_bf16 v[80:95], v[172:175], v[188:191], v[80:95]
    ds_read_b128 v[168:171], v6
    ds_read_b128 v[172:175], v6 offset:512
    v_exp_f32 v112, v112
    v_exp_f32 v113, v113
    v_exp_f32 v114, v114
    v_exp_f32 v115, v115
    v_exp_f32 v116, v116
    v_exp_f32 v117, v117
    v_exp_f32 v118, v118
    v_exp_f32 v119, v119
    v_cvt_pk_bf16_f32 v184, v112, v113
    v_cvt_pk_bf16_f32 v185, v114, v115
    v_cvt_pk_bf16_f32 v186, v116, v117
    v_cvt_pk_bf16_f32 v187, v118, v119
    v_exp_f32 v120, v120
    v_exp_f32 v121, v121
    s_waitcnt lgkmcnt(2)
    v_mfma_f32_32x32x16_bf16 v[64:79], v[176:179], v[184:187], v[64:79]
    v_exp_f32 v122, v122
    v_exp_f32 v123, v123
    v_exp_f32 v124, v124
    v_exp_f32 v125, v125
    v_exp_f32 v126, v126
    v_exp_f32 v127, v127
    v_cvt_pk_bf16_f32 v188, v120, v121
    v_cvt_pk_bf16_f32 v189, v122, v123
    v_cvt_pk_bf16_f32 v190, v124, v125
    v_cvt_pk_bf16_f32 v191, v126, v127
    s_nop 1
    v_mfma_f32_32x32x16_bf16 v[64:79], v[180:183], v[188:191], v[64:79]
    v_exp_f32 v96, v96
    v_exp_f32 v97, v97
    v_exp_f32 v98, v98
    v_exp_f32 v99, v99
    v_exp_f32 v100, v100
    v_exp_f32 v101, v101
    v_exp_f32 v102, v102
    v_exp_f32 v103, v103
    v_cvt_pk_bf16_f32 v184, v96, v97
    v_cvt_pk_bf16_f32 v185, v98, v99
    v_cvt_pk_bf16_f32 v186, v100, v101
    v_cvt_pk_bf16_f32 v187, v102, v103
    v_exp_f32 v104, v104
    v_exp_f32 v105, v105
    s_waitcnt lgkmcnt(0)
    v_mfma_f32_32x32x16_bf16 v[80:95], v[168:171], v[184:187], v[80:95]
    v_exp_f32 v106, v106
    v_exp_f32 v107, v107
    v_exp_f32 v108, v108
    v_exp_f32 v109, v109
    v_exp_f32 v110, v110
    v_exp_f32 v111, v111
    v_cvt_pk_bf16_f32 v188, v104, v105
    v_cvt_pk_bf16_f32 v189, v106, v107
    v_cvt_pk_bf16_f32 v190, v108, v109
    v_cvt_pk_bf16_f32 v191, v110, v111
    s_nop 1
    v_mfma_f32_32x32x16_bf16 v[80:95], v[172:175], v[188:191], v[80:95]
L_attd_25:
    v_mov_b32 v20, 0xf149f2ca
    v_mov_b32 v21, v20
    v_pk_add_f32 v[224:225], v[20:21], v[224:225] neg_lo:[0,1] neg_hi:[0,1]
    v_pk_add_f32 v[226:227], v[20:21], v[226:227] neg_lo:[0,1] neg_hi:[0,1]
    v_pk_add_f32 v[228:229], v[20:21], v[228:229] neg_lo:[0,1] neg_hi:[0,1]
    v_pk_add_f32 v[230:231], v[20:21], v[230:231] neg_lo:[0,1] neg_hi:[0,1]
    v_pk_add_f32 v[232:233], v[20:21], v[232:233] neg_lo:[0,1] neg_hi:[0,1]
    v_pk_add_f32 v[234:235], v[20:21], v[234:235] neg_lo:[0,1] neg_hi:[0,1]
    v_pk_add_f32 v[236:237], v[20:21], v[236:237] neg_lo:[0,1] neg_hi:[0,1]
    v_pk_add_f32 v[238:239], v[20:21], v[238:239] neg_lo:[0,1] neg_hi:[0,1]
    s_barrier
    s_cmp_eq_u32 s40, 0
    s_cbranch_scc1 L_nohalo_26
    v_add_u32 v4, 49152, v8
    v_add_u32 v29, 49152, v5
    v_cndmask_b32_e64 v29, v30, v29, s[64:65]
    s_cmp_eq_u32 s42, 1
    s_cbranch_scc1 L_att1_28
    s_cmp_eq_u32 s42, 2
    s_cbranch_scc1 L_att2_29
    s_cmp_eq_u32 s42, 3
    s_cbranch_scc1 L_att3_30
L_att0_27:
    ds_read_b128 v[128:131], v4 offset:0
    ds_read_b128 v[132:135], v4 offset:2048
    ds_read_b128 v[136:139], v4 offset:4096
    ds_read_b128 v[140:143], v4 offset:6144
    ds_read_b128 v[144:147], v4 offset:8192
    ds_read_b128 v[148:151], v4 offset:10240
    ds_read_b128 v[152:155], v4 offset:12288
    ds_read_b128 v[156:159], v4 offset:14336
    s_waitcnt lgkmcnt(7)
    v_mfma_f32_32x32x16_bf16 v[96:111], v[128:131], v[160:163], v[224:239]
    s_waitcnt lgkmcnt(6)
    v_mfma_f32_32x32x16_bf16 v[112:127], v[132:135], v[160:163], 0
    v_mad_u32_u24 v6, v28, 0, v29
    ds_read_b128 v[168:171], v6
    ds_read_b128 v[172:175], v6 offset:512
    v_mad_u32_u24 v6, v28, 1, v29
    ds_read_b128 v[176:179], v6
    ds_read_b128 v[180:183], v6 offset:512
    s_waitcnt lgkmcnt(9)
    v_mfma_f32_32x32x16_bf16 v[192:207], v[136:139], v[160:163], 0
    s_nop 1
    v_max3_f32 v20, v96, v97, v98
    v_max3_f32 v21, v99, v100, v101
    v_max3_f32 v20, v20, v102, v103
    v_max3_f32 v21, v21, v104, v105
    v_max3_f32 v20, v20, v106, v107
    v_max3_f32 v21, v21, v108, v109
    v_max3_f32 v20, v20, v110, v111
    s_waitcnt lgkmcnt(8)
    v_mfma_f32_32x32x16_bf16 v[96:111], v[140:143], v[160:163], 0
    v_max3_f32 v20, v20, v112, v113
    v_max3_f32 v21, v21, v114, v115
    v_max3_f32 v20, v20, v116, v117
    v_max3_f32 v21, v21, v118, v119
    v_max3_f32 v20, v20, v120, v121
    v_max3_f32 v21, v21, v122, v123
    v_max3_f32 v20, v20, v124, v125
    v_max3_f32 v21, v21, v126, v127
    s_waitcnt lgkmcnt(7)
    v_mfma_f32_32x32x16_bf16 v[112:127], v[144:147], v[160:163], 0
    v_max3_f32 v20, v20, v192, v193
    v_max3_f32 v21, v21, v194, v195
    v_max3_f32 v20, v20, v196, v197
    v_max3_f32 v21, v21, v198, v199
    v_max3_f32 v20, v20, v200, v201
    v_max3_f32 v21, v21, v202, v203
    v_max3_f32 v20, v20, v204, v205
    v_max3_f32 v21, v21, v206, v207
    s_waitcnt lgkmcnt(6)
    v_mfma_f32_32x32x16_bf16 v[192:207], v[148:151], v[160:163], 0
    v_max3_f32 v20, v20, v96, v97
    v_max3_f32 v21, v21, v98, v99
    v_max3_f32 v20, v20, v100, v101
    v_max3_f32 v21, v21, v102, v103
    v_max3_f32 v20, v20, v104, v105
    v_max3_f32 v21, v21, v106, v107
    v_max3_f32 v20, v20, v108, v109
    v_max3_f32 v21, v21, v110, v111
    s_waitcnt lgkmcnt(5)
    v_mfma_f32_32x32x16_bf16 v[96:111], v[152:155], v[160:163], 0
    v_max3_f32 v20, v20, v112, v113
    v_max3_f32 v21, v21, v114, v115
    v_max3_f32 v20, v20, v116, v117
    v_max3_f32 v21, v21, v118, v119
    v_max3_f32 v20, v20, v120, v121
    v_max3_f32 v21, v21, v122, v123
    v_max3_f32 v20, v20, v124, v125
    v_max3_f32 v21, v21, v126, v127
    s_waitcnt lgkmcnt(4)
    v_mfma_f32_32x32x16_bf16 v[112:127], v[156:159], v[164:167], v[224:239]
    v_max3_f32 v20, v20, v192, v193
    v_max3_f32 v21, v21, v194, v195
    v_max3_f32 v20, v20, v196, v197
    v_max3_f32 v21, v21, v198, v199
    v_max3_f32 v20, v20, v200, v201
    v_max3_f32 v21, v21, v202, v203
    v_max3_f32 v20, v20, v204, v205
    v_max3_f32 v21, v21, v206, v207
    v_mfma_f32_32x32x16_bf16 v[192:207], v[156:159], v[160:163], 0
    v_max3_f32 v20, v20, v96, v97
    v_max3_f32 v21, v21, v98, v99
    v_max3_f32 v20, v20, v100, v101
    v_max3_f32 v21, v21, v102, v103
    v_max3_f32 v20, v20, v104, v105
    v_max3_f32 v21, v21, v106, v107
    v_max3_f32 v20, v20, v108, v109
    v_max3_f32 v21, v21, v110, v111
    v_max3_f32 v22, v112, v113, v114
    v_max3_f32 v23, v115, v116, v117
    v_max3_f32 v22, v22, v118, v119
    v_max3_f32 v23, v23, v120, v121
    v_max3_f32 v22, v22, v122, v123
    v_max3_f32 v23, v23, v124, v125
    v_max3_f32 v22, v22, v126, v127
    v_max3_f32 v20, v20, v192, v193
    v_max3_f32 v21, v21, v194, v195
    v_max3_f32 v20, v20, v196, v197
    v_max3_f32 v21, v21, v198, v199
    v_max3_f32 v20, v20, v200, v201
    v_max3_f32 v21, v21, v202, v203
    v_max3_f32 v20, v20, v204, v205
    v_max3_f32 v21, v21, v206, v207
    v_max_f32 v20, v20, v21
    v_max_f32 v22, v22, v23
    v_mov_b32 v21, v20
    v_mov_b32 v23, v22
    s_nop 0
    v_permlane32_swap_b32 v20, v21
    v_permlane32_swap_b32 v22, v23
    v_max3_f32 v20, v20, v21, v12
    v_max3_f32 v22, v22, v23, v14
    v_sub_f32 v24, v12, v20
    v_sub_f32 v26, v14, v22
    v_exp_f32 v24, v24
    v_exp_f32 v26, v26
    v_mov_b32 v12, v20
    v_mov_b32 v14, v22
    v_sub_f32 v20, 0, v12
    v_sub_f32 v22, 0, v14
    v_mov_b32 v21, v20
    v_mov_b32 v23, v22
    v_pk_add_f32 v[192:193], v[224:225], v[20:21]
    v_pk_add_f32 v[194:195], v[226:227], v[20:21]
    v_pk_add_f32 v[196:197], v[228:229], v[20:21]
    v_pk_add_f32 v[198:199], v[230:231], v[20:21]
    v_pk_add_f32 v[200:201], v[232:233], v[20:21]
    v_pk_add_f32 v[202:203], v[234:235], v[20:21]
    v_pk_add_f32 v[204:205], v[236:237], v[20:21]
    v_pk_add_f32 v[206:207], v[238:239], v[20:21]
    v_pk_mov_b32 v[32:33], v[20:21], v[20:21] op_sel:[0,0]
    v_pk_mov_b32 v[34:35], v[20:21], v[20:21] op_sel:[0,0]
    v_pk_mov_b32 v[36:37], v[20:21], v[20:21] op_sel:[0,0]
    v_pk_mov_b32 v[38:39], v[20:21], v[20:21] op_sel:[0,0]
    v_pk_mov_b32 v[40:41], v[20:21], v[20:21] op_sel:[0,0]
    v_pk_mov_b32 v[42:43], v[20:21], v[20:21] op_sel:[0,0]
    v_pk_mov_b32 v[44:45], v[20:21], v[20:21] op_sel:[0,0]
    v_pk_mov_b32 v[46:47], v[20:21], v[20:21] op_sel:[0,0]
    v_mfma_f32_32x32x16_bf16 v[96:111], v[128:131], v[160:163], v[192:207]
    v_pk_mul_f32 v[64:65], v[64:65], v[24:25] op_sel_hi:[1,0]
    v_pk_mul_f32 v[66:67], v[66:67], v[24:25] op_sel_hi:[1,0]
    v_pk_mul_f32 v[68:69], v[68:69], v[24:25] op_sel_hi:[1,0]
    v_pk_mul_f32 v[70:71], v[70:71], v[24:25] op_sel_hi:[1,0]
    v_mul_f32 v72, v72, v24
    v_pk_mul_f32 v[80:81], v[80:81], v[26:27] op_sel_hi:[1,0]
    v_pk_mul_f32 v[82:83], v[82:83], v[26:27] op_sel_hi:[1,0]
    v_pk_mul_f32 v[84:85], v[84:85], v[26:27] op_sel_hi:[1,0]
    v_pk_mul_f32 v[86:87], v[86:87], v[26:27] op_sel_hi:[1,0]
    v_mul_f32 v88, v88, v26
    v_mfma_f32_32x32x16_bf16 v[112:127], v[132:135], v[160:163], v[32:47]
    v_pk_add_f32 v[208:209], v[224:225], v[22:23]
    v_pk_add_f32 v[210:211], v[226:227], v[22:23]
    v_pk_add_f32 v[212:213], v[228:229], v[22:23]
    v_pk_add_f32 v[214:215], v[230:231], v[22:23]
    v_pk_add_f32 v[216:217], v[232:233], v[22:23]
    v_pk_add_f32 v[218:219], v[234:235], v[22:23]
    v_pk_add_f32 v[220:221], v[236:237], v[22:23]
    v_pk_add_f32 v[222:223], v[238:239], v[22:23]
    v_exp_f32 v96, v96
    v_exp_f32 v97, v97
    v_exp_f32 v98, v98
    v_exp_f32 v99, v99
    v_exp_f32 v100, v100
    v_exp_f32 v101, v101
    v_exp_f32 v102, v102
    v_exp_f32 v103, v103
    v_cvt_pk_bf16_f32 v184, v96, v97
    v_cvt_pk_bf16_f32 v185, v98, v99
    v_cvt_pk_bf16_f32 v186, v100, v101
    v_cvt_pk_bf16_f32 v187, v102, v103
    v_exp_f32 v104, v104
    v_exp_f32 v105, v105
    s_waitcnt lgkmcnt(2)
    v_mfma_f32_32x32x16_bf16 v[64:79], v[168:171], v[184:187], v[64:79]
    v_exp_f32 v106, v106
    v_exp_f32 v107, v107
    v_exp_f32 v108, v108
    v_exp_f32 v109, v109
    v_exp_f32 v110, v110
    v_exp_f32 v111, v111
    v_cvt_pk_bf16_f32 v188, v104, v105
    v_cvt_pk_bf16_f32 v189, v106, v107
    v_cvt_pk_bf16_f32 v190, v108, v109
    v_cvt_pk_bf16_f32 v191, v110, v111
    v_mfma_f32_32x32x16_bf16 v[96:111], v[136:139], v[160:163], v[32:47]
    v_mad_u32_u24 v6, v28, 2, v29
    v_mfma_f32_32x32x16_bf16 v[64:79], v[172:175], v[188:191], v[64:79]
    ds_read_b128 v[168:171], v6
    ds_read_b128 v[172:175], v6 offset:512
    v_exp_f32 v112, v112
    v_exp_f32 v113, v113
    v_exp_f32 v114, v114
    v_exp_f32 v115, v115
    v_exp_f32 v116, v116
    v_exp_f32 v117, v117
    v_exp_f32 v118, v118
    v_exp_f32 v119, v119
    v_cvt_pk_bf16_f32 v184, v112, v113
    v_cvt_pk_bf16_f32 v185, v114, v115
    v_cvt_pk_bf16_f32 v186, v116, v117
    v_cvt_pk_bf16_f32 v187, v118, v119
    v_exp_f32 v120, v120
    v_exp_f32 v121, v121
    s_waitcnt lgkmcnt(2)
    v_mfma_f32_32x32x16_bf16 v[64:79], v[176:179], v[184:187], v[64:79]
    v_exp_f32 v122, v122
    v_exp_f32 v123, v123
    v_exp_f32 v124, v124
    v_exp_f32 v125, v125
    v_exp_f32 v126, v126
    v_exp_f32 v127, v127
    v_cvt_pk_bf16_f32 v188, v120, v121
    v_cvt_pk_bf16_f32 v189, v122, v123
    v_cvt_pk_bf16_f32 v190, v124, v125
    v_cvt_pk_bf16_f32 v191, v126, v127
    v_mfma_f32_32x32x16_bf16 v[112:127], v[140:143], v[160:163], v[32:47]
    v_mad_u32_u24 v6, v28, 3, v29
    v_mfma_f32_32x32x16_bf16 v[64:79], v[180:183], v[188:191], v[64:79]
    ds_read_b128 v[176:179], v6
    ds_read_b128 v[180:183], v6 offset:512
    v_exp_f32 v96, v96
    v_exp_f32 v97, v97
    v_exp_f32 v98, v98
    v_exp_f32 v99, v99
    v_exp_f32 v100, v100
    v_exp_f32 v101, v101
    v_exp_f32 v102, v102
    v_exp_f32 v103, v103
    v_cvt_pk_bf16_f32 v184, v96, v97
    v_cvt_pk_bf16_f32 v185, v98, v99
    v_cvt_pk_bf16_f32 v186, v100, v101
    v_cvt_pk_bf16_f32 v187, v102, v103
    v_exp_f32 v104, v104
    v_exp_f32 v105, v105
    s_waitcnt lgkmcnt(2)
    v_mfma_f32_32x32x16_bf16 v[64:79], v[168:171], v[184:187], v[64:79]
    v_exp_f32 v106, v106
    v_exp_f32 v107, v107
    v_exp_f32 v108, v108
    v_exp_f32 v109, v109
    v_exp_f32 v110, v110
    v_exp_f32 v111, v111
    v_cvt_pk_bf16_f32 v188, v104, v105
    v_cvt_pk_bf16_f32 v189, v106, v107
    v_cvt_pk_bf16_f32 v190, v108, v109
    v_cvt_pk_bf16_f32 v191, v110, v111
    v_mfma_f32_32x32x16_bf16 v[96:111], v[144:147], v[160:163], v[32:47]
    v_mad_u32_u24 v6, v28, 4, v29
    v_mfma_f32_32x32x16_bf16 v[64:79], v[172:175], v[188:191], v[64:79]
    ds_read_b128 v[168:171], v6
    ds_read_b128 v[172:175], v6 offset:512
    v_exp_f32 v112, v112
    v_exp_f32 v113, v113
    v_exp_f32 v114, v114
    v_exp_f32 v115, v115
    v_exp_f32 v116, v116
    v_exp_f32 v117, v117
    v_exp_f32 v118, v118
    v_exp_f32 v119, v119
    v_cvt_pk_bf16_f32 v184, v112, v113
    v_cvt_pk_bf16_f32 v185, v114, v115
    v_cvt_pk_bf16_f32 v186, v116, v117
    v_cvt_pk_bf16_f32 v187, v118, v119
    v_exp_f32 v120, v120
    v_exp_f32 v121, v121
    s_waitcnt lgkmcnt(2)
    v_mfma_f32_32x32x16_bf16 v[64:79], v[176:179], v[184:187], v[64:79]
    v_exp_f32 v122, v122
    v_exp_f32 v123, v123
    v_exp_f32 v124, v124
    v_exp_f32 v125, v125
    v_exp_f32 v126, v126
    v_exp_f32 v127, v127
    v_cvt_pk_bf16_f32 v188, v120, v121
    v_cvt_pk_bf16_f32 v189, v122, v123
    v_cvt_pk_bf16_f32 v190, v124, v125
    v_cvt_pk_bf16_f32 v191, v126, v127
    v_mfma_f32_32x32x16_bf16 v[112:127], v[148:151], v[160:163], v[32:47]
    v_mad_u32_u24 v6, v28, 5, v29
    v_mfma_f32_32x32x16_bf16 v[64:79], v[180:183], v[188:191], v[64:79]
    ds_read_b128 v[176:179], v6
    ds_read_b128 v[180:183], v6 offset:512
    v_exp_f32 v96, v96
    v_exp_f32 v97, v97
    v_exp_f32 v98, v98
    v_exp_f32 v99, v99
    v_exp_f32 v100, v100
    v_exp_f32 v101, v101
    v_exp_f32 v102, v102
    v_exp_f32 v103, v103
    v_cvt_pk_bf16_f32 v184, v96, v97
    v_cvt_pk_bf16_f32 v185, v98, v99
    v_cvt_pk_bf16_f32 v186, v100, v101
    v_cvt_pk_bf16_f32 v187, v102, v103
    v_exp_f32 v104, v104
    v_exp_f32 v105, v105
    s_waitcnt lgkmcnt(2)
    v_mfma_f32_32x32x16_bf16 v[64:79], v[168:171], v[184:187], v[64:79]
    v_exp_f32 v106, v106
    v_exp_f32 v107, v107
    v_exp_f32 v108, v108
    v_exp_f32 v109, v109
    v_exp_f32 v110, v110
    v_exp_f32 v111, v111
    v_cvt_pk_bf16_f32 v188, v104, v105
    v_cvt_pk_bf16_f32 v189, v106, v107
    v_cvt_pk_bf16_f32 v190, v108, v109
    v_cvt_pk_bf16_f32 v191, v110, v111
    v_mfma_f32_32x32x16_bf16 v[96:111], v[152:155], v[160:163], v[32:47]
    v_mad_u32_u24 v6, v28, 6, v29
    v_mfma_f32_32x32x16_bf16 v[64:79], v[172:175], v[188:191], v[64:79]
    ds_read_b128 v[168:171], v6
    ds_read_b128 v[172:175], v6 offset:512
    v_exp_f32 v112, v112
    v_exp_f32 v113, v113
    v_exp_f32 v114, v114
    v_exp_f32 v115, v115
    v_exp_f32 v116, v116
    v_exp_f32 v117, v117
    v_exp_f32 v118, v118
    v_exp_f32 v119, v119
    v_cvt_pk_bf16_f32 v184, v112, v113
    v_cvt_pk_bf16_f32 v185, v114, v115
    v_cvt_pk_bf16_f32 v186, v116, v117
    v_cvt_pk_bf16_f32 v187, v118, v119
    v_exp_f32 v120, v120
    v_exp_f32 v121, v121
    s_waitcnt lgkmcnt(2)
    v_mfma_f32_32x32x16_bf16 v[64:79], v[176:179], v[184:187], v[64:79]
    v_exp_f32 v122, v122
    v_exp_f32 v123, v123
    v_exp_f32 v124, v124
    v_exp_f32 v125, v125
    v_exp_f32 v126, v126
    v_exp_f32 v127, v127
    v_cvt_pk_bf16_f32 v188, v120, v121
    v_cvt_pk_bf16_f32 v189, v122, v123
    v_cvt_pk_bf16_f32 v190, v124, v125
    v_cvt_pk_bf16_f32 v191, v126, v127
    v_mfma_f32_32x32x16_bf16 v[112:127], v[156:159], v[164:167], v[208:223]
    v_mad_u32_u24 v6, v28, 7, v29
    v_mfma_f32_32x32x16_bf16 v[64:79], v[180:183], v[188:191], v[64:79]
    ds_read_b128 v[176:179], v6
    ds_read_b128 v[180:183], v6 offset:512
    v_exp_f32 v96, v96
    v_exp_f32 v97, v97
    v_exp_f32 v98, v98
    v_exp_f32 v99, v99
    v_exp_f32 v100, v100
    v_exp_f32 v101, v101
    v_exp_f32 v102, v102
    v_exp_f32 v103, v103
    v_cvt_pk_bf16_f32 v184, v96, v97
    v_cvt_pk_bf16_f32 v185, v98, v99
    v_cvt_pk_bf16_f32 v186, v100, v101
    v_cvt_pk_bf16_f32 v187, v102, v103
    v_exp_f32 v104, v104
    v_exp_f32 v105, v105
    s_waitcnt lgkmcnt(2)
    v_mfma_f32_32x32x16_bf16 v[64:79], v[168:171], v[184:187], v[64:79]
    v_exp_f32 v106, v106
    v_exp_f32 v107, v107
    v_exp_f32 v108, v108
    v_exp_f32 v109, v109
    v_exp_f32 v110, v110
    v_exp_f32 v111, v111
    v_cvt_pk_bf16_f32 v188, v104, v105
    v_cvt_pk_bf16_f32 v189, v106, v107
    v_cvt_pk_bf16_f32 v190, v108, v109
    v_cvt_pk_bf16_f32 v191, v110, v111
    v_mfma_f32_32x32x16_bf16 v[96:111], v[156:159], v[160:163], v[32:47]
    v_mad_u32_u24 v6, v28, 7, v29
    v_mfma_f32_32x32x16_bf16 v[64:79], v[172:175], v[188:191], v[64:79]
    ds_read_b128 v[168:171], v6
    ds_read_b128 v[172:175], v6 offset:512
    v_exp_f32 v112, v112
    v_exp_f32 v113, v113
    v_exp_f32 v114, v114
    v_exp_f32 v115, v115
    v_exp_f32 v116, v116
    v_exp_f32 v117, v117
    v_exp_f32 v118, v118
    v_exp_f32 v119, v119
    v_cvt_pk_bf16_f32 v184, v112, v113
    v_cvt_pk_bf16_f32 v185, v114, v115
    v_cvt_pk_bf16_f32 v186, v116, v117
    v_cvt_pk_bf16_f32 v187, v118, v119
    v_exp_f32 v120, v120
    v_exp_f32 v121, v121
    s_waitcnt lgkmcnt(2)
    v_mfma_f32_32x32x16_bf16 v[80:95], v[176:179], v[184:187], v[80:95]
    v_exp_f32 v122, v122
    v_exp_f32 v123, v123
    v_exp_f32 v124, v124
    v_exp_f32 v125, v125
    v_exp_f32 v126, v126
    v_exp_f32 v127, v127
    v_cvt_pk_bf16_f32 v188, v120, v121
    v_cvt_pk_bf16_f32 v189, v122, v123
    v_cvt_pk_bf16_f32 v190, v124, v125
    v_cvt_pk_bf16_f32 v191, v126, v127
    s_nop 1
    v_mfma_f32_32x32x16_bf16 v[80:95], v[180:183], v[188:191], v[80:95]
    v_exp_f32 v96, v96
    v_exp_f32 v97, v97
    v_exp_f32 v98, v98
    v_exp_f32 v99, v99
    v_exp_f32 v100, v100
    v_exp_f32 v101, v101
    v_exp_f32 v102, v102
    v_exp_f32 v103, v103
    v_cvt_pk_bf16_f32 v184, v96, v97
    v_cvt_pk_bf16_f32 v185, v98, v99
    v_cvt_pk_bf16_f32 v186, v100, v101
    v_cvt_pk_bf16_f32 v187, v102, v103
    v_exp_f32 v104, v104
    v_exp_f32 v105, v105
    s_waitcnt lgkmcnt(0)
    v_mfma_f32_32x32x16_bf16 v[64:79], v[168:171], v[184:187], v[64:79]
    v_exp_f32 v106, v106
    v_exp_f32 v107, v107
    v_exp_f32 v108, v108
    v_exp_f32 v109, v109
    v_exp_f32 v110, v110
    v_exp_f32 v111, v111
    v_cvt_pk_bf16_f32 v188, v104, v105
    v_cvt_pk_bf16_f32 v189, v106, v107
    v_cvt_pk_bf16_f32 v190, v108, v109
    v_cvt_pk_bf16_f32 v191, v110, v111
    s_nop 1
    v_mfma_f32_32x32x16_bf16 v[64:79], v[172:175], v[188:191], v[64:79]
    s_branch L_attd_31
L_att1_28:
    ds_read_b128 v[128:131], v4 offset:2048
    ds_read_b128 v[132:135], v4 offset:4096
    ds_read_b128 v[136:139], v4 offset:6144
    ds_read_b128 v[140:143], v4 offset:8192
    ds_read_b128 v[144:147], v4 offset:10240
    ds_read_b128 v[148:151], v4 offset:12288
    ds_read_b128 v[152:155], v4 offset:14336
    s_waitcnt lgkmcnt(6)
    v_mfma_f32_32x32x16_bf16 v[96:111], v[128:131], v[160:163], v[224:239]
    s_waitcnt lgkmcnt(5)
    v_mfma_f32_32x32x16_bf16 v[112:127], v[132:135], v[160:163], 0
    v_mad_u32_u24 v6, v28, 1, v29
    ds_read_b128 v[168:171], v6
    ds_read_b128 v[172:175], v6 offset:512
    v_mad_u32_u24 v6, v28, 2, v29
    ds_read_b128 v[176:179], v6
    ds_read_b128 v[180:183], v6 offset:512
    s_waitcnt lgkmcnt(8)
    v_mfma_f32_32x32x16_bf16 v[192:207], v[136:139], v[160:163], 0
    s_nop 1
    v_max3_f32 v20, v96, v97, v98
    v_max3_f32 v21, v99, v100, v101
    v_max3_f32 v20, v20, v102, v103
    v_max3_f32 v21, v21, v104, v105
    v_max3_f32 v20, v20, v106, v107
    v_max3_f32 v21, v21, v108, v109
    v_max3_f32 v20, v20, v110, v111
    s_waitcnt lgkmcnt(7)
    v_mfma_f32_32x32x16_bf16 v[96:111], v[140:143], v[160:163], 0
    v_max3_f32 v20, v20, v112, v113
    v_max3_f32 v21, v21, v114, v115
    v_max3_f32 v20, v20, v116, v117
    v_max3_f32 v21, v21, v118, v119
    v_max3_f32 v20, v20, v120, v121
    v_max3_f32 v21, v21, v122, v123
    v_max3_f32 v20, v20, v124, v125
    v_max3_f32 v21, v21, v126, v127
    s_waitcnt lgkmcnt(6)
    v_mfma_f32_32x32x16_bf16 v[112:127], v[144:147], v[160:163], 0
    v_max3_f32 v20, v20, v192, v193
    v_max3_f32 v21, v21, v194, v195
    v_max3_f32 v20, v20, v196, v197
    v_max3_f32 v21, v21, v198, v199
    v_max3_f32 v20, v20, v200, v201
    v_max3_f32 v21, v21, v202, v203
    v_max3_f32 v20, v20, v204, v205
    v_max3_f32 v21, v21, v206, v207
    s_waitcnt lgkmcnt(5)
    v_mfma_f32_32x32x16_bf16 v[192:207], v[148:151], v[164:167], v[224:239]
    v_max3_f32 v20, v20, v96, v97
    v_max3_f32 v21, v21, v98, v99
    v_max3_f32 v20, v20, v100, v101
    v_max3_f32 v21, v21, v102, v103
    v_max3_f32 v20, v20, v104, v105
    v_max3_f32 v21, v21, v106, v107
    v_max3_f32 v20, v20, v108, v109
    v_max3_f32 v21, v21, v110, v111
    v_mfma_f32_32x32x16_bf16 v[96:111], v[148:151], v[160:163], 0
    v_max3_f32 v20, v20, v112, v113
    v_max3_f32 v21, v21, v114, v115
    v_max3_f32 v20, v20, v116, v117
    v_max3_f32 v21, v21, v118, v119
    v_max3_f32 v20, v20, v120, v121
    v_max3_f32 v21, v21, v122, v123
    v_max3_f32 v20, v20, v124, v125
    v_max3_f32 v21, v21, v126, v127
    s_waitcnt lgkmcnt(4)
    v_mfma_f32_32x32x16_bf16 v[112:127], v[152:155], v[164:167], 0
    v_max3_f32 v22, v192, v193, v194
    v_max3_f32 v23, v195, v196, v197
    v_max3_f32 v22, v22, v198, v199
    v_max3_f32 v23, v23, v200, v201
    v_max3_f32 v22, v22, v202, v203
    v_max3_f32 v23, v23, v204, v205
    v_max3_f32 v22, v22, v206, v207
    v_mfma_f32_32x32x16_bf16 v[192:207], v[152:155], v[160:163], 0
    v_max3_f32 v20, v20, v96, v97
    v_max3_f32 v21, v21, v98, v99
    v_max3_f32 v20, v20, v100, v101
    v_max3_f32 v21, v21, v102, v103
    v_max3_f32 v20, v20, v104, v105
    v_max3_f32 v21, v21, v106, v107
    v_max3_f32 v20, v20, v108, v109
    v_max3_f32 v21, v21, v110, v111
    v_max3_f32 v22, v22, v112, v113
    v_max3_f32 v23, v23, v114, v115
    v_max3_f32 v22, v22, v116, v117
    v_max3_f32 v23, v23, v118, v119
    v_max3_f32 v22, v22, v120, v121
    v_max3_f32 v23, v23, v122, v123
    v_max3_f32 v22, v22, v124, v125
    v_max3_f32 v23, v23, v126, v127
    v_max3_f32 v20, v20, v192, v193
    v_max3_f32 v21, v21, v194, v195
    v_max3_f32 v20, v20, v196, v197
    v_max3_f32 v21, v21, v198, v199
    v_max3_f32 v20, v20, v200, v201
    v_max3_f32 v21, v21, v202, v203
    v_max3_f32 v20, v20, v204, v205
    v_max3_f32 v21, v21, v206, v207
    v_max_f32 v20, v20, v21
    v_max_f32 v22, v22, v23
    v_mov_b32 v21, v20
    v_mov_b32 v23, v22
    s_nop 0
    v_permlane32_swap_b32 v20, v21
    v_permlane32_swap_b32 v22, v23
    v_max3_f32 v20, v20, v21, v12
    v_max3_f32 v22, v22, v23, v14
    v_sub_f32 v24, v12, v20
    v_sub_f32 v26, v14, v22
    v_exp_f32 v24, v24
    v_exp_f32 v26, v26
    v_mov_b32 v12, v20
    v_mov_b32 v14, v22
    v_sub_f32 v20, 0, v12
    v_sub_f32 v22, 0, v14
    v_mov_b32 v21, v20
    v_mov_b32 v23, v22
    v_pk_add_f32 v[192:193], v[224:225], v[20:21]
    v_pk_add_f32 v[194:195], v[226:227], v[20:21]
    v_pk_add_f32 v[196:197], v[228:229], v[20:21]
    v_pk_add_f32 v[198:199], v[230:231], v[20:21]
    v_pk_add_f32 v[200:201], v[232:233], v[20:21]
    v_pk_add_f32 v[202:203], v[234:235], v[20:21]
    v_pk_add_f32 v[204:205], v[236:237], v[20:21]
    v_pk_add_f32 v[206:207], v[238:239], v[20:21]
    v_pk_mov_b32 v[32:33], v[20:21], v[20:21] op_sel:[0,0]
    v_pk_mov_b32 v[34:35], v[20:21], v[20:21] op_sel:[0,0]
    v_pk_mov_b32 v[36:37], v[20:21], v[20:21] op_sel:[0,0]
    v_pk_mov_b32 v[38:39], v[20:21], v[20:21] op_sel:[0,0]
    v_pk_mov_b32 v[40:41], v[20:21], v[20:21] op_sel:[0,0]
    v_pk_mov_b32 v[42:43], v[20:21], v[20:21] op_sel:[0,0]
    v_pk_mov_b32 v[44:45], v[20:21], v[20:21] op_sel:[0,0]
    v_pk_mov_b32 v[46:47], v[20:21], v[20:21] op_sel:[0,0]
    v_mfma_f32_32x32x16_bf16 v[96:111], v[128:131], v[160:163], v[192:207]
    v_pk_mul_f32 v[64:65], v[64:65], v[24:25] op_sel_hi:[1,0]
    v_pk_mul_f32 v[66:67], v[66:67], v[24:25] op_sel_hi:[1,0]
    v_pk_mul_f32 v[68:69], v[68:69], v[24:25] op_sel_hi:[1,0]
    v_pk_mul_f32 v[70:71], v[70:71], v[24:25] op_sel_hi:[1,0]
    v_mul_f32 v72, v72, v24
    v_pk_mul_f32 v[80:81], v[80:81], v[26:27] op_sel_hi:[1,0]
    v_pk_mul_f32 v[82:83], v[82:83], v[26:27] op_sel_hi:[1,0]
    v_pk_mul_f32 v[84:85], v[84:85], v[26:27] op_sel_hi:[1,0]
    v_pk_mul_f32 v[86:87], v[86:87], v[26:27] op_sel_hi:[1,0]
    v_mul_f32 v88, v88, v26
    v_mfma_f32_32x32x16_bf16 v[112:127], v[132:135], v[160:163], v[32:47]
    v_pk_add_f32 v[208:209], v[224:225], v[22:23]
    v_pk_add_f32 v[210:211], v[226:227], v[22:23]
    v_pk_add_f32 v[212:213], v[228:229], v[22:23]
    v_pk_add_f32 v[214:215], v[230:231], v[22:23]
    v_pk_add_f32 v[216:217], v[232:233], v[22:23]
    v_pk_add_f32 v[218:219], v[234:235], v[22:23]
    v_pk_add_f32 v[220:221], v[236:237], v[22:23]
    v_pk_add_f32 v[222:223], v[238:239], v[22:23]
    v_pk_mov_b32 v[48:49], v[22:23], v[22:23] op_sel:[0,0]
    v_pk_mov_b32 v[50:51], v[22:23], v[22:23] op_sel:[0,0]
    v_pk_mov_b32 v[52:53], v[22:23], v[22:23] op_sel:[0,0]
    v_pk_mov_b32 v[54:55], v[22:23], v[22:23] op_sel:[0,0]
    v_pk_mov_b32 v[56:57], v[22:23], v[22:23] op_sel:[0,0]
    v_pk_mov_b32 v[58:59], v[22:23], v[22:23] op_sel:[0,0]
    v_pk_mov_b32 v[60:61], v[22:23], v[22:23] op_sel:[0,0]
    v_pk_mov_b32 v[62:63], v[22:23], v[22:23] op_sel:[0,0]
    v_exp_f32 v96, v96
    v_exp_f32 v97, v97
    v_exp_f32 v98, v98
    v_exp_f32 v99, v99
    v_exp_f32 v100, v100
    v_exp_f32 v101, v101
    v_exp_f32 v102, v102
    v_exp_f32 v103, v103
    v_cvt_pk_bf16_f32 v184, v96, v97
    v_cvt_pk_bf16_f32 v185, v98, v99
    v_cvt_pk_bf16_f32 v186, v100, v101
    v_cvt_pk_bf16_f32 v187, v102, v103
    v_exp_f32 v104, v104
    v_exp_f32 v105, v105
    s_waitcnt lgkmcnt(2)
    v_mfma_f32_32x32x16_bf16 v[64:79], v[168:171], v[184:187], v[64:79]
    v_exp_f32 v106, v106
    v_exp_f32 v107, v107
    v_exp_f32 v108, v108
    v_exp_f32 v109, v109
    v_exp_f32 v110, v110
    v_exp_f32 v111, v111
    v_cvt_pk_bf16_f32 v188, v104, v105
    v_cvt_pk_bf16_f32 v189, v106, v107
    v_cvt_pk_bf16_f32 v190, v108, v109
    v_cvt_pk_bf16_f32 v191, v110, v111
    v_mfma_f32_32x32x16_bf16 v[96:111], v[136:139], v[160:163], v[32:47]
    v_mad_u32_u24 v6, v28, 3, v29
    v_mfma_f32_32x32x16_bf16 v[64:79], v[172:175], v[188:191], v[64:79]
    ds_read_b128 v[168:171], v6
    ds_read_b128 v[172:175], v6 offset:512
    v_exp_f32 v112, v112
    v_exp_f32 v113, v113
    v_exp_f32 v114, v114
    v_exp_f32 v115, v115
    v_exp_f32 v116, v116
    v_exp_f32 v117, v117
    v_exp_f32 v118, v118
    v_exp_f32 v119, v119
    v_cvt_pk_bf16_f32 v184, v112, v113
    v_cvt_pk_bf16_f32 v185, v114, v115
    v_cvt_pk_bf16_f32 v186, v116, v117
    v_cvt_pk_bf16_f32 v187, v118, v119
    v_exp_f32 v120, v120
    v_exp_f32 v121, v121
    s_waitcnt lgkmcnt(2)
    v_mfma_f32_32x32x16_bf16 v[64:79], v[176:179], v[184:187], v[64:79]
    v_exp_f32 v122, v122
    v_exp_f32 v123, v123
    v_exp_f32 v124, v124
    v_exp_f32 v125, v125
    v_exp_f32 v126, v126
    v_exp_f32 v127, v127
    v_cvt_pk_bf16_f32 v188, v120, v121
    v_cvt_pk_bf16_f32 v189, v122, v123
    v_cvt_pk_bf16_f32 v190, v124, v125
    v_cvt_pk_bf16_f32 v191, v126, v127
    v_mfma_f32_32x32x16_bf16 v[112:127], v[140:143], v[160:163], v[32:47]
    v_mad_u32_u24 v6, v28, 4, v29
    v_mfma_f32_32x32x16_bf16 v[64:79], v[180:183], v[188:191], v[64:79]
    ds_read_b128 v[176:179], v6
    ds_read_b128 v[180:183], v6 offset:512
    v_exp_f32 v96, v96
    v_exp_f32 v97, v97
    v_exp_f32 v98, v98
    v_exp_f32 v99, v99
    v_exp_f32 v100, v100
    v_exp_f32 v101, v101
    v_exp_f32 v102, v102
    v_exp_f32 v103, v103
    v_cvt_pk_bf16_f32 v184, v96, v97
    v_cvt_pk_bf16_f32 v185, v98, v99
    v_cvt_pk_bf16_f32 v186, v100, v101
    v_cvt_pk_bf16_f32 v187, v102, v103
    v_exp_f32 v104, v104
    v_exp_f32 v105, v105
    s_waitcnt lgkmcnt(2)
    v_mfma_f32_32x32x16_bf16 v[64:79], v[168:171], v[184:187], v[64:79]
    v_exp_f32 v106, v106
    v_exp_f32 v107, v107
    v_exp_f32 v108, v108
    v_exp_f32 v109, v109
    v_exp_f32 v110, v110
    v_exp_f32 v111, v111
    v_cvt_pk_bf16_f32 v188, v104, v105
    v_cvt_pk_bf16_f32 v189, v106, v107
    v_cvt_pk_bf16_f32 v190, v108, v109
    v_cvt_pk_bf16_f32 v191, v110, v111
    v_mfma_f32_32x32x16_bf16 v[96:111], v[144:147], v[160:163], v[32:47]
    v_mad_u32_u24 v6, v28, 5, v29
    v_mfma_f32_32x32x16_bf16 v[64:79], v[172:175], v[188:191], v[64:79]
    ds_read_b128 v[168:171], v6
    ds_read_b128 v[172:175], v6 offset:512
    v_exp_f32 v112, v112
    v_exp_f32 v113, v113
    v_exp_f32 v114, v114
    v_exp_f32 v115, v115
    v_exp_f32 v116, v116
    v_exp_f32 v117, v117
    v_exp_f32 v118, v118
    v_exp_f32 v119, v119
    v_cvt_pk_bf16_f32 v184, v112, v113
    v_cvt_pk_bf16_f32 v185, v114, v115
    v_cvt_pk_bf16_f32 v186, v116, v117
    v_cvt_pk_bf16_f32 v187, v118, v119
    v_exp_f32 v120, v120
    v_exp_f32 v121, v121
    s_waitcnt lgkmcnt(2)
    v_mfma_f32_32x32x16_bf16 v[64:79], v[176:179], v[184:187], v[64:79]
    v_exp_f32 v122, v122
    v_exp_f32 v123, v123
    v_exp_f32 v124, v124
    v_exp_f32 v125, v125
    v_exp_f32 v126, v126
    v_exp_f32 v127, v127
    v_cvt_pk_bf16_f32 v188, v120, v121
    v_cvt_pk_bf16_f32 v189, v122, v123
    v_cvt_pk_bf16_f32 v190, v124, v125
    v_cvt_pk_bf16_f32 v191, v126, v127
    v_mfma_f32_32x32x16_bf16 v[112:127], v[148:151], v[164:167], v[208:223]
    v_mad_u32_u24 v6, v28, 6, v29
    v_mfma_f32_32x32x16_bf16 v[64:79], v[180:183], v[188:191], v[64:79]
    ds_read_b128 v[176:179], v6
    ds_read_b128 v[180:183], v6 offset:512
    v_exp_f32 v96, v96
    v_exp_f32 v97, v97
    v_exp_f32 v98, v98
    v_exp_f32 v99, v99
    v_exp_f32 v100, v100
    v_exp_f32 v101, v101
    v_exp_f32 v102, v102
    v_exp_f32 v103, v103
    v_cvt_pk_bf16_f32 v184, v96, v97
    v_cvt_pk_bf16_f32 v185, v98, v99
    v_cvt_pk_bf16_f32 v186, v100, v101
    v_cvt_pk_bf16_f32 v187, v102, v103
    v_exp_f32 v104, v104
    v_exp_f32 v105, v105
    s_waitcnt lgkmcnt(2)
    v_mfma_f32_32x32x16_bf16 v[64:79], v[168:171], v[184:187], v[64:79]
    v_exp_f32 v106, v106
    v_exp_f32 v107, v107
    v_exp_f32 v108, v108
    v_exp_f32 v109, v109
    v_exp_f32 v110, v110
    v_exp_f32 v111, v111
    v_cvt_pk_bf16_f32 v188, v104, v105
    v_cvt_pk_bf16_f32 v189, v106, v107
    v_cvt_pk_bf16_f32 v190, v108, v109
    v_cvt_pk_bf16_f32 v191, v110, v111
    v_mfma_f32_32x32x16_bf16 v[96:111], v[148:151], v[160:163], v[32:47]
    v_mad_u32_u24 v6, v28, 6, v29
    v_mfma_f32_32x32x16_bf16 v[64:79], v[172:175], v[188:191], v[64:79]
    ds_read_b128 v[168:171], v6
    ds_read_b128 v[172:175], v6 offset:512
    v_exp_f32 v112, v112
    v_exp_f32 v113, v113
    v_exp_f32 v114, v114
    v_exp_f32 v115, v115
    v_exp_f32 v116, v116
    v_exp_f32 v117, v117
    v_exp_f32 v118, v118
    v_exp_f32 v119, v119
    v_cvt_pk_bf16_f32 v184, v112, v113
    v_cvt_pk_bf16_f32 v185, v114, v115
    v_cvt_pk_bf16_f32 v186, v116, v117
    v_cvt_pk_bf16_f32 v187, v118, v119
    v_exp_f32 v120, v120
    v_exp_f32 v121, v121
    s_waitcnt lgkmcnt(2)
    v_mfma_f32_32x32x16_bf16 v[80:95], v[176:179], v[184:187], v[80:95]
    v_exp_f32 v122, v122
    v_exp_f32 v123, v123
    v_exp_f32 v124, v124
    v_exp_f32 v125, v125
    v_exp_f32 v126, v126
    v_exp_f32 v127, v127
    v_cvt_pk_bf16_f32 v188, v120, v121
    v_cvt_pk_bf16_f32 v189, v122, v123
    v_cvt_pk_bf16_f32 v190, v124, v125
    v_cvt_pk_bf16_f32 v191, v126, v127
    v_mfma_f32_32x32x16_bf16 v[112:127], v[152:155], v[164:167], v[48:63]
    v_mad_u32_u24 v6, v28, 7, v29
    v_mfma_f32_32x32x16_bf16 v[80:95], v[180:183], v[188:191], v[80:95]
    ds_read_b128 v[176:179], v6
    ds_read_b128 v[180:183], v6 offset:512
    v_exp_f32 v96, v96
    v_exp_f32 v97, v97
    v_exp_f32 v98, v98
    v_exp_f32 v99, v99
    v_exp_f32 v100, v100
    v_exp_f32 v101, v101
    v_exp_f32 v102, v102
    v_exp_f32 v103, v103
    v_cvt_pk_bf16_f32 v184, v96, v97
    v_cvt_pk_bf16_f32 v185, v98, v99
    v_cvt_pk_bf16_f32 v186, v100, v101
    v_cvt_pk_bf16_f32 v187, v102, v103
    v_exp_f32 v104, v104
    v_exp_f32 v105, v105
    s_waitcnt lgkmcnt(2)
    v_mfma_f32_32x32x16_bf16 v[64:79], v[168:171], v[184:187], v[64:79]
    v_exp_f32 v106, v106
    v_exp_f32 v107, v107
    v_exp_f32 v108, v108
    v_exp_f32 v109, v109
    v_exp_f32 v110, v110
    v_exp_f32 v111, v111
    v_cvt_pk_bf16_f32 v188, v104, v105
    v_cvt_pk_bf16_f32 v189, v106, v107
    v_cvt_pk_bf16_f32 v190, v108, v109
    v_cvt_pk_bf16_f32 v191, v110, v111
    v_mfma_f32_32x32x16_bf16 v[96:111], v[152:155], v[160:163], v[32:47]
    v_mad_u32_u24 v6, v28, 7, v29
    v_mfma_f32_32x32x16_bf16 v[64:79], v[172:175], v[188:191], v[64:79]
    ds_read_b128 v[168:171], v6
    ds_read_b128 v[172:175], v6 offset:512
    v_exp_f32 v112, v112
    v_exp_f32 v113, v113
    v_exp_f32 v114, v114
    v_exp_f32 v115, v115
    v_exp_f32 v116, v116
    v_exp_f32 v117, v117
    v_exp_f32 v118, v118
    v_exp_f32 v119, v119
    v_cvt_pk_bf16_f32 v184, v112, v113
    v_cvt_pk_bf16_f32 v185, v114, v115
    v_cvt_pk_bf16_f32 v186, v116, v117
    v_cvt_pk_bf16_f32 v187, v118, v119
    v_exp_f32 v120, v120
    v_exp_f32 v121, v121
    s_waitcnt lgkmcnt(2)
    v_mfma_f32_32x32x16_bf16 v[80:95], v[176:179], v[184:187], v[80:95]
    v_exp_f32 v122, v122
    v_exp_f32 v123, v123
    v_exp_f32 v124, v124
    v_exp_f32 v125, v125
    v_exp_f32 v126, v126
    v_exp_f32 v127, v127
    v_cvt_pk_bf16_f32 v188, v120, v121
    v_cvt_pk_bf16_f32 v189, v122, v123
    v_cvt_pk_bf16_f32 v190, v124, v125
    v_cvt_pk_bf16_f32 v191, v126, v127
    s_nop 1
    v_mfma_f32_32x32x16_bf16 v[80:95], v[180:183], v[188:191], v[80:95]
    v_exp_f32 v96, v96
    v_exp_f32 v97, v97
    v_exp_f32 v98, v98
    v_exp_f32 v99, v99
    v_exp_f32 v100, v100
    v_exp_f32 v101, v101
    v_exp_f32 v102, v102
    v_exp_f32 v103, v103
    v_cvt_pk_bf16_f32 v184, v96, v97
    v_cvt_pk_bf16_f32 v185, v98, v99
    v_cvt_pk_bf16_f32 v186, v100, v101
    v_cvt_pk_bf16_f32 v187, v102, v103
    v_exp_f32 v104, v104
    v_exp_f32 v105, v105
    s_waitcnt lgkmcnt(0)
    v_mfma_f32_32x32x16_bf16 v[64:79], v[168:171], v[184:187], v[64:79]
    v_exp_f32 v106, v106
    v_exp_f32 v107, v107
    v_exp_f32 v108, v108
    v_exp_f32 v109, v109
    v_exp_f32 v110, v110
    v_exp_f32 v111, v111
    v_cvt_pk_bf16_f32 v188, v104, v105
    v_cvt_pk_bf16_f32 v189, v106, v107
    v_cvt_pk_bf16_f32 v190, v108, v109
    v_cvt_pk_bf16_f32 v191, v110, v111
    s_nop 1
    v_mfma_f32_32x32x16_bf16 v[64:79], v[172:175], v[188:191], v[64:79]
    s_branch L_attd_31
L_att2_29:
    ds_read_b128 v[128:131], v4 offset:4096
    ds_read_b128 v[132:135], v4 offset:6144
    ds_read_b128 v[136:139], v4 offset:8192
    ds_read_b128 v[140:143], v4 offset:10240
    ds_read_b128 v[144:147], v4 offset:12288
    ds_read_b128 v[148:151], v4 offset:14336
    s_waitcnt lgkmcnt(5)
    v_mfma_f32_32x32x16_bf16 v[96:111], v[128:131], v[160:163], v[224:239]
    s_waitcnt lgkmcnt(4)
    v_mfma_f32_32x32x16_bf16 v[112:127], v[132:135], v[160:163], 0
    v_mad_u32_u24 v6, v28, 2, v29
    ds_read_b128 v[168:171], v6
    ds_read_b128 v[172:175], v6 offset:512
    v_mad_u32_u24 v6, v28, 3, v29
    ds_read_b128 v[176:179], v6
    ds_read_b128 v[180:183], v6 offset:512
    s_waitcnt lgkmcnt(7)
    v_mfma_f32_32x32x16_bf16 v[192:207], v[136:139], v[160:163], 0
    s_nop 1
    v_max3_f32 v20, v96, v97, v98
    v_max3_f32 v21, v99, v100, v101
    v_max3_f32 v20, v20, v102, v103
    v_max3_f32 v21, v21, v104, v105
    v_max3_f32 v20, v20, v106, v107
    v_max3_f32 v21, v21, v108, v109
    v_max3_f32 v20, v20, v110, v111
    s_waitcnt lgkmcnt(6)
    v_mfma_f32_32x32x16_bf16 v[96:111], v[140:143], v[164:167], v[224:239]
    v_max3_f32 v20, v20, v112, v113
    v_max3_f32 v21, v21, v114, v115
    v_max3_f32 v20, v20, v116, v117
    v_max3_f32 v21, v21, v118, v119
    v_max3_f32 v20, v20, v120, v121
    v_max3_f32 v21, v21, v122, v123
    v_max3_f32 v20, v20, v124, v125
    v_max3_f32 v21, v21, v126, v127
    v_mfma_f32_32x32x16_bf16 v[112:127], v[140:143], v[160:163], 0
    v_max3_f32 v20, v20, v192, v193
    v_max3_f32 v21, v21, v194, v195
    v_max3_f32 v20, v20, v196, v197
    v_max3_f32 v21, v21, v198, v199
    v_max3_f32 v20, v20, v200, v201
    v_max3_f32 v21, v21, v202, v203
    v_max3_f32 v20, v20, v204, v205
    v_max3_f32 v21, v21, v206, v207
    s_waitcnt lgkmcnt(5)
    v_mfma_f32_32x32x16_bf16 v[192:207], v[144:147], v[164:167], 0
    v_max3_f32 v22, v96, v97, v98
    v_max3_f32 v23, v99, v100, v101
    v_max3_f32 v22, v22, v102, v103
    v_max3_f32 v23, v23, v104, v105
    v_max3_f32 v22, v22, v106, v107
    v_max3_f32 v23, v23, v108, v109
    v_max3_f32 v22, v22, v110, v111
    v_mfma_f32_32x32x16_bf16 v[96:111], v[144:147], v[160:163], 0
    v_max3_f32 v20, v20, v112, v113
    v_max3_f32 v21, v21, v114, v115
    v_max3_f32 v20, v20, v116, v117
    v_max3_f32 v21, v21, v118, v119
    v_max3_f32 v20, v20, v120, v121
    v_max3_f32 v21, v21, v122, v123
    v_max3_f32 v20, v20, v124, v125
    v_max3_f32 v21, v21, v126, v127
    s_waitcnt lgkmcnt(4)
    v_mfma_f32_32x32x16_bf16 v[112:127], v[148:151], v[164:167], 0
    v_max3_f32 v22, v22, v192, v193
    v_max3_f32 v23, v23, v194, v195
    v_max3_f32 v22, v22, v196, v197
    v_max3_f32 v23, v23, v198, v199
    v_max3_f32 v22, v22, v200, v201
    v_max3_f32 v23, v23, v202, v203
    v_max3_f32 v22, v22, v204, v205
    v_max3_f32 v23, v23, v206, v207
    v_mfma_f32_32x32x16_bf16 v[192:207], v[148:151], v[160:163], 0
    v_max3_f32 v20, v20, v96, v97
    v_max3_f32 v21, v21, v98, v99
    v_max3_f32 v20, v20, v100, v101
    v_max3_f32 v21, v21, v102, v103
    v_max3_f32 v20, v20, v104, v105
    v_max3_f32 v21, v21, v106, v107
    v_max3_f32 v20, v20, v108, v109
    v_max3_f32 v21, v21, v110, v111
    v_max3_f32 v22, v22, v112, v113
    v_max3_f32 v23, v23, v114, v115
    v_max3_f32 v22, v22, v116, v117
    v_max3_f32 v23, v23, v118, v119
    v_max3_f32 v22, v22, v120, v121
    v_max3_f32 v23, v23, v122, v123
    v_max3_f32 v22, v22, v124, v125
    v_max3_f32 v23, v23, v126, v127
    v_max3_f32 v20, v20, v192, v193
    v_max3_f32 v21, v21, v194, v195
    v_max3_f32 v20, v20, v196, v197
    v_max3_f32 v21, v21, v198, v199
    v_max3_f32 v20, v20, v200, v201
    v_max3_f32 v21, v21, v202, v203
    v_max3_f32 v20, v20, v204, v205
    v_max3_f32 v21, v21, v206, v207
    v_max_f32 v20, v20, v21
    v_max_f32 v22, v22, v23
    v_mov_b32 v21, v20
    v_mov_b32 v23, v22
    s_nop 0
    v_permlane32_swap_b32 v20, v21
    v_permlane32_swap_b32 v22, v23
    v_max3_f32 v20, v20, v21, v12
    v_max3_f32 v22, v22, v23, v14
    v_sub_f32 v24, v12, v20
    v_sub_f32 v26, v14, v22
    v_exp_f32 v24, v24
    v_exp_f32 v26, v26
    v_mov_b32 v12, v20
    v_mov_b32 v14, v22
    v_sub_f32 v20, 0, v12
    v_sub_f32 v22, 0, v14
    v_mov_b32 v21, v20
    v_mov_b32 v23, v22
    v_pk_add_f32 v[192:193], v[224:225], v[20:21]
    v_pk_add_f32 v[194:195], v[226:227], v[20:21]
    v_pk_add_f32 v[196:197], v[228:229], v[20:21]
    v_pk_add_f32 v[198:199], v[230:231], v[20:21]
    v_pk_add_f32 v[200:201], v[232:233], v[20:21]
    v_pk_add_f32 v[202:203], v[234:235], v[20:21]
    v_pk_add_f32 v[204:205], v[236:237], v[20:21]
    v_pk_add_f32 v[206:207], v[238:239], v[20:21]
    v_pk_mov_b32 v[32:33], v[20:21], v[20:21] op_sel:[0,0]
    v_pk_mov_b32 v[34:35], v[20:21], v[20:21] op_sel:[0,0]
    v_pk_mov_b32 v[36:37], v[20:21], v[20:21] op_sel:[0,0]
    v_pk_mov_b32 v[38:39], v[20:21], v[20:21] op_sel:[0,0]
    v_pk_mov_b32 v[40:41], v[20:21], v[20:21] op_sel:[0,0]
    v_pk_mov_b32 v[42:43], v[20:21], v[20:21] op_sel:[0,0]
    v_pk_mov_b32 v[44:45], v[20:21], v[20:21] op_sel:[0,0]
    v_pk_mov_b32 v[46:47], v[20:21], v[20:21] op_sel:[0,0]
    v_mfma_f32_32x32x16_bf16 v[96:111], v[128:131], v[160:163], v[192:207]
    v_pk_mul_f32 v[64:65], v[64:65], v[24:25] op_sel_hi:[1,0]
    v_pk_mul_f32 v[66:67], v[66:67], v[24:25] op_sel_hi:[1,0]
    v_pk_mul_f32 v[68:69], v[68:69], v[24:25] op_sel_hi:[1,0]
    v_pk_mul_f32 v[70:71], v[70:71], v[24:25] op_sel_hi:[1,0]
    v_mul_f32 v72, v72, v24
    v_pk_mul_f32 v[80:81], v[80:81], v[26:27] op_sel_hi:[1,0]
    v_pk_mul_f32 v[82:83], v[82:83], v[26:27] op_sel_hi:[1,0]
    v_pk_mul_f32 v[84:85], v[84:85], v[26:27] op_sel_hi:[1,0]
    v_pk_mul_f32 v[86:87], v[86:87], v[26:27] op_sel_hi:[1,0]
    v_mul_f32 v88, v88, v26
    v_mfma_f32_32x32x16_bf16 v[112:127], v[132:135], v[160:163], v[32:47]
    v_pk_add_f32 v[208:209], v[224:225], v[22:23]
    v_pk_add_f32 v[210:211], v[226:227], v[22:23]
    v_pk_add_f32 v[212:213], v[228:229], v[22:23]
    v_pk_add_f32 v[214:215], v[230:231], v[22:23]
    v_pk_add_f32 v[216:217], v[232:233], v[22:23]
    v_pk_add_f32 v[218:219], v[234:235], v[22:23]
    v_pk_add_f32 v[220:221], v[236:237], v[22:23]
    v_pk_add_f32 v[222:223], v[238:239], v[22:23]
    v_pk_mov_b32 v[48:49], v[22:23], v[22:23] op_sel:[0,0]
    v_pk_mov_b32 v[50:51], v[22:23], v[22:23] op_sel:[0,0]
    v_pk_mov_b32 v[52:53], v[22:23], v[22:23] op_sel:[0,0]
    v_pk_mov_b32 v[54:55], v[22:23], v[22:23] op_sel:[0,0]
    v_pk_mov_b32 v[56:57], v[22:23], v[22:23] op_sel:[0,0]
    v_pk_mov_b32 v[58:59], v[22:23], v[22:23] op_sel:[0,0]
    v_pk_mov_b32 v[60:61], v[22:23], v[22:23] op_sel:[0,0]
    v_pk_mov_b32 v[62:63], v[22:23], v[22:23] op_sel:[0,0]
    v_exp_f32 v96, v96
    v_exp_f32 v97, v97
    v_exp_f32 v98, v98
    v_exp_f32 v99, v99
    v_exp_f32 v100, v100
    v_exp_f32 v101, v101
    v_exp_f32 v102, v102
    v_exp_f32 v103, v103
    v_cvt_pk_bf16_f32 v184, v96, v97
    v_cvt_pk_bf16_f32 v185, v98, v99
    v_cvt_pk_bf16_f32 v186, v100, v101
    v_cvt_pk_bf16_f32 v187, v102, v103
    v_exp_f32 v104, v104
    v_exp_f32 v105, v105
    s_waitcnt lgkmcnt(2)
    v_mfma_f32_32x32x16_bf16 v[64:79], v[168:171], v[184:187], v[64:79]
    v_exp_f32 v106, v106
    v_exp_f32 v107, v107
    v_exp_f32 v108, v108
    v_exp_f32 v109, v109
    v_exp_f32 v110, v110
    v_exp_f32 v111, v111
    v_cvt_pk_bf16_f32 v188, v104, v105
    v_cvt_pk_bf16_f32 v189, v106, v107
    v_cvt_pk_bf16_f32 v190, v108, v109
    v_cvt_pk_bf16_f32 v191, v110, v111
    v_mfma_f32_32x32x16_bf16 v[96:111], v[136:139], v[160:163], v[32:47]
    v_mad_u32_u24 v6, v28, 4, v29
    v_mfma_f32_32x32x16_bf16 v[64:79], v[172:175], v[188:191], v[64:79]
    ds_read_b128 v[168:171], v6
    ds_read_b128 v[172:175], v6 offset:512
    v_exp_f32 v112, v112
    v_exp_f32 v113, v113
    v_exp_f32 v114, v114
    v_exp_f32 v115, v115
    v_exp_f32 v116, v116
    v_exp_f32 v117, v117
    v_exp_f32 v118, v118
    v_exp_f32 v119, v119
    v_cvt_pk_bf16_f32 v184, v112, v113
    v_cvt_pk_bf16_f32 v185, v114, v115
    v_cvt_pk_bf16_f32 v186, v116, v117
    v_cvt_pk_bf16_f32 v187, v118, v119
    v_exp_f32 v120, v120
    v_exp_f32 v121, v121
    s_waitcnt lgkmcnt(2)
    v_mfma_f32_32x32x16_bf16 v[64:79], v[176:179], v[184:187], v[64:79]
    v_exp_f32 v122, v122
    v_exp_f32 v123, v123
    v_exp_f32 v124, v124
    v_exp_f32 v125, v125
    v_exp_f32 v126, v126
    v_exp_f32 v127, v127
    v_cvt_pk_bf16_f32 v188, v120, v121
    v_cvt_pk_bf16_f32 v189, v122, v123
    v_cvt_pk_bf16_f32 v190, v124, v125
    v_cvt_pk_bf16_f32 v191, v126, v127
    v_mfma_f32_32x32x16_bf16 v[112:127], v[140:143], v[164:167], v[208:223]
    v_mad_u32_u24 v6, v28, 5, v29
    v_mfma_f32_32x32x16_bf16 v[64:79], v[180:183], v[188:191], v[64:79]
    ds_read_b128 v[176:179], v6
    ds_read_b128 v[180:183], v6 offset:512
    v_exp_f32 v96, v96
    v_exp_f32 v97, v97
    v_exp_f32 v98, v98
    v_exp_f32 v99, v99
    v_exp_f32 v100, v100
    v_exp_f32 v101, v101
    v_exp_f32 v102, v102
    v_exp_f32 v103, v103
    v_cvt_pk_bf16_f32 v184, v96, v97
    v_cvt_pk_bf16_f32 v185, v98, v99
    v_cvt_pk_bf16_f32 v186, v100, v101
    v_cvt_pk_bf16_f32 v187, v102, v103
    v_exp_f32 v104, v104
    v_exp_f32 v105, v105
    s_waitcnt lgkmcnt(2)
    v_mfma_f32_32x32x16_bf16 v[64:79], v[168:171], v[184:187], v[64:79]
    v_exp_f32 v106, v106
    v_exp_f32 v107, v107
    v_exp_f32 v108, v108
    v_exp_f32 v109, v109
    v_exp_f32 v110, v110
    v_exp_f32 v111, v111
    v_cvt_pk_bf16_f32 v188, v104, v105
    v_cvt_pk_bf16_f32 v189, v106, v107
    v_cvt_pk_bf16_f32 v190, v108, v109
    v_cvt_pk_bf16_f32 v191, v110, v111
    v_mfma_f32_32x32x16_bf16 v[96:111], v[140:143], v[160:163], v[32:47]
    v_mad_u32_u24 v6, v28, 5, v29
    v_mfma_f32_32x32x16_bf16 v[64:79], v[172:175], v[188:191], v[64:79]
    ds_read_b128 v[168:171], v6
    ds_read_b128 v[172:175], v6 offset:512
    v_exp_f32 v112, v112
    v_exp_f32 v113, v113
    v_exp_f32 v114, v114
    v_exp_f32 v115, v115
    v_exp_f32 v116, v116
    v_exp_f32 v117, v117
    v_exp_f32 v118, v118
    v_exp_f32 v119, v119
    v_cvt_pk_bf16_f32 v184, v112, v113
    v_cvt_pk_bf16_f32 v185, v114, v115
    v_cvt_pk_bf16_f32 v186, v116, v117
    v_cvt_pk_bf16_f32 v187, v118, v119
    v_exp_f32 v120, v120
    v_exp_f32 v121, v121
    s_waitcnt lgkmcnt(2)
    v_mfma_f32_32x32x16_bf16 v[80:95], v[176:179], v[184:187], v[80:95]
    v_exp_f32 v122, v122
    v_exp_f32 v123, v123
    v_exp_f32 v124, v124
    v_exp_f32 v125, v125
    v_exp_f32 v126, v126
    v_exp_f32 v127, v127
    v_cvt_pk_bf16_f32 v188, v120, v121
    v_cvt_pk_bf16_f32 v189, v122, v123
    v_cvt_pk_bf16_f32 v190, v124, v125
    v_cvt_pk_bf16_f32 v191, v126, v127
    v_mfma_f32_32x32x16_bf16 v[112:127], v[144:147], v[164:167], v[48:63]
    v_mad_u32_u24 v6, v28, 6, v29
    v_mfma_f32_32x32x16_bf16 v[80:95], v[180:183], v[188:191], v[80:95]
    ds_read_b128 v[176:179], v6
    ds_read_b128 v[180:183], v6 offset:512
    v_exp_f32 v96, v96
    v_exp_f32 v97, v97
    v_exp_f32 v98, v98
    v_exp_f32 v99, v99
    v_exp_f32 v100, v100
    v_exp_f32 v101, v101
    v_exp_f32 v102, v102
    v_exp_f32 v103, v103
    v_cvt_pk_bf16_f32 v184, v96, v97
    v_cvt_pk_bf16_f32 v185, v98, v99
    v_cvt_pk_bf16_f32 v186, v100, v101
    v_cvt_pk_bf16_f32 v187, v102, v103
    v_exp_f32 v104, v104
    v_exp_f32 v105, v105
    s_waitcnt lgkmcnt(2)
    v_mfma_f32_32x32x16_bf16 v[64:79], v[168:171], v[184:187], v[64:79]
    v_exp_f32 v106, v106
    v_exp_f32 v107, v107
    v_exp_f32 v108, v108
    v_exp_f32 v109, v109
    v_exp_f32 v110, v110
    v_exp_f32 v111, v111
    v_cvt_pk_bf16_f32 v188, v104, v105
    v_cvt_pk_bf16_f32 v189, v106, v107
    v_cvt_pk_bf16_f32 v190, v108, v109
    v_cvt_pk_bf16_f32 v191, v110, v111
    v_mfma_f32_32x32x16_bf16 v[96:111], v[144:147], v[160:163], v[32:47]
    v_mad_u32_u24 v6, v28, 6, v29
    v_mfma_f32_32x32x16_bf16 v[64:79], v[172:175], v[188:191], v[64:79]
    ds_read_b128 v[168:171], v6
    ds_read_b128 v[172:175], v6 offset:512
    v_exp_f32 v112, v112
    v_exp_f32 v113, v113
    v_exp_f32 v114, v114
    v_exp_f32 v115, v115
    v_exp_f32 v116, v116
    v_exp_f32 v117, v117
    v_exp_f32 v118, v118
    v_exp_f32 v119, v119
    v_cvt_pk_bf16_f32 v184, v112, v113
    v_cvt_pk_bf16_f32 v185, v114, v115
    v_cvt_pk_bf16_f32 v186, v116, v117
    v_cvt_pk_bf16_f32 v187, v118, v119
    v_exp_f32 v120, v120
    v_exp_f32 v121, v121
    s_waitcnt lgkmcnt(2)
    v_mfma_f32_32x32x16_bf16 v[80:95], v[176:179], v[184:187], v[80:95]
    v_exp_f32 v122, v122
    v_exp_f32 v123, v123
    v_exp_f32 v124, v124
    v_exp_f32 v125, v125
    v_exp_f32 v126, v126
    v_exp_f32 v127, v127
    v_cvt_pk_bf16_f32 v188, v120, v121
    v_cvt_pk_bf16_f32 v189, v122, v123
    v_cvt_pk_bf16_f32 v190, v124, v125
    v_cvt_pk_bf16_f32 v191, v126, v127
    v_mfma_f32_32x32x16_bf16 v[112:127], v[148:151], v[164:167], v[48:63]
    v_mad_u32_u24 v6, v28, 7, v29
    v_mfma_f32_32x32x16_bf16 v[80:95], v[180:183], v[188:191], v[80:95]
    ds_read_b128 v[176:179], v6
    ds_read_b128 v[180:183], v6 offset:512
    v_exp_f32 v96, v96
    v_exp_f32 v97, v97
    v_exp_f32 v98, v98
    v_exp_f32 v99, v99
    v_exp_f32 v100, v100
    v_exp_f32 v101, v101
    v_exp_f32 v102, v102
    v_exp_f32 v103, v103
    v_cvt_pk_bf16_f32 v184, v96, v97
    v_cvt_pk_bf16_f32 v185, v98, v99
    v_cvt_pk_bf16_f32 v186, v100, v101
    v_cvt_pk_bf16_f32 v187, v102, v103
    v_exp_f32 v104, v104
    v_exp_f32 v105, v105
    s_waitcnt lgkmcnt(2)
    v_mfma_f32_32x32x16_bf16 v[64:79], v[168:171], v[184:187], v[64:79]
    v_exp_f32 v106, v106
    v_exp_f32 v107, v107
    v_exp_f32 v108, v108
    v_exp_f32 v109, v109
    v_exp_f32 v110, v110
    v_exp_f32 v111, v111
    v_cvt_pk_bf16_f32 v188, v104, v105
    v_cvt_pk_bf16_f32 v189, v106, v107
    v_cvt_pk_bf16_f32 v190, v108, v109
    v_cvt_pk_bf16_f32 v191, v110, v111
    v_mfma_f32_32x32x16_bf16 v[96:111], v[148:151], v[160:163], v[32:47]
    v_mad_u32_u24 v6, v28, 7, v29
    v_mfma_f32_32x32x16_bf16 v[64:79], v[172:175], v[188:191], v[64:79]
    ds_read_b128 v[168:171], v6
    ds_read_b128 v[172:175], v6 offset:512
    v_exp_f32 v112, v112
    v_exp_f32 v113, v113
    v_exp_f32 v114, v114
    v_exp_f32 v115, v115
    v_exp_f32 v116, v116
    v_exp_f32 v117, v117
    v_exp_f32 v118, v118
    v_exp_f32 v119, v119
    v_cvt_pk_bf16_f32 v184, v112, v113
    v_cvt_pk_bf16_f32 v185, v114, v115
    v_cvt_pk_bf16_f32 v186, v116, v117
    v_cvt_pk_bf16_f32 v187, v118, v119
    v_exp_f32 v120, v120
    v_exp_f32 v121, v121
    s_waitcnt lgkmcnt(2)
    v_mfma_f32_32x32x16_bf16 v[80:95], v[176:179], v[184:187], v[80:95]
    v_exp_f32 v122, v122
    v_exp_f32 v123, v123
    v_exp_f32 v124, v124
    v_exp_f32 v125, v125
    v_exp_f32 v126, v126
    v_exp_f32 v127, v127
    v_cvt_pk_bf16_f32 v188, v120, v121
    v_cvt_pk_bf16_f32 v189, v122, v123
    v_cvt_pk_bf16_f32 v190, v124, v125
    v_cvt_pk_bf16_f32 v191, v126, v127
    s_nop 1
    v_mfma_f32_32x32x16_bf16 v[80:95], v[180:183], v[188:191], v[80:95]
    v_exp_f32 v96, v96
    v_exp_f32 v97, v97
    v_exp_f32 v98, v98
    v_exp_f32 v99, v99
    v_exp_f32 v100, v100
    v_exp_f32 v101, v101
    v_exp_f32 v102, v102
    v_exp_f32 v103, v103
    v_cvt_pk_bf16_f32 v184, v96, v97
    v_cvt_pk_bf16_f32 v185, v98, v99
    v_cvt_pk_bf16_f32 v186, v100, v101
    v_cvt_pk_bf16_f32 v187, v102, v103
    v_exp_f32 v104, v104
    v_exp_f32 v105, v105
    s_waitcnt lgkmcnt(0)
    v_mfma_f32_32x32x16_bf16 v[64:79], v[168:171], v[184:187], v[64:79]
    v_exp_f32 v106, v106
    v_exp_f32 v107, v107
    v_exp_f32 v108, v108
    v_exp_f32 v109, v109
    v_exp_f32 v110, v110
    v_exp_f32 v111, v111
    v_cvt_pk_bf16_f32 v188, v104, v105
    v_cvt_pk_bf16_f32 v189, v106, v107
    v_cvt_pk_bf16_f32 v190, v108, v109
    v_cvt_pk_bf16_f32 v191, v110, v111
    s_nop 1
    v_mfma_f32_32x32x16_bf16 v[64:79], v[172:175], v[188:191], v[64:79]
    s_branch L_attd_31
L_att3_30:
    ds_read_b128 v[128:131], v4 offset:6144
    ds_read_b128 v[132:135], v4 offset:8192
    ds_read_b128 v[136:139], v4 offset:10240
    ds_read_b128 v[140:143], v4 offset:12288
    ds_read_b128 v[144:147], v4 offset:14336
    s_waitcnt lgkmcnt(4)
    v_mfma_f32_32x32x16_bf16 v[96:111], v[128:131], v[160:163], v[224:239]
    s_waitcnt lgkmcnt(3)
    v_mfma_f32_32x32x16_bf16 v[112:127], v[132:135], v[164:167], v[224:239]
    v_mad_u32_u24 v6, v28, 3, v29
    ds_read_b128 v[168:171], v6
    ds_read_b128 v[172:175], v6 offset:512
    v_mad_u32_u24 v6, v28, 4, v29
    ds_read_b128 v[176:179], v6
    ds_read_b128 v[180:183], v6 offset:512
    v_mfma_f32_32x32x16_bf16 v[192:207], v[132:135], v[160:163], 0
    s_nop 2
    v_max3_f32 v20, v96, v97, v98
    v_max3_f32 v21, v99, v100, v101
    v_max3_f32 v20, v20, v102, v103
    v_max3_f32 v21, v21, v104, v105
    v_max3_f32 v20, v20, v106, v107
    v_max3_f32 v21, v21, v108, v109
    v_max3_f32 v20, v20, v110, v111
    s_waitcnt lgkmcnt(6)
    v_mfma_f32_32x32x16_bf16 v[96:111], v[136:139], v[164:167], 0
    v_max3_f32 v22, v112, v113, v114
    v_max3_f32 v23, v115, v116, v117
    v_max3_f32 v22, v22, v118, v119
    v_max3_f32 v23, v23, v120, v121
    v_max3_f32 v22, v22, v122, v123
    v_max3_f32 v23, v23, v124, v125
    v_max3_f32 v22, v22, v126, v127
    v_mfma_f32_32x32x16_bf16 v[112:127], v[136:139], v[160:163], 0
    v_max3_f32 v20, v20, v192, v193
    v_max3_f32 v21, v21, v194, v195
    v_max3_f32 v20, v20, v196, v197
    v_max3_f32 v21, v21, v198, v199
    v_max3_f32 v20, v20, v200, v201
    v_max3_f32 v21, v21, v202, v203
    v_max3_f32 v20, v20, v204, v205
    v_max3_f32 v21, v21, v206, v207
    s_waitcnt lgkmcnt(5)
    v_mfma_f32_32x32x16_bf16 v[192:207], v[140:143], v[164:167], 0
    v_max3_f32 v22, v22, v96, v97
    v_max3_f32 v23, v23, v98, v99
    v_max3_f32 v22, v22, v100, v101
    v_max3_f32 v23, v23, v102, v103
    v_max3_f32 v22, v22, v104, v105
    v_max3_f32 v23, v23, v106, v107
    v_max3_f32 v22, v22, v108, v109
    v_max3_f32 v23, v23, v110, v111
    v_mfma_f32_32x32x16_bf16 v[96:111], v[140:143], v[160:163], 0
    v_max3_f32 v20, v20, v112, v113
    v_max3_f32 v21, v21, v114, v115
    v_max3_f32 v20, v20, v116, v117
    v_max3_f32 v21, v21, v118, v119
    v_max3_f32 v20, v20, v120, v121
    v_max3_f32 v21, v21, v122, v123
    v_max3_f32 v20, v20, v124, v125
    v_max3_f32 v21, v21, v126, v127
    s_waitcnt lgkmcnt(4)
    v_mfma_f32_32x32x16_bf16 v[112:127], v[144:147], v[164:167], 0
    v_max3_f32 v22, v22, v192, v193
    v_max3_f32 v23, v23, v194, v195
    v_max3_f32 v22, v22, v196, v197
    v_max3_f32 v23, v23, v198, v199
    v_max3_f32 v22, v22, v200, v201
    v_max3_f32 v23, v23, v202, v203
    v_max3_f32 v22, v22, v204, v205
    v_max3_f32 v23, v23, v206, v207
    v_mfma_f32_32x32x16_bf16 v[192:207], v[144:147], v[160:163], 0
    v_max3_f32 v20, v20, v96, v97
    v_max3_f32 v21, v21, v98, v99
    v_max3_f32 v20, v20, v100, v101
    v_max3_f32 v21, v21, v102, v103
    v_max3_f32 v20, v20, v104, v105
    v_max3_f32 v21, v21, v106, v107
    v_max3_f32 v20, v20, v108, v109
    v_max3_f32 v21, v21, v110, v111
    v_max3_f32 v22, v22, v112, v113
    v_max3_f32 v23, v23, v114, v115
    v_max3_f32 v22, v22, v116, v117
    v_max3_f32 v23, v23, v118, v119
    v_max3_f32 v22, v22, v120, v121
    v_max3_f32 v23, v23, v122, v123
    v_max3_f32 v22, v22, v124, v125
    v_max3_f32 v23, v23, v126, v127
    v_max3_f32 v20, v20, v192, v193
    v_max3_f32 v21, v21, v194, v195
    v_max3_f32 v20, v20, v196, v197
    v_max3_f32 v21, v21, v198, v199
    v_max3_f32 v20, v20, v200, v201
    v_max3_f32 v21, v21, v202, v203
    v_max3_f32 v20, v20, v204, v205
    v_max3_f32 v21, v21, v206, v207
    v_max_f32 v20, v20, v21
    v_max_f32 v22, v22, v23
    v_mov_b32 v21, v20
    v_mov_b32 v23, v22
    s_nop 0
    v_permlane32_swap_b32 v20, v21
    v_permlane32_swap_b32 v22, v23
    v_max3_f32 v20, v20, v21, v12
    v_max3_f32 v22, v22, v23, v14
    v_sub_f32 v24, v12, v20
    v_sub_f32 v26, v14, v22
    v_exp_f32 v24, v24
    v_exp_f32 v26, v26
    v_mov_b32 v12, v20
    v_mov_b32 v14, v22
    v_sub_f32 v20, 0, v12
    v_sub_f32 v22, 0, v14
    v_mov_b32 v21, v20
    v_mov_b32 v23, v22
    v_pk_add_f32 v[192:193], v[224:225], v[20:21]
    v_pk_add_f32 v[194:195], v[226:227], v[20:21]
    v_pk_add_f32 v[196:197], v[228:229], v[20:21]
    v_pk_add_f32 v[198:199], v[230:231], v[20:21]
    v_pk_add_f32 v[200:201], v[232:233], v[20:21]
    v_pk_add_f32 v[202:203], v[234:235], v[20:21]
    v_pk_add_f32 v[204:205], v[236:237], v[20:21]
    v_pk_add_f32 v[206:207], v[238:239], v[20:21]
    v_pk_add_f32 v[208:209], v[224:225], v[22:23]
    v_pk_add_f32 v[210:211], v[226:227], v[22:23]
    v_pk_add_f32 v[212:213], v[228:229], v[22:23]
    v_pk_add_f32 v[214:215], v[230:231], v[22:23]
    v_pk_add_f32 v[216:217], v[232:233], v[22:23]
    v_pk_add_f32 v[218:219], v[234:235], v[22:23]
    v_pk_add_f32 v[220:221], v[236:237], v[22:23]
    v_pk_add_f32 v[222:223], v[238:239], v[22:23]
    v_mfma_f32_32x32x16_bf16 v[96:111], v[128:131], v[160:163], v[192:207]
    v_pk_mul_f32 v[64:65], v[64:65], v[24:25] op_sel_hi:[1,0]
    v_pk_mul_f32 v[66:67], v[66:67], v[24:25] op_sel_hi:[1,0]
    v_pk_mul_f32 v[68:69], v[68:69], v[24:25] op_sel_hi:[1,0]
    v_pk_mul_f32 v[70:71], v[70:71], v[24:25] op_sel_hi:[1,0]
    v_mul_f32 v72, v72, v24
    v_pk_mul_f32 v[80:81], v[80:81], v[26:27] op_sel_hi:[1,0]
    v_pk_mul_f32 v[82:83], v[82:83], v[26:27] op_sel_hi:[1,0]
    v_pk_mul_f32 v[84:85], v[84:85], v[26:27] op_sel_hi:[1,0]
    v_pk_mul_f32 v[86:87], v[86:87], v[26:27] op_sel_hi:[1,0]
    v_mul_f32 v88, v88, v26
    v_mfma_f32_32x32x16_bf16 v[112:127], v[132:135], v[164:167], v[208:223]
    v_pk_mov_b32 v[32:33], v[20:21], v[20:21] op_sel:[0,0]
    v_pk_mov_b32 v[34:35], v[20:21], v[20:21] op_sel:[0,0]
    v_pk_mov_b32 v[36:37], v[20:21], v[20:21] op_sel:[0,0]
    v_pk_mov_b32 v[38:39], v[20:21], v[20:21] op_sel:[0,0]
    v_pk_mov_b32 v[40:41], v[20:21], v[20:21] op_sel:[0,0]
    v_pk_mov_b32 v[42:43], v[20:21], v[20:21] op_sel:[0,0]
    v_pk_mov_b32 v[44:45], v[20:21], v[20:21] op_sel:[0,0]
    v_pk_mov_b32 v[46:47], v[20:21], v[20:21] op_sel:[0,0]
    v_pk_mov_b32 v[48:49], v[22:23], v[22:23] op_sel:[0,0]
    v_pk_mov_b32 v[50:51], v[22:23], v[22:23] op_sel:[0,0]
    v_pk_mov_b32 v[52:53], v[22:23], v[22:23] op_sel:[0,0]
    v_pk_mov_b32 v[54:55], v[22:23], v[22:23] op_sel:[0,0]
    v_pk_mov_b32 v[56:57], v[22:23], v[22:23] op_sel:[0,0]
    v_pk_mov_b32 v[58:59], v[22:23], v[22:23] op_sel:[0,0]
    v_pk_mov_b32 v[60:61], v[22:23], v[22:23] op_sel:[0,0]
    v_pk_mov_b32 v[62:63], v[22:23], v[22:23] op_sel:[0,0]
    v_exp_f32 v96, v96
    v_exp_f32 v97, v97
    v_exp_f32 v98, v98
    v_exp_f32 v99, v99
    v_exp_f32 v100, v100
    v_exp_f32 v101, v101
    v_exp_f32 v102, v102
    v_exp_f32 v103, v103
    v_cvt_pk_bf16_f32 v184, v96, v97
    v_cvt_pk_bf16_f32 v185, v98, v99
    v_cvt_pk_bf16_f32 v186, v100, v101
    v_cvt_pk_bf16_f32 v187, v102, v103
    v_exp_f32 v104, v104
    v_exp_f32 v105, v105
    s_waitcnt lgkmcnt(2)
    v_mfma_f32_32x32x16_bf16 v[64:79], v[168:171], v[184:187], v[64:79]
    v_exp_f32 v106, v106
    v_exp_f32 v107, v107
    v_exp_f32 v108, v108
    v_exp_f32 v109, v109
    v_exp_f32 v110, v110
    v_exp_f32 v111, v111
    v_cvt_pk_bf16_f32 v188, v104, v105
    v_cvt_pk_bf16_f32 v189, v106, v107
    v_cvt_pk_bf16_f32 v190, v108, v109
    v_cvt_pk_bf16_f32 v191, v110, v111
    v_mfma_f32_32x32x16_bf16 v[96:111], v[132:135], v[160:163], v[32:47]
    v_mad_u32_u24 v6, v28, 4, v29
    v_mfma_f32_32x32x16_bf16 v[64:79], v[172:175], v[188:191], v[64:79]
    ds_read_b128 v[168:171], v6
    ds_read_b128 v[172:175], v6 offset:512
    v_exp_f32 v112, v112
    v_exp_f32 v113, v113
    v_exp_f32 v114, v114
    v_exp_f32 v115, v115
    v_exp_f32 v116, v116
    v_exp_f32 v117, v117
    v_exp_f32 v118, v118
    v_exp_f32 v119, v119
    v_cvt_pk_bf16_f32 v184, v112, v113
    v_cvt_pk_bf16_f32 v185, v114, v115
    v_cvt_pk_bf16_f32 v186, v116, v117
    v_cvt_pk_bf16_f32 v187, v118, v119
    v_exp_f32 v120, v120
    v_exp_f32 v121, v121
    s_waitcnt lgkmcnt(2)
    v_mfma_f32_32x32x16_bf16 v[80:95], v[176:179], v[184:187], v[80:95]
    v_exp_f32 v122, v122
    v_exp_f32 v123, v123
    v_exp_f32 v124, v124
    v_exp_f32 v125, v125
    v_exp_f32 v126, v126
    v_exp_f32 v127, v127
    v_cvt_pk_bf16_f32 v188, v120, v121
    v_cvt_pk_bf16_f32 v189, v122, v123
    v_cvt_pk_bf16_f32 v190, v124, v125
    v_cvt_pk_bf16_f32 v191, v126, v127
    v_mfma_f32_32x32x16_bf16 v[112:127], v[136:139], v[164:167], v[48:63]
    v_mad_u32_u24 v6, v28, 5, v29
    v_mfma_f32_32x32x16_bf16 v[80:95], v[180:183], v[188:191], v[80:95]
    ds_read_b128 v[176:179], v6
    ds_read_b128 v[180:183], v6 offset:512
    v_exp_f32 v96, v96
    v_exp_f32 v97, v97
    v_exp_f32 v98, v98
    v_exp_f32 v99, v99
    v_exp_f32 v100, v100
    v_exp_f32 v101, v101
    v_exp_f32 v102, v102
    v_exp_f32 v103, v103
    v_cvt_pk_bf16_f32 v184, v96, v97
    v_cvt_pk_bf16_f32 v185, v98, v99
    v_cvt_pk_bf16_f32 v186, v100, v101
    v_cvt_pk_bf16_f32 v187, v102, v103
    v_exp_f32 v104, v104
    v_exp_f32 v105, v105
    s_waitcnt lgkmcnt(2)
    v_mfma_f32_32x32x16_bf16 v[64:79], v[168:171], v[184:187], v[64:79]
    v_exp_f32 v106, v106
    v_exp_f32 v107, v107
    v_exp_f32 v108, v108
    v_exp_f32 v109, v109
    v_exp_f32 v110, v110
    v_exp_f32 v111, v111
    v_cvt_pk_bf16_f32 v188, v104, v105
    v_cvt_pk_bf16_f32 v189, v106, v107
    v_cvt_pk_bf16_f32 v190, v108, v109
    v_cvt_pk_bf16_f32 v191, v110, v111
    v_mfma_f32_32x32x16_bf16 v[96:111], v[136:139], v[160:163], v[32:47]
    v_mad_u32_u24 v6, v28, 5, v29
    v_mfma_f32_32x32x16_bf16 v[64:79], v[172:175], v[188:191], v[64:79]
    ds_read_b128 v[168:171], v6
    ds_read_b128 v[172:175], v6 offset:512
    v_exp_f32 v112, v112
    v_exp_f32 v113, v113
    v_exp_f32 v114, v114
    v_exp_f32 v115, v115
    v_exp_f32 v116, v116
    v_exp_f32 v117, v117
    v_exp_f32 v118, v118
    v_exp_f32 v119, v119
    v_cvt_pk_bf16_f32 v184, v112, v113
    v_cvt_pk_bf16_f32 v185, v114, v115
    v_cvt_pk_bf16_f32 v186, v116, v117
    v_cvt_pk_bf16_f32 v187, v118, v119
    v_exp_f32 v120, v120
    v_exp_f32 v121, v121
    s_waitcnt lgkmcnt(2)
    v_mfma_f32_32x32x16_bf16 v[80:95], v[176:179], v[184:187], v[80:95]
    v_exp_f32 v122, v122
    v_exp_f32 v123, v123
    v_exp_f32 v124, v124
    v_exp_f32 v125, v125
    v_exp_f32 v126, v126
    v_exp_f32 v127, v127
    v_cvt_pk_bf16_f32 v188, v120, v121
    v_cvt_pk_bf16_f32 v189, v122, v123
    v_cvt_pk_bf16_f32 v190, v124, v125
    v_cvt_pk_bf16_f32 v191, v126, v127
    v_mfma_f32_32x32x16_bf16 v[112:127], v[140:143], v[164:167], v[48:63]
    v_mad_u32_u24 v6, v28, 6, v29
    v_mfma_f32_32x32x16_bf16 v[80:95], v[180:183], v[188:191], v[80:95]
    ds_read_b128 v[176:179], v6
    ds_read_b128 v[180:183], v6 offset:512
    v_exp_f32 v96, v96
    v_exp_f32 v97, v97
    v_exp_f32 v98, v98
    v_exp_f32 v99, v99
    v_exp_f32 v100, v100
    v_exp_f32 v101, v101
    v_exp_f32 v102, v102
    v_exp_f32 v103, v103
    v_cvt_pk_bf16_f32 v184, v96, v97
    v_cvt_pk_bf16_f32 v185, v98, v99
    v_cvt_pk_bf16_f32 v186, v100, v101
    v_cvt_pk_bf16_f32 v187, v102, v103
    v_exp_f32 v104, v104
    v_exp_f32 v105, v105
    s_waitcnt lgkmcnt(2)
    v_mfma_f32_32x32x16_bf16 v[64:79], v[168:171], v[184:187], v[64:79]
    v_exp_f32 v106, v106
    v_exp_f32 v107, v107
    v_exp_f32 v108, v108
    v_exp_f32 v109, v109
    v_exp_f32 v110, v110
    v_exp_f32 v111, v111
    v_cvt_pk_bf16_f32 v188, v104, v105
    v_cvt_pk_bf16_f32 v189, v106, v107
    v_cvt_pk_bf16_f32 v190, v108, v109
    v_cvt_pk_bf16_f32 v191, v110, v111
    v_mfma_f32_32x32x16_bf16 v[96:111], v[140:143], v[160:163], v[32:47]
    v_mad_u32_u24 v6, v28, 6, v29
    v_mfma_f32_32x32x16_bf16 v[64:79], v[172:175], v[188:191], v[64:79]
    ds_read_b128 v[168:171], v6
    ds_read_b128 v[172:175], v6 offset:512
    v_exp_f32 v112, v112
    v_exp_f32 v113, v113
    v_exp_f32 v114, v114
    v_exp_f32 v115, v115
    v_exp_f32 v116, v116
    v_exp_f32 v117, v117
    v_exp_f32 v118, v118
    v_exp_f32 v119, v119
    v_cvt_pk_bf16_f32 v184, v112, v113
    v_cvt_pk_bf16_f32 v185, v114, v115
    v_cvt_pk_bf16_f32 v186, v116, v117
    v_cvt_pk_bf16_f32 v187, v118, v119
    v_exp_f32 v120, v120
    v_exp_f32 v121, v121
    s_waitcnt lgkmcnt(2)
    v_mfma_f32_32x32x16_bf16 v[80:95], v[176:179], v[184:187], v[80:95]
    v_exp_f32 v122, v122
    v_exp_f32 v123, v123
    v_exp_f32 v124, v124
    v_exp_f32 v125, v125
    v_exp_f32 v126, v126
    v_exp_f32 v127, v127
    v_cvt_pk_bf16_f32 v188, v120, v121
    v_cvt_pk_bf16_f32 v189, v122, v123
    v_cvt_pk_bf16_f32 v190, v124, v125
    v_cvt_pk_bf16_f32 v191, v126, v127
    v_mfma_f32_32x32x16_bf16 v[112:127], v[144:147], v[164:167], v[48:63]
    v_mad_u32_u24 v6, v28, 7, v29
    v_mfma_f32_32x32x16_bf16 v[80:95], v[180:183], v[188:191], v[80:95]
    ds_read_b128 v[176:179], v6
    ds_read_b128 v[180:183], v6 offset:512
    v_exp_f32 v96, v96
    v_exp_f32 v97, v97
    v_exp_f32 v98, v98
    v_exp_f32 v99, v99
    v_exp_f32 v100, v100
    v_exp_f32 v101, v101
    v_exp_f32 v102, v102
    v_exp_f32 v103, v103
    v_cvt_pk_bf16_f32 v184, v96, v97
    v_cvt_pk_bf16_f32 v185, v98, v99
    v_cvt_pk_bf16_f32 v186, v100, v101
    v_cvt_pk_bf16_f32 v187, v102, v103
    v_exp_f32 v104, v104
    v_exp_f32 v105, v105
    s_waitcnt lgkmcnt(2)
    v_mfma_f32_32x32x16_bf16 v[64:79], v[168:171], v[184:187], v[64:79]
    v_exp_f32 v106, v106
    v_exp_f32 v107, v107
    v_exp_f32 v108, v108
    v_exp_f32 v109, v109
    v_exp_f32 v110, v110
    v_exp_f32 v111, v111
    v_cvt_pk_bf16_f32 v188, v104, v105
    v_cvt_pk_bf16_f32 v189, v106, v107
    v_cvt_pk_bf16_f32 v190, v108, v109
    v_cvt_pk_bf16_f32 v191, v110, v111
    v_mfma_f32_32x32x16_bf16 v[96:111], v[144:147], v[160:163], v[32:47]
    v_mad_u32_u24 v6, v28, 7, v29
    v_mfma_f32_32x32x16_bf16 v[64:79], v[172:175], v[188:191], v[64:79]
    ds_read_b128 v[168:171], v6
    ds_read_b128 v[172:175], v6 offset:512
    v_exp_f32 v112, v112
    v_exp_f32 v113, v113
    v_exp_f32 v114, v114
    v_exp_f32 v115, v115
    v_exp_f32 v116, v116
    v_exp_f32 v117, v117
    v_exp_f32 v118, v118
    v_exp_f32 v119, v119
    v_cvt_pk_bf16_f32 v184, v112, v113
    v_cvt_pk_bf16_f32 v185, v114, v115
    v_cvt_pk_bf16_f32 v186, v116, v117
    v_cvt_pk_bf16_f32 v187, v118, v119
    v_exp_f32 v120, v120
    v_exp_f32 v121, v121
    s_waitcnt lgkmcnt(2)
    v_mfma_f32_32x32x16_bf16 v[80:95], v[176:179], v[184:187], v[80:95]
    v_exp_f32 v122, v122
    v_exp_f32 v123, v123
    v_exp_f32 v124, v124
    v_exp_f32 v125, v125
    v_exp_f32 v126, v126
    v_exp_f32 v127, v127
    v_cvt_pk_bf16_f32 v188, v120, v121
    v_cvt_pk_bf16_f32 v189, v122, v123
    v_cvt_pk_bf16_f32 v190, v124, v125
    v_cvt_pk_bf16_f32 v191, v126, v127
    s_nop 1
    v_mfma_f32_32x32x16_bf16 v[80:95], v[180:183], v[188:191], v[80:95]
    v_exp_f32 v96, v96
    v_exp_f32 v97, v97
    v_exp_f32 v98, v98
    v_exp_f32 v99, v99
    v_exp_f32 v100, v100
    v_exp_f32 v101, v101
    v_exp_f32 v102, v102
    v_exp_f32 v103, v103
    v_cvt_pk_bf16_f32 v184, v96, v97
    v_cvt_pk_bf16_f32 v185, v98, v99
    v_cvt_pk_bf16_f32 v186, v100, v101
    v_cvt_pk_bf16_f32 v187, v102, v103
    v_exp_f32 v104, v104
    v_exp_f32 v105, v105
    s_waitcnt lgkmcnt(0)
    v_mfma_f32_32x32x16_bf16 v[64:79], v[168:171], v[184:187], v[64:79]
    v_exp_f32 v106, v106
    v_exp_f32 v107, v107
    v_exp_f32 v108, v108
    v_exp_f32 v109, v109
    v_exp_f32 v110, v110
    v_exp_f32 v111, v111
    v_cvt_pk_bf16_f32 v188, v104, v105
    v_cvt_pk_bf16_f32 v189, v106, v107
    v_cvt_pk_bf16_f32 v190, v108, v109
    v_cvt_pk_bf16_f32 v191, v110, v111
    s_nop 1
    v_mfma_f32_32x32x16_bf16 v[64:79], v[172:175], v[188:191], v[64:79]
L_attd_31:
L_nohalo_26:
    s_nop 11
    s_lshl_b32 s56, s41, 10
    s_mul_i32 s57, s50, 32768
    s_add_u32 s57, s57, s56
    s_add_u32 s57, s57, 4718592
    s_add_u32 s57, s57, s94
    s_mul_i32 s58, s51, 32768
    s_add_u32 s58, s58, s56
    s_add_u32 s58, s58, 4718592
    s_add_u32 s58, s58, s94
    v_rcp_f32 v20, v72
    s_nop 0
    v_pk_mul_f32 v[64:65], v[64:65], v[20:21] op_sel_hi:[1,0]
    v_pk_mul_f32 v[66:67], v[66:67], v[20:21] op_sel_hi:[1,0]
    v_pk_mul_f32 v[68:69], v[68:69], v[20:21] op_sel_hi:[1,0]
    v_pk_mul_f32 v[70:71], v[70:71], v[20:21] op_sel_hi:[1,0]
    v_cvt_pk_bf16_f32 v184, v64, v65
    v_cvt_pk_bf16_f32 v185, v66, v67
    v_cvt_pk_bf16_f32 v186, v68, v69
    v_cvt_pk_bf16_f32 v187, v70, v71
    buffer_store_dwordx4 v[184:187], v8, s[4:7], s57 offen
    v_rcp_f32 v20, v88
    s_nop 0
    v_pk_mul_f32 v[80:81], v[80:81], v[20:21] op_sel_hi:[1,0]
    v_pk_mul_f32 v[82:83], v[82:83], v[20:21] op_sel_hi:[1,0]
    v_pk_mul_f32 v[84:85], v[84:85], v[20:21] op_sel_hi:[1,0]
    v_pk_mul_f32 v[86:87], v[86:87], v[20:21] op_sel_hi:[1,0]
    v_cvt_pk_bf16_f32 v188, v80, v81
    v_cvt_pk_bf16_f32 v189, v82, v83
    v_cvt_pk_bf16_f32 v190, v84, v85
    v_cvt_pk_bf16_f32 v191, v86, v87
    buffer_store_dwordx4 v[188:191], v8, s[4:7], s58 offen
    s_waitcnt vmcnt(0)
    s_barrier
    s_cmp_eq_u32 s42, 0
    s_cbranch_scc0 L_nosig_32
    s_lshl_b32 s46, s40, 8
    s_add_u32 s46, s46, 41943040
    s_add_u32 s46, s46, s95
    s_lshl_b32 s47, s41, 2
    v_mov_b32 v5, s47
    v_mov_b32 v6, s97
    s_mov_b64 exec, 1
    s_cmp_eq_u32 s43, 0
    s_cbranch_scc0 L_slowsig_33
    buffer_store_dword v6, v5, s[4:7], s46 offen
    s_branch L_sigdone_34
L_slowsig_33:
    buffer_wbl2 sc1
    s_waitcnt vmcnt(0)
    buffer_store_dword v6, v5, s[4:7], s46 offen sc1
L_sigdone_34:
    s_mov_b64 exec, -1
L_nosig_32:
    s_lshr_b32 s50, s41, 3
    s_lshl_b32 s50, s50, 1
    s_and_b32 s51, s42, 1
    s_add_u32 s50, s50, s51
    s_lshl_b32 s51, s40, 3
    s_add_u32 s50, s50, s51
    s_and_b32 s51, s41, 7
    s_lshr_b32 s52, s42, 1
    v_lshlrev_b32 v8, 4, v0
    s_mul_i32 s53, s50, 32768
    s_lshl_b32 s54, s51, 12
    s_add_u32 s53, s53, s54
    s_lshl_b32 s54, s52, 11
    s_add_u32 s53, s53, s54
    s_add_u32 s54, s53, 0
    s_add_u32 s54, s54, s94
    buffer_load_dwordx4 v[128:131], v8, s[4:7], s54 offen sc1
    buffer_load_dwordx4 v[132:135], v8, s[4:7], s54 offen offset:1024 sc1
    s_lshl_b32 s55, s52, 15
    s_add_u32 s55, s55, 65536
    v_lshrrev_b32 v4, 5, v0
    v_lshlrev_b32 v4, 2, v4
    v_bfe_u32 v1, v0, 2, 2
    v_add_u32 v1, v1, v4
    v_bfe_u32 v2, v0, 4, 1
    v_and_b32 v3, 3, v0
    v_lshlrev_b32 v3, 3, v3
    v_bfe_u32 v4, v1, 1, 1
    v_xor_b32 v4, s52, v4
    v_lshlrev_b32 v9, 7, v1
    v_lshl_add_u32 v9, v4, 6, v9
    v_lshl_add_u32 v9, v2, 5, v9
    v_add_u32 v9, v9, v3
    v_add_u32 v9, s55, v9
    v_xor_b32 v10, 64, v9
    ds_read_b64_tr_b16 v[136:137], v9 offset:0
    ds_read_b64_tr_b16 v[138:139], v9 offset:1024
    ds_read_b64_tr_b16 v[140:141], v10 offset:0
    ds_read_b64_tr_b16 v[142:143], v10 offset:1024
    ds_read_b64_tr_b16 v[144:145], v9 offset:2048
    ds_read_b64_tr_b16 v[146:147], v9 offset:3072
    ds_read_b64_tr_b16 v[148:149], v10 offset:2048
    ds_read_b64_tr_b16 v[150:151], v10 offset:3072
    s_waitcnt vmcnt(0)
    v_lshlrev_b32 v32, 16, v128
    v_and_b32 v33, 0xffff0000, v128
    v_lshlrev_b32 v34, 16, v129
    v_and_b32 v35, 0xffff0000, v129
    v_lshlrev_b32 v36, 16, v130
    v_and_b32 v37, 0xffff0000, v130
    v_lshlrev_b32 v38, 16, v131
    v_and_b32 v39, 0xffff0000, v131
    v_lshlrev_b32 v40, 16, v132
    v_and_b32 v41, 0xffff0000, v132
    v_lshlrev_b32 v42, 16, v133
    v_and_b32 v43, 0xffff0000, v133
    v_lshlrev_b32 v44, 16, v134
    v_and_b32 v45, 0xffff0000, v134
    v_lshlrev_b32 v46, 16, v135
    v_and_b32 v47, 0xffff0000, v135
    s_mul_i32 s56, s50, 32768
    s_lshl_b32 s57, s52, 14
    s_add_u32 s56, s56, s57
    s_add_u32 s56, s56, 4718592
    s_add_u32 s56, s56, s94
    s_mov_b32 s60, s56
    s_lshl_b32 s46, s40, 8
    s_add_u32 s46, s46, 41943040
    s_add_u32 s46, s46, s95
    v_lshlrev_b32 v5, 2, v0
    s_mov_b32 exec_lo, 0xffffffff
    s_mov_b32 exec_hi, 0x0
    s_mov_b32 s45, 0
L_poll_35:
    buffer_load_dword v6, v5, s[4:7], s46 offen sc1
    s_waitcnt vmcnt(0)
    v_subrev_u32 v6, s97, v6
    v_cmp_gt_u32 vcc, 2, v6
    s_cmp_eq_u64 vcc, exec
    s_cbranch_scc1 L_polldone_36
    s_add_u32 s45, s45, 1
    s_cmp_lt_u32 s45, 200000
    s_cbranch_scc1 L_poll_35
    v_mov_b32 v6, 100
    v_mov_b32 v7, 20
    buffer_store_dword v6, v7, s[36:39], 0 offen
    s_waitcnt vmcnt(0)
L_polldone_36:
    s_mov_b64 exec, -1
    s_cmp_eq_u32 s43, 0
    s_cbranch_scc1 L_noinv_37
    buffer_inv sc1
    s_waitcnt vmcnt(0)
L_noinv_37:
    buffer_load_dwordx4 v[64:67], v8, s[4:7], s60 offen offset:0 sc1
    buffer_load_dwordx4 v[68:71], v8, s[4:7], s60 offen offset:1024 sc1
    buffer_load_dwordx4 v[72:75], v8, s[4:7], s60 offen offset:2048 sc1
    buffer_load_dwordx4 v[76:79], v8, s[4:7], s60 offen offset:3072 sc1
    s_add_u32 s60, s60, 4096
    buffer_load_dwordx4 v[80:83], v8, s[4:7], s60 offen offset:0 sc1
    buffer_load_dwordx4 v[84:87], v8, s[4:7], s60 offen offset:1024 sc1
    s_waitcnt vmcnt(5)
    s_waitcnt lgkmcnt(4)
    v_mfma_f32_32x32x16_bf16 v[32:47], v[136:139], v[64:67], v[32:47]
    ds_read_b64_tr_b16 v[152:153], v9 offset:4096
    ds_read_b64_tr_b16 v[154:155], v9 offset:5120
    buffer_load_dwordx4 v[88:91], v8, s[4:7], s60 offen offset:2048 sc1
    v_mfma_f32_32x32x16_bf16 v[48:63], v[140:143], v[64:67], 0
    ds_read_b64_tr_b16 v[156:157], v10 offset:4096
    ds_read_b64_tr_b16 v[158:159], v10 offset:5120
    buffer_load_dwordx4 v[92:95], v8, s[4:7], s60 offen offset:3072 sc1
    s_waitcnt vmcnt(6)
    s_waitcnt lgkmcnt(4)
    v_mfma_f32_32x32x16_bf16 v[32:47], v[144:147], v[68:71], v[32:47]
    ds_read_b64_tr_b16 v[136:137], v9 offset:6144
    ds_read_b64_tr_b16 v[138:139], v9 offset:7168
    s_add_u32 s60, s60, 4096
    buffer_load_dwordx4 v[96:99], v8, s[4:7], s60 offen offset:0 sc1
    v_mfma_f32_32x32x16_bf16 v[48:63], v[148:151], v[68:71], v[48:63]
    ds_read_b64_tr_b16 v[140:141], v10 offset:6144
    ds_read_b64_tr_b16 v[142:143], v10 offset:7168
    buffer_load_dwordx4 v[100:103], v8, s[4:7], s60 offen offset:1024 sc1
    s_waitcnt vmcnt(7)
    s_waitcnt lgkmcnt(4)
    v_mfma_f32_32x32x16_bf16 v[32:47], v[152:155], v[72:75], v[32:47]
    ds_read_b64_tr_b16 v[144:145], v9 offset:8192
    ds_read_b64_tr_b16 v[146:147], v9 offset:9216
    buffer_load_dwordx4 v[104:107], v8, s[4:7], s60 offen offset:2048 sc1
    v_mfma_f32_32x32x16_bf16 v[48:63], v[156:159], v[72:75], v[48:63]
    ds_read_b64_tr_b16 v[148:149], v10 offset:8192
    ds_read_b64_tr_b16 v[150:151], v10 offset:9216
    buffer_load_dwordx4 v[108:111], v8, s[4:7], s60 offen offset:3072 sc1
    s_waitcnt vmcnt(8)
    s_waitcnt lgkmcnt(4)
    v_mfma_f32_32x32x16_bf16 v[32:47], v[136:139], v[76:79], v[32:47]
    ds_read_b64_tr_b16 v[152:153], v9 offset:10240
    ds_read_b64_tr_b16 v[154:155], v9 offset:11264
    s_add_u32 s60, s60, 4096
    buffer_load_dwordx4 v[112:115], v8, s[4:7], s60 offen offset:0 sc1
    v_mfma_f32_32x32x16_bf16 v[48:63], v[140:143], v[76:79], v[48:63]
    ds_read_b64_tr_b16 v[156:157], v10 offset:10240
    ds_read_b64_tr_b16 v[158:159], v10 offset:11264
    buffer_load_dwordx4 v[116:119], v8, s[4:7], s60 offen offset:1024 sc1
    s_waitcnt vmcnt(9)
    s_waitcnt lgkmcnt(4)
    v_mfma_f32_32x32x16_bf16 v[32:47], v[144:147], v[80:83], v[32:47]
    ds_read_b64_tr_b16 v[136:137], v9 offset:12288
    ds_read_b64_tr_b16 v[138:139], v9 offset:13312
    buffer_load_dwordx4 v[120:123], v8, s[4:7], s60 offen offset:2048 sc1
    v_mfma_f32_32x32x16_bf16 v[48:63], v[148:151], v[80:83], v[48:63]
    ds_read_b64_tr_b16 v[140:141], v10 offset:12288
    ds_read_b64_tr_b16 v[142:143], v10 offset:13312
    buffer_load_dwordx4 v[124:127], v8, s[4:7], s60 offen offset:3072 sc1
    s_waitcnt vmcnt(10)
    s_waitcnt lgkmcnt(4)
    v_mfma_f32_32x32x16_bf16 v[32:47], v[152:155], v[84:87], v[32:47]
    ds_read_b64_tr_b16 v[144:145], v9 offset:14336
    ds_read_b64_tr_b16 v[146:147], v9 offset:15360
    v_mfma_f32_32x32x16_bf16 v[48:63], v[156:159], v[84:87], v[48:63]
    ds_read_b64_tr_b16 v[148:149], v10 offset:14336
    ds_read_b64_tr_b16 v[150:151], v10 offset:15360
    s_waitcnt vmcnt(9)
    s_waitcnt lgkmcnt(4)
    v_mfma_f32_32x32x16_bf16 v[32:47], v[136:139], v[88:91], v[32:47]
    ds_read_b64_tr_b16 v[152:153], v9 offset:16384
    ds_read_b64_tr_b16 v[154:155], v9 offset:17408
    v_mfma_f32_32x32x16_bf16 v[48:63], v[140:143], v[88:91], v[48:63]
    ds_read_b64_tr_b16 v[156:157], v10 offset:16384
    ds_read_b64_tr_b16 v[158:159], v10 offset:17408
    s_waitcnt vmcnt(8)
    s_waitcnt lgkmcnt(4)
    v_mfma_f32_32x32x16_bf16 v[32:47], v[144:147], v[92:95], v[32:47]
    ds_read_b64_tr_b16 v[136:137], v9 offset:18432
    ds_read_b64_tr_b16 v[138:139], v9 offset:19456
    v_mfma_f32_32x32x16_bf16 v[48:63], v[148:151], v[92:95], v[48:63]
    ds_read_b64_tr_b16 v[140:141], v10 offset:18432
    ds_read_b64_tr_b16 v[142:143], v10 offset:19456
    s_waitcnt vmcnt(7)
    s_waitcnt lgkmcnt(4)
    v_mfma_f32_32x32x16_bf16 v[32:47], v[152:155], v[96:99], v[32:47]
    ds_read_b64_tr_b16 v[144:145], v9 offset:20480
    ds_read_b64_tr_b16 v[146:147], v9 offset:21504
    v_mfma_f32_32x32x16_bf16 v[48:63], v[156:159], v[96:99], v[48:63]
    ds_read_b64_tr_b16 v[148:149], v10 offset:20480
    ds_read_b64_tr_b16 v[150:151], v10 offset:21504
    s_waitcnt vmcnt(6)
    s_waitcnt lgkmcnt(4)
    v_mfma_f32_32x32x16_bf16 v[32:47], v[136:139], v[100:103], v[32:47]
    ds_read_b64_tr_b16 v[152:153], v9 offset:22528
    ds_read_b64_tr_b16 v[154:155], v9 offset:23552
    v_mfma_f32_32x32x16_bf16 v[48:63], v[140:143], v[100:103], v[48:63]
    ds_read_b64_tr_b16 v[156:157], v10 offset:22528
    ds_read_b64_tr_b16 v[158:159], v10 offset:23552
    s_waitcnt vmcnt(5)
    s_waitcnt lgkmcnt(4)
    v_mfma_f32_32x32x16_bf16 v[32:47], v[144:147], v[104:107], v[32:47]
    ds_read_b64_tr_b16 v[136:137], v9 offset:24576
    ds_read_b64_tr_b16 v[138:139], v9 offset:25600
    v_mfma_f32_32x32x16_bf16 v[48:63], v[148:151], v[104:107], v[48:63]
    ds_read_b64_tr_b16 v[140:141], v10 offset:24576
    ds_read_b64_tr_b16 v[142:143], v10 offset:25600
    s_waitcnt vmcnt(4)
    s_waitcnt lgkmcnt(4)
    v_mfma_f32_32x32x16_bf16 v[32:47], v[152:155], v[108:111], v[32:47]
    ds_read_b64_tr_b16 v[144:145], v9 offset:26624
    ds_read_b64_tr_b16 v[146:147], v9 offset:27648
    v_mfma_f32_32x32x16_bf16 v[48:63], v[156:159], v[108:111], v[48:63]
    ds_read_b64_tr_b16 v[148:149], v10 offset:26624
    ds_read_b64_tr_b16 v[150:151], v10 offset:27648
    s_waitcnt vmcnt(3)
    s_waitcnt lgkmcnt(4)
    v_mfma_f32_32x32x16_bf16 v[32:47], v[136:139], v[112:115], v[32:47]
    ds_read_b64_tr_b16 v[152:153], v9 offset:28672
    ds_read_b64_tr_b16 v[154:155], v9 offset:29696
    v_mfma_f32_32x32x16_bf16 v[48:63], v[140:143], v[112:115], v[48:63]
    ds_read_b64_tr_b16 v[156:157], v10 offset:28672
    ds_read_b64_tr_b16 v[158:159], v10 offset:29696
    s_waitcnt vmcnt(2)
    s_waitcnt lgkmcnt(4)
    v_mfma_f32_32x32x16_bf16 v[32:47], v[144:147], v[116:119], v[32:47]
    ds_read_b64_tr_b16 v[136:137], v9 offset:30720
    ds_read_b64_tr_b16 v[138:139], v9 offset:31744
    v_mfma_f32_32x32x16_bf16 v[48:63], v[148:151], v[116:119], v[48:63]
    ds_read_b64_tr_b16 v[140:141], v10 offset:30720
    ds_read_b64_tr_b16 v[142:143], v10 offset:31744
    s_waitcnt vmcnt(1)
    s_waitcnt lgkmcnt(4)
    v_mfma_f32_32x32x16_bf16 v[32:47], v[152:155], v[120:123], v[32:47]
    v_mfma_f32_32x32x16_bf16 v[48:63], v[156:159], v[120:123], v[48:63]
    s_waitcnt vmcnt(0)
    s_waitcnt lgkmcnt(0)
    v_mfma_f32_32x32x16_bf16 v[32:47], v[136:139], v[124:127], v[32:47]
    v_mfma_f32_32x32x16_bf16 v[48:63], v[140:143], v[124:127], v[48:63]
    s_lshl_b32 s56, s42, 12
    s_add_u32 s57, s56, 131072
    s_xor_b32 s56, s56, 0x2000
    s_add_u32 s58, s56, 131072
    v_add_u32 v4, s57, v8
    v_add_u32 v5, s58, v8
    s_nop 5
    ds_write_b128 v4, v[48:51] offset:0
    ds_write_b128 v4, v[52:55] offset:1024
    ds_write_b128 v4, v[56:59] offset:2048
    ds_write_b128 v4, v[60:63] offset:3072
    s_waitcnt lgkmcnt(0)
    s_barrier
    ds_read_b128 v[48:51], v5 offset:0
    ds_read_b128 v[52:55], v5 offset:1024
    ds_read_b128 v[56:59], v5 offset:2048
    ds_read_b128 v[60:63], v5 offset:3072
    s_waitcnt lgkmcnt(3)
    v_pk_add_f32 v[32:33], v[32:33], v[48:49]
    v_pk_add_f32 v[34:35], v[34:35], v[50:51]
    s_waitcnt lgkmcnt(2)
    v_pk_add_f32 v[36:37], v[36:37], v[52:53]
    v_pk_add_f32 v[38:39], v[38:39], v[54:55]
    s_waitcnt lgkmcnt(1)
    v_pk_add_f32 v[40:41], v[40:41], v[56:57]
    v_pk_add_f32 v[42:43], v[42:43], v[58:59]
    s_waitcnt lgkmcnt(0)
    v_pk_add_f32 v[44:45], v[44:45], v[60:61]
    v_pk_add_f32 v[46:47], v[46:47], v[62:63]
    v_cvt_pk_bf16_f32 v16, v32, v33
    v_cvt_pk_bf16_f32 v17, v34, v35
    v_cvt_pk_bf16_f32 v18, v36, v37
    v_cvt_pk_bf16_f32 v19, v38, v39
    v_cvt_pk_bf16_f32 v20, v40, v41
    v_cvt_pk_bf16_f32 v21, v42, v43
    v_cvt_pk_bf16_f32 v22, v44, v45
    v_cvt_pk_bf16_f32 v23, v46, v47
    s_add_u32 s54, s53, 2359296
    s_add_u32 s54, s54, s94
    buffer_store_dwordx4 v[16:19], v8, s[4:7], s54 offen
    buffer_store_dwordx4 v[20:23], v8, s[4:7], s54 offen offset:1024
    v_mov_b32 v26, 0x3f803f80
    v_mov_b32 v24, 0
    v_mov_b32 v25, 0
    v_dot2_f32_bf16 v24, v16, v26, v24
    v_dot2_f32_bf16 v25, v16, v16, v25
    v_dot2_f32_bf16 v24, v17, v26, v24
    v_dot2_f32_bf16 v25, v17, v17, v25
    v_dot2_f32_bf16 v24, v18, v26, v24
    v_dot2_f32_bf16 v25, v18, v18, v25
    v_dot2_f32_bf16 v24, v19, v26, v24
    v_dot2_f32_bf16 v25, v19, v19, v25
    v_dot2_f32_bf16 v24, v20, v26, v24
    v_dot2_f32_bf16 v25, v20, v20, v25
    v_dot2_f32_bf16 v24, v21, v26, v24
    v_dot2_f32_bf16 v25, v21, v21, v25
    v_dot2_f32_bf16 v24, v22, v26, v24
    v_dot2_f32_bf16 v25, v22, v22, v25
    v_dot2_f32_bf16 v24, v23, v26, v24
    v_dot2_f32_bf16 v25, v23, v23, v25
    s_nop 2
    v_permlane32_swap_b32 v24, v25
    v_add_f32 v24, v24, v25
    v_mov_b32 v25, v24
    s_nop 1
    v_permlane32_swap_b32 v24, v25
    s_lshl_b32 s55, s50, 12
    s_lshl_b32 s56, s51, 9
    s_add_u32 s55, s55, s56
    s_lshl_b32 s56, s52, 8
    s_add_u32 s55, s55, s56
    s_add_u32 s55, s55, 14942208
    s_add_u32 s55, s55, s94
    v_mov_b32 v26, v24
    v_mov_b32 v27, v25
    s_nop 0
    v_permlane16_swap_b32 v24, v26
    v_permlane16_swap_b32 v25, v27
    s_mov_b32 exec_lo, 0xffff
    s_mov_b32 exec_hi, 0x0
    buffer_store_dwordx4 v[24:27], v8, s[4:7], s55 offen
    s_mov_b64 exec, -1
    s_waitcnt vmcnt(0)
    s_barrier
    s_cmp_eq_u32 s42, 0
    s_cbranch_scc0 L_nosig_38
    s_lshl_b32 s46, s40, 8
    s_add_u32 s46, s46, 41945088
    s_add_u32 s46, s46, s95
    s_lshl_b32 s47, s41, 2
    v_mov_b32 v5, s47
    v_mov_b32 v6, s97
    s_mov_b64 exec, 1
    s_cmp_eq_u32 s43, 0
    s_cbranch_scc0 L_slowsig_39
    buffer_store_dword v6, v5, s[4:7], s46 offen
    s_branch L_sigdone_40
L_slowsig_39:
    buffer_wbl2 sc1
    s_waitcnt vmcnt(0)
    buffer_store_dword v6, v5, s[4:7], s46 offen sc1
L_sigdone_40:
    s_mov_b64 exec, -1
L_nosig_38:
    s_and_b32 s56, s41, 1
    s_lshl_b32 s57, s56, 2
    s_lshl_b32 s50, s40, 3
    s_add_u32 s50, s50, s42
    s_xor_b32 s58, s57, 4
    s_add_u32 s51, s50, s58
    s_add_u32 s50, s50, s57
    s_mul_i32 s52, s50, 32768
    s_add_u32 s52, s52, 2359296
    s_add_u32 s52, s52, s94
    s_mul_i32 s53, s51, 32768
    s_add_u32 s53, s53, 2359296
    s_add_u32 s53, s53, s94
    v_lshlrev_b32 v8, 4, v0
    v_lshrrev_b32 v4, 5, v0
    v_lshlrev_b32 v4, 2, v4
    v_bfe_u32 v1, v0, 2, 2
    v_add_u32 v1, v1, v4
    v_bfe_u32 v2, v0, 4, 1
    v_and_b32 v3, 3, v0
    v_lshlrev_b32 v3, 3, v3
    v_bfe_u32 v4, v1, 1, 1
    v_lshlrev_b32 v5, 1, v2
    v_xor_b32 v4, v4, v5
    v_lshlrev_b32 v5, 14, v2
    v_lshl_add_u32 v5, v1, 7, v5
    v_add_u32 v5, v5, v3
    s_add_u32 s57, s56, 0
    s_and_b32 s57, s57, 3
    v_xor_b32 v6, s57, v4
    v_lshl_add_u32 v10, v6, 5, v5
    v_add_u32 v14, 0x10000, v10
    s_add_u32 s57, s56, 1
    s_and_b32 s57, s57, 3
    v_xor_b32 v6, s57, v4
    v_lshl_add_u32 v11, v6, 5, v5
    v_add_u32 v15, 0x10000, v11
    s_add_u32 s57, s56, 2
    s_and_b32 s57, s57, 3
    v_xor_b32 v6, s57, v4
    v_lshl_add_u32 v12, v6, 5, v5
    v_add_u32 v16, 0x10000, v12
    s_add_u32 s57, s56, 3
    s_and_b32 s57, s57, 3
    v_xor_b32 v6, s57, v4
    v_lshl_add_u32 v13, v6, 5, v5
    v_add_u32 v17, 0x10000, v13
    ds_read_b64_tr_b16 v[144:145], v10 offset:0
    ds_read_b64_tr_b16 v[146:147], v10 offset:1024
    ds_read_b64_tr_b16 v[148:149], v11 offset:0
    ds_read_b64_tr_b16 v[150:151], v11 offset:1024
    ds_read_b64_tr_b16 v[152:153], v12 offset:0
    ds_read_b64_tr_b16 v[154:155], v12 offset:1024
    ds_read_b64_tr_b16 v[156:157], v13 offset:0
    ds_read_b64_tr_b16 v[158:159], v13 offset:1024
    v_mov_b32 v226, 0
    v_mov_b32 v227, 0
    v_mov_b32 v230, 0
    v_mov_b32 v231, 0
    s_lshl_b32 s62, s50, 12
    s_add_u32 s62, s62, 14942208
    s_add_u32 s62, s62, s94
    s_lshl_b32 s63, s51, 12
    s_add_u32 s63, s63, 14942208
    s_add_u32 s63, s63, s94
    v_mov_b32 v234, 0
    v_mov_b32 v235, 0
    v_mov_b32 v238, 0
    v_mov_b32 v239, 0
    v_mov_b32 v242, 0
    v_mov_b32 v243, 0
    v_mov_b32 v246, 0
    v_mov_b32 v247, 0
    s_lshl_b32 s46, s40, 8
    s_add_u32 s46, s46, 41945088
    s_add_u32 s46, s46, s95
    v_lshlrev_b32 v5, 2, v0
    s_mov_b32 exec_lo, 0xffffffff
    s_mov_b32 exec_hi, 0x0
    s_mov_b32 s45, 0
L_poll_41:
    buffer_load_dword v6, v5, s[4:7], s46 offen sc1
    s_waitcnt vmcnt(0)
    v_subrev_u32 v6, s97, v6
    v_cmp_gt_u32 vcc, 2, v6
    s_cmp_eq_u64 vcc, exec
    s_cbranch_scc1 L_polldone_42
    s_add_u32 s45, s45, 1
    s_cmp_lt_u32 s45, 200000
    s_cbranch_scc1 L_poll_41
    v_mov_b32 v6, 101
    v_mov_b32 v7, 20
    buffer_store_dword v6, v7, s[36:39], 0 offen
    s_waitcnt vmcnt(0)
L_polldone_42:
    s_mov_b64 exec, -1
    s_cmp_eq_u32 s43, 0
    s_cbranch_scc1 L_noinv_43
    buffer_inv sc1
    s_waitcnt vmcnt(0)
L_noinv_43:
    s_add_u32 s54, s52, 0
    s_add_u32 s55, s53, 0
    buffer_load_dwordx4 v[160:163], v8, s[4:7], s54 offen offset:0 sc1
    buffer_load_dwordx4 v[164:167], v8, s[4:7], s55 offen offset:0 sc1
    buffer_load_dwordx4 v[168:171], v8, s[4:7], s54 offen offset:1024 sc1
    buffer_load_dwordx4 v[172:175], v8, s[4:7], s55 offen offset:1024 sc1
    buffer_load_dwordx4 v[176:179], v8, s[4:7], s54 offen offset:2048 sc1
    buffer_load_dwordx4 v[180:183], v8, s[4:7], s55 offen offset:2048 sc1
    s_waitcnt vmcnt(5)
    s_waitcnt lgkmcnt(6)
    v_mfma_f32_32x32x16_bf16 v[32:47], v[144:147], v[160:163], 0
    buffer_load_dwordx4 v[184:187], v8, s[4:7], s54 offen offset:3072 sc1
    s_waitcnt vmcnt(5)
    v_mfma_f32_32x32x16_bf16 v[48:63], v[144:147], v[164:167], 0
    ds_read_b64_tr_b16 v[144:145], v10 offset:2048
    ds_read_b64_tr_b16 v[146:147], v10 offset:3072
    s_waitcnt lgkmcnt(6)
    v_mfma_f32_32x32x16_bf16 v[64:79], v[148:151], v[160:163], 0
    buffer_load_dwordx4 v[188:191], v8, s[4:7], s55 offen offset:3072 sc1
    v_mfma_f32_32x32x16_bf16 v[80:95], v[148:151], v[164:167], 0
    ds_read_b64_tr_b16 v[148:149], v11 offset:2048
    ds_read_b64_tr_b16 v[150:151], v11 offset:3072
    s_waitcnt lgkmcnt(6)
    v_mfma_f32_32x32x16_bf16 v[96:111], v[152:155], v[160:163], 0
    s_add_u32 s54, s52, 4096
    s_add_u32 s55, s53, 4096
    buffer_load_dwordx4 v[192:195], v8, s[4:7], s54 offen offset:0 sc1
    v_mfma_f32_32x32x16_bf16 v[112:127], v[152:155], v[164:167], 0
    ds_read_b64_tr_b16 v[152:153], v12 offset:2048
    ds_read_b64_tr_b16 v[154:155], v12 offset:3072
    s_waitcnt lgkmcnt(6)
    v_mfma_f32_32x32x16_bf16 v[128:143], v[156:159], v[160:163], 0
    ds_read_b64_tr_b16 v[156:157], v13 offset:2048
    ds_read_b64_tr_b16 v[158:159], v13 offset:3072
    buffer_load_dwordx4 v[196:199], v8, s[4:7], s55 offen offset:0 sc1
    s_waitcnt vmcnt(7)
    s_waitcnt lgkmcnt(6)
    v_mfma_f32_32x32x16_bf16 v[32:47], v[144:147], v[168:171], v[32:47]
    buffer_load_dwordx4 v[200:203], v8, s[4:7], s54 offen offset:1024 sc1
    s_waitcnt vmcnt(7)
    v_mfma_f32_32x32x16_bf16 v[48:63], v[144:147], v[172:175], v[48:63]
    ds_read_b64_tr_b16 v[144:145], v10 offset:4096
    ds_read_b64_tr_b16 v[146:147], v10 offset:5120
    s_waitcnt lgkmcnt(6)
    v_mfma_f32_32x32x16_bf16 v[64:79], v[148:151], v[168:171], v[64:79]
    buffer_load_dwordx4 v[204:207], v8, s[4:7], s55 offen offset:1024 sc1
    v_mfma_f32_32x32x16_bf16 v[80:95], v[148:151], v[172:175], v[80:95]
    ds_read_b64_tr_b16 v[148:149], v11 offset:4096
    ds_read_b64_tr_b16 v[150:151], v11 offset:5120
    s_waitcnt lgkmcnt(6)
    v_mfma_f32_32x32x16_bf16 v[96:111], v[152:155], v[168:171], v[96:111]
    buffer_load_dwordx4 v[208:211], v8, s[4:7], s54 offen offset:2048 sc1
    v_mfma_f32_32x32x16_bf16 v[112:127], v[152:155], v[172:175], v[112:127]
    ds_read_b64_tr_b16 v[152:153], v12 offset:4096
    ds_read_b64_tr_b16 v[154:155], v12 offset:5120
    s_waitcnt lgkmcnt(6)
    v_mfma_f32_32x32x16_bf16 v[128:143], v[156:159], v[168:171], v[128:143]
    ds_read_b64_tr_b16 v[156:157], v13 offset:4096
    ds_read_b64_tr_b16 v[158:159], v13 offset:5120
    buffer_load_dwordx4 v[212:215], v8, s[4:7], s55 offen offset:2048 sc1
    s_waitcnt vmcnt(9)
    s_waitcnt lgkmcnt(6)
    v_mfma_f32_32x32x16_bf16 v[32:47], v[144:147], v[176:179], v[32:47]
    buffer_load_dwordx4 v[216:219], v8, s[4:7], s54 offen offset:3072 sc1
    s_waitcnt vmcnt(9)
    v_mfma_f32_32x32x16_bf16 v[48:63], v[144:147], v[180:183], v[48:63]
    ds_read_b64_tr_b16 v[144:145], v10 offset:6144
    ds_read_b64_tr_b16 v[146:147], v10 offset:7168
    s_waitcnt lgkmcnt(6)
    v_mfma_f32_32x32x16_bf16 v[64:79], v[148:151], v[176:179], v[64:79]
    buffer_load_dwordx4 v[220:223], v8, s[4:7], s55 offen offset:3072 sc1
    v_mfma_f32_32x32x16_bf16 v[80:95], v[148:151], v[180:183], v[80:95]
    ds_read_b64_tr_b16 v[148:149], v11 offset:6144
    ds_read_b64_tr_b16 v[150:151], v11 offset:7168
    s_waitcnt lgkmcnt(6)
    v_mfma_f32_32x32x16_bf16 v[96:111], v[152:155], v[176:179], v[96:111]
    s_add_u32 s54, s52, 8192
    s_add_u32 s55, s53, 8192
    buffer_load_dwordx4 v[160:163], v8, s[4:7], s54 offen offset:0 sc1
    v_mfma_f32_32x32x16_bf16 v[112:127], v[152:155], v[180:183], v[112:127]
    ds_read_b64_tr_b16 v[152:153], v12 offset:6144
    ds_read_b64_tr_b16 v[154:155], v12 offset:7168
    s_waitcnt lgkmcnt(6)
    v_mfma_f32_32x32x16_bf16 v[128:143], v[156:159], v[176:179], v[128:143]
    ds_read_b64_tr_b16 v[156:157], v13 offset:6144
    ds_read_b64_tr_b16 v[158:159], v13 offset:7168
    buffer_load_dwordx4 v[164:167], v8, s[4:7], s55 offen offset:0 sc1
    s_waitcnt vmcnt(11)
    s_waitcnt lgkmcnt(6)
    v_mfma_f32_32x32x16_bf16 v[32:47], v[144:147], v[184:187], v[32:47]
    buffer_load_dwordx4 v[168:171], v8, s[4:7], s54 offen offset:1024 sc1
    s_waitcnt vmcnt(11)
    v_mfma_f32_32x32x16_bf16 v[48:63], v[144:147], v[188:191], v[48:63]
    ds_read_b64_tr_b16 v[144:145], v10 offset:8192
    ds_read_b64_tr_b16 v[146:147], v10 offset:9216
    s_waitcnt lgkmcnt(6)
    v_mfma_f32_32x32x16_bf16 v[64:79], v[148:151], v[184:187], v[64:79]
    buffer_load_dwordx4 v[172:175], v8, s[4:7], s55 offen offset:1024 sc1
    v_mfma_f32_32x32x16_bf16 v[80:95], v[148:151], v[188:191], v[80:95]
    ds_read_b64_tr_b16 v[148:149], v11 offset:8192
    ds_read_b64_tr_b16 v[150:151], v11 offset:9216
    s_waitcnt lgkmcnt(6)
    v_mfma_f32_32x32x16_bf16 v[96:111], v[152:155], v[184:187], v[96:111]
    buffer_load_dwordx4 v[176:179], v8, s[4:7], s54 offen offset:2048 sc1
    v_mfma_f32_32x32x16_bf16 v[112:127], v[152:155], v[188:191], v[112:127]
    ds_read_b64_tr_b16 v[152:153], v12 offset:8192
    ds_read_b64_tr_b16 v[154:155], v12 offset:9216
    s_waitcnt lgkmcnt(6)
    v_mfma_f32_32x32x16_bf16 v[128:143], v[156:159], v[184:187], v[128:143]
    ds_read_b64_tr_b16 v[156:157], v13 offset:8192
    ds_read_b64_tr_b16 v[158:159], v13 offset:9216
    buffer_load_dwordx4 v[180:183], v8, s[4:7], s55 offen offset:2048 sc1
    s_waitcnt vmcnt(13)
    s_waitcnt lgkmcnt(6)
    v_mfma_f32_32x32x16_bf16 v[32:47], v[144:147], v[192:195], v[32:47]
    buffer_load_dwordx4 v[184:187], v8, s[4:7], s54 offen offset:3072 sc1
    s_waitcnt vmcnt(13)
    v_mfma_f32_32x32x16_bf16 v[48:63], v[144:147], v[196:199], v[48:63]
    ds_read_b64_tr_b16 v[144:145], v10 offset:10240
    ds_read_b64_tr_b16 v[146:147], v10 offset:11264
    s_waitcnt lgkmcnt(6)
    v_mfma_f32_32x32x16_bf16 v[64:79], v[148:151], v[192:195], v[64:79]
    buffer_load_dwordx4 v[188:191], v8, s[4:7], s55 offen offset:3072 sc1
    v_mfma_f32_32x32x16_bf16 v[80:95], v[148:151], v[196:199], v[80:95]
    ds_read_b64_tr_b16 v[148:149], v11 offset:10240
    ds_read_b64_tr_b16 v[150:151], v11 offset:11264
    s_waitcnt lgkmcnt(6)
    v_mfma_f32_32x32x16_bf16 v[96:111], v[152:155], v[192:195], v[96:111]
    v_mfma_f32_32x32x16_bf16 v[112:127], v[152:155], v[196:199], v[112:127]
    ds_read_b64_tr_b16 v[152:153], v12 offset:10240
    ds_read_b64_tr_b16 v[154:155], v12 offset:11264
    s_waitcnt lgkmcnt(6)
    v_mfma_f32_32x32x16_bf16 v[128:143], v[156:159], v[192:195], v[128:143]
    ds_read_b64_tr_b16 v[156:157], v13 offset:10240
    ds_read_b64_tr_b16 v[158:159], v13 offset:11264
    s_waitcnt vmcnt(13)
    s_waitcnt lgkmcnt(6)
    v_mfma_f32_32x32x16_bf16 v[32:47], v[144:147], v[200:203], v[32:47]
    s_add_u32 s54, s52, 12288
    s_add_u32 s55, s53, 12288
    buffer_load_dwordx4 v[192:195], v8, s[4:7], s54 offen offset:0 sc1
    s_waitcnt vmcnt(13)
    v_mfma_f32_32x32x16_bf16 v[48:63], v[144:147], v[204:207], v[48:63]
    ds_read_b64_tr_b16 v[144:145], v10 offset:12288
    ds_read_b64_tr_b16 v[146:147], v10 offset:13312
    s_waitcnt lgkmcnt(6)
    v_mfma_f32_32x32x16_bf16 v[64:79], v[148:151], v[200:203], v[64:79]
    buffer_load_dwordx4 v[196:199], v8, s[4:7], s55 offen offset:0 sc1
    v_mfma_f32_32x32x16_bf16 v[80:95], v[148:151], v[204:207], v[80:95]
    ds_read_b64_tr_b16 v[148:149], v11 offset:12288
    ds_read_b64_tr_b16 v[150:151], v11 offset:13312
    s_waitcnt lgkmcnt(6)
    v_mfma_f32_32x32x16_bf16 v[96:111], v[152:155], v[200:203], v[96:111]
    v_mfma_f32_32x32x16_bf16 v[112:127], v[152:155], v[204:207], v[112:127]
    ds_read_b64_tr_b16 v[152:153], v12 offset:12288
    ds_read_b64_tr_b16 v[154:155], v12 offset:13312
    s_waitcnt lgkmcnt(6)
    v_mfma_f32_32x32x16_bf16 v[128:143], v[156:159], v[200:203], v[128:143]
    ds_read_b64_tr_b16 v[156:157], v13 offset:12288
    ds_read_b64_tr_b16 v[158:159], v13 offset:13312
    s_waitcnt vmcnt(13)
    s_waitcnt lgkmcnt(6)
    v_mfma_f32_32x32x16_bf16 v[32:47], v[144:147], v[208:211], v[32:47]
    buffer_load_dwordx4 v[200:203], v8, s[4:7], s54 offen offset:1024 sc1
    s_waitcnt vmcnt(13)
    v_mfma_f32_32x32x16_bf16 v[48:63], v[144:147], v[212:215], v[48:63]
    ds_read_b64_tr_b16 v[144:145], v10 offset:14336
    ds_read_b64_tr_b16 v[146:147], v10 offset:15360
    s_waitcnt lgkmcnt(6)
    v_mfma_f32_32x32x16_bf16 v[64:79], v[148:151], v[208:211], v[64:79]
    buffer_load_dwordx4 v[204:207], v8, s[4:7], s55 offen offset:1024 sc1
    v_mfma_f32_32x32x16_bf16 v[80:95], v[148:151], v[212:215], v[80:95]
    ds_read_b64_tr_b16 v[148:149], v11 offset:14336
    ds_read_b64_tr_b16 v[150:151], v11 offset:15360
    s_waitcnt lgkmcnt(6)
    v_mfma_f32_32x32x16_bf16 v[96:111], v[152:155], v[208:211], v[96:111]
    v_mfma_f32_32x32x16_bf16 v[112:127], v[152:155], v[212:215], v[112:127]
    ds_read_b64_tr_b16 v[152:153], v12 offset:14336
    ds_read_b64_tr_b16 v[154:155], v12 offset:15360
    s_waitcnt lgkmcnt(6)
    v_mfma_f32_32x32x16_bf16 v[128:143], v[156:159], v[208:211], v[128:143]
    ds_read_b64_tr_b16 v[156:157], v13 offset:14336
    ds_read_b64_tr_b16 v[158:159], v13 offset:15360
    s_waitcnt vmcnt(13)
    s_waitcnt lgkmcnt(6)
    v_mfma_f32_32x32x16_bf16 v[32:47], v[144:147], v[216:219], v[32:47]
    buffer_load_dwordx4 v[208:211], v8, s[4:7], s54 offen offset:2048 sc1
    s_waitcnt vmcnt(13)
    v_mfma_f32_32x32x16_bf16 v[48:63], v[144:147], v[220:223], v[48:63]
    ds_read_b64_tr_b16 v[144:145], v10 offset:32768
    ds_read_b64_tr_b16 v[146:147], v10 offset:33792
    s_waitcnt lgkmcnt(6)
    v_mfma_f32_32x32x16_bf16 v[64:79], v[148:151], v[216:219], v[64:79]
    buffer_load_dwordx4 v[212:215], v8, s[4:7], s55 offen offset:2048 sc1
    v_mfma_f32_32x32x16_bf16 v[80:95], v[148:151], v[220:223], v[80:95]
    ds_read_b64_tr_b16 v[148:149], v11 offset:32768
    ds_read_b64_tr_b16 v[150:151], v11 offset:33792
    s_waitcnt lgkmcnt(6)
    v_mfma_f32_32x32x16_bf16 v[96:111], v[152:155], v[216:219], v[96:111]
    v_mfma_f32_32x32x16_bf16 v[112:127], v[152:155], v[220:223], v[112:127]
    ds_read_b64_tr_b16 v[152:153], v12 offset:32768
    ds_read_b64_tr_b16 v[154:155], v12 offset:33792
    s_waitcnt lgkmcnt(6)
    v_mfma_f32_32x32x16_bf16 v[128:143], v[156:159], v[216:219], v[128:143]
    ds_read_b64_tr_b16 v[156:157], v13 offset:32768
    ds_read_b64_tr_b16 v[158:159], v13 offset:33792
    s_barrier
    s_waitcnt vmcnt(13)
    s_waitcnt lgkmcnt(6)
    v_mfma_f32_32x32x16_bf16 v[32:47], v[144:147], v[160:163], v[32:47]
    buffer_load_dwordx4 v[216:219], v8, s[4:7], s54 offen offset:3072 sc1
    s_waitcnt vmcnt(13)
    v_mfma_f32_32x32x16_bf16 v[48:63], v[144:147], v[164:167], v[48:63]
    ds_read_b64_tr_b16 v[144:145], v10 offset:34816
    ds_read_b64_tr_b16 v[146:147], v10 offset:35840
    s_waitcnt lgkmcnt(6)
    v_mfma_f32_32x32x16_bf16 v[64:79], v[148:151], v[160:163], v[64:79]
    buffer_load_dwordx4 v[220:223], v8, s[4:7], s55 offen offset:3072 sc1
    v_mfma_f32_32x32x16_bf16 v[80:95], v[148:151], v[164:167], v[80:95]
    ds_read_b64_tr_b16 v[148:149], v11 offset:34816
    ds_read_b64_tr_b16 v[150:151], v11 offset:35840
    s_waitcnt lgkmcnt(6)
    v_mfma_f32_32x32x16_bf16 v[96:111], v[152:155], v[160:163], v[96:111]
    v_mfma_f32_32x32x16_bf16 v[112:127], v[152:155], v[164:167], v[112:127]
    ds_read_b64_tr_b16 v[152:153], v12 offset:34816
    ds_read_b64_tr_b16 v[154:155], v12 offset:35840
    s_waitcnt lgkmcnt(6)
    v_mfma_f32_32x32x16_bf16 v[128:143], v[156:159], v[160:163], v[128:143]
    ds_read_b64_tr_b16 v[156:157], v13 offset:34816
    ds_read_b64_tr_b16 v[158:159], v13 offset:35840
    s_waitcnt vmcnt(13)
    s_waitcnt lgkmcnt(6)
    v_mfma_f32_32x32x16_bf16 v[32:47], v[144:147], v[168:171], v[32:47]
    s_add_u32 s54, s52, 16384
    s_add_u32 s55, s53, 16384
    buffer_load_dwordx4 v[160:163], v8, s[4:7], s54 offen offset:0 sc1
    s_waitcnt vmcnt(13)
    v_mfma_f32_32x32x16_bf16 v[48:63], v[144:147], v[172:175], v[48:63]
    ds_read_b64_tr_b16 v[144:145], v10 offset:36864
    ds_read_b64_tr_b16 v[146:147], v10 offset:37888
    s_waitcnt lgkmcnt(6)
    v_mfma_f32_32x32x16_bf16 v[64:79], v[148:151], v[168:171], v[64:79]
    buffer_load_dwordx4 v[164:167], v8, s[4:7], s55 offen offset:0 sc1
    v_mfma_f32_32x32x16_bf16 v[80:95], v[148:151], v[172:175], v[80:95]
    ds_read_b64_tr_b16 v[148:149], v11 offset:36864
    ds_read_b64_tr_b16 v[150:151], v11 offset:37888
    s_waitcnt lgkmcnt(6)
    v_mfma_f32_32x32x16_bf16 v[96:111], v[152:155], v[168:171], v[96:111]
    v_mfma_f32_32x32x16_bf16 v[112:127], v[152:155], v[172:175], v[112:127]
    ds_read_b64_tr_b16 v[152:153], v12 offset:36864
    ds_read_b64_tr_b16 v[154:155], v12 offset:37888
    s_waitcnt lgkmcnt(6)
    v_mfma_f32_32x32x16_bf16 v[128:143], v[156:159], v[168:171], v[128:143]
    ds_read_b64_tr_b16 v[156:157], v13 offset:36864
    ds_read_b64_tr_b16 v[158:159], v13 offset:37888
    s_waitcnt vmcnt(13)
    s_waitcnt lgkmcnt(6)
    v_mfma_f32_32x32x16_bf16 v[32:47], v[144:147], v[176:179], v[32:47]
    buffer_load_dwordx4 v[168:171], v8, s[4:7], s54 offen offset:1024 sc1
    s_waitcnt vmcnt(13)
    v_mfma_f32_32x32x16_bf16 v[48:63], v[144:147], v[180:183], v[48:63]
    ds_read_b64_tr_b16 v[144:145], v10 offset:38912
    ds_read_b64_tr_b16 v[146:147], v10 offset:39936
    s_waitcnt lgkmcnt(6)
    v_mfma_f32_32x32x16_bf16 v[64:79], v[148:151], v[176:179], v[64:79]
    buffer_load_dwordx4 v[172:175], v8, s[4:7], s55 offen offset:1024 sc1
    v_mfma_f32_32x32x16_bf16 v[80:95], v[148:151], v[180:183], v[80:95]
    ds_read_b64_tr_b16 v[148:149], v11 offset:38912
    ds_read_b64_tr_b16 v[150:151], v11 offset:39936
    s_waitcnt lgkmcnt(6)
    v_mfma_f32_32x32x16_bf16 v[96:111], v[152:155], v[176:179], v[96:111]
    v_mfma_f32_32x32x16_bf16 v[112:127], v[152:155], v[180:183], v[112:127]
    ds_read_b64_tr_b16 v[152:153], v12 offset:38912
    ds_read_b64_tr_b16 v[154:155], v12 offset:39936
    s_waitcnt lgkmcnt(6)
    v_mfma_f32_32x32x16_bf16 v[128:143], v[156:159], v[176:179], v[128:143]
    ds_read_b64_tr_b16 v[156:157], v13 offset:38912
    ds_read_b64_tr_b16 v[158:159], v13 offset:39936
    s_waitcnt vmcnt(13)
    s_waitcnt lgkmcnt(6)
    v_mfma_f32_32x32x16_bf16 v[32:47], v[144:147], v[184:187], v[32:47]
    buffer_load_dwordx4 v[176:179], v8, s[4:7], s54 offen offset:2048 sc1
    s_waitcnt vmcnt(13)
    v_mfma_f32_32x32x16_bf16 v[48:63], v[144:147], v[188:191], v[48:63]
    ds_read_b64_tr_b16 v[144:145], v10 offset:40960
    ds_read_b64_tr_b16 v[146:147], v10 offset:41984
    s_waitcnt lgkmcnt(6)
    v_mfma_f32_32x32x16_bf16 v[64:79], v[148:151], v[184:187], v[64:79]
    buffer_load_dwordx4 v[180:183], v8, s[4:7], s55 offen offset:2048 sc1
    v_mfma_f32_32x32x16_bf16 v[80:95], v[148:151], v[188:191], v[80:95]
    ds_read_b64_tr_b16 v[148:149], v11 offset:40960
    ds_read_b64_tr_b16 v[150:151], v11 offset:41984
    s_waitcnt lgkmcnt(6)
    v_mfma_f32_32x32x16_bf16 v[96:111], v[152:155], v[184:187], v[96:111]
    v_mfma_f32_32x32x16_bf16 v[112:127], v[152:155], v[188:191], v[112:127]
    ds_read_b64_tr_b16 v[152:153], v12 offset:40960
    ds_read_b64_tr_b16 v[154:155], v12 offset:41984
    s_waitcnt lgkmcnt(6)
    v_mfma_f32_32x32x16_bf16 v[128:143], v[156:159], v[184:187], v[128:143]
    ds_read_b64_tr_b16 v[156:157], v13 offset:40960
    ds_read_b64_tr_b16 v[158:159], v13 offset:41984
    s_waitcnt vmcnt(13)
    s_waitcnt lgkmcnt(6)
    v_mfma_f32_32x32x16_bf16 v[32:47], v[144:147], v[192:195], v[32:47]
    buffer_load_dwordx4 v[184:187], v8, s[4:7], s54 offen offset:3072 sc1
    s_waitcnt vmcnt(13)
    v_mfma_f32_32x32x16_bf16 v[48:63], v[144:147], v[196:199], v[48:63]
    ds_read_b64_tr_b16 v[144:145], v10 offset:43008
    ds_read_b64_tr_b16 v[146:147], v10 offset:44032
    s_waitcnt lgkmcnt(6)
    v_mfma_f32_32x32x16_bf16 v[64:79], v[148:151], v[192:195], v[64:79]
    buffer_load_dwordx4 v[188:191], v8, s[4:7], s55 offen offset:3072 sc1
    v_mfma_f32_32x32x16_bf16 v[80:95], v[148:151], v[196:199], v[80:95]
    ds_read_b64_tr_b16 v[148:149], v11 offset:43008
    ds_read_b64_tr_b16 v[150:151], v11 offset:44032
    s_waitcnt lgkmcnt(6)
    v_mfma_f32_32x32x16_bf16 v[96:111], v[152:155], v[192:195], v[96:111]
    v_mfma_f32_32x32x16_bf16 v[112:127], v[152:155], v[196:199], v[112:127]
    ds_read_b64_tr_b16 v[152:153], v12 offset:43008
    ds_read_b64_tr_b16 v[154:155], v12 offset:44032
    s_waitcnt lgkmcnt(6)
    v_mfma_f32_32x32x16_bf16 v[128:143], v[156:159], v[192:195], v[128:143]
    ds_read_b64_tr_b16 v[156:157], v13 offset:43008
    ds_read_b64_tr_b16 v[158:159], v13 offset:44032
    s_waitcnt vmcnt(13)
    s_waitcnt lgkmcnt(6)
    v_mfma_f32_32x32x16_bf16 v[32:47], v[144:147], v[200:203], v[32:47]
    s_add_u32 s54, s52, 20480
    s_add_u32 s55, s53, 20480
    buffer_load_dwordx4 v[192:195], v8, s[4:7], s54 offen offset:0 sc1
    s_waitcnt vmcnt(13)
    v_mfma_f32_32x32x16_bf16 v[48:63], v[144:147], v[204:207], v[48:63]
    ds_read_b64_tr_b16 v[144:145], v10 offset:45056
    ds_read_b64_tr_b16 v[146:147], v10 offset:46080
    s_waitcnt lgkmcnt(6)
    v_mfma_f32_32x32x16_bf16 v[64:79], v[148:151], v[200:203], v[64:79]
    buffer_load_dwordx4 v[196:199], v8, s[4:7], s55 offen offset:0 sc1
    v_mfma_f32_32x32x16_bf16 v[80:95], v[148:151], v[204:207], v[80:95]
    ds_read_b64_tr_b16 v[148:149], v11 offset:45056
    ds_read_b64_tr_b16 v[150:151], v11 offset:46080
    s_waitcnt lgkmcnt(6)
    v_mfma_f32_32x32x16_bf16 v[96:111], v[152:155], v[200:203], v[96:111]
    v_mfma_f32_32x32x16_bf16 v[112:127], v[152:155], v[204:207], v[112:127]
    ds_read_b64_tr_b16 v[152:153], v12 offset:45056
    ds_read_b64_tr_b16 v[154:155], v12 offset:46080
    s_waitcnt lgkmcnt(6)
    v_mfma_f32_32x32x16_bf16 v[128:143], v[156:159], v[200:203], v[128:143]
    ds_read_b64_tr_b16 v[156:157], v13 offset:45056
    ds_read_b64_tr_b16 v[158:159], v13 offset:46080
    s_waitcnt vmcnt(13)
    s_waitcnt lgkmcnt(6)
    v_mfma_f32_32x32x16_bf16 v[32:47], v[144:147], v[208:211], v[32:47]
    buffer_load_dwordx4 v[200:203], v8, s[4:7], s54 offen offset:1024 sc1
    s_waitcnt vmcnt(13)
    v_mfma_f32_32x32x16_bf16 v[48:63], v[144:147], v[212:215], v[48:63]
    ds_read_b64_tr_b16 v[144:145], v10 offset:47104
    ds_read_b64_tr_b16 v[146:147], v10 offset:48128
    s_waitcnt lgkmcnt(6)
    v_mfma_f32_32x32x16_bf16 v[64:79], v[148:151], v[208:211], v[64:79]
    buffer_load_dwordx4 v[204:207], v8, s[4:7], s55 offen offset:1024 sc1
    v_mfma_f32_32x32x16_bf16 v[80:95], v[148:151], v[212:215], v[80:95]
    ds_read_b64_tr_b16 v[148:149], v11 offset:47104
    ds_read_b64_tr_b16 v[150:151], v11 offset:48128
    s_waitcnt lgkmcnt(6)
    v_mfma_f32_32x32x16_bf16 v[96:111], v[152:155], v[208:211], v[96:111]
    v_mfma_f32_32x32x16_bf16 v[112:127], v[152:155], v[212:215], v[112:127]
    ds_read_b64_tr_b16 v[152:153], v12 offset:47104
    ds_read_b64_tr_b16 v[154:155], v12 offset:48128
    s_waitcnt lgkmcnt(6)
    v_mfma_f32_32x32x16_bf16 v[128:143], v[156:159], v[208:211], v[128:143]
    ds_read_b64_tr_b16 v[156:157], v13 offset:47104
    ds_read_b64_tr_b16 v[158:159], v13 offset:48128
    s_waitcnt vmcnt(13)
    s_waitcnt lgkmcnt(6)
    v_mfma_f32_32x32x16_bf16 v[32:47], v[144:147], v[216:219], v[32:47]
    buffer_load_dwordx4 v[208:211], v8, s[4:7], s54 offen offset:2048 sc1
    s_waitcnt vmcnt(13)
    v_mfma_f32_32x32x16_bf16 v[48:63], v[144:147], v[220:223], v[48:63]
    ds_read_b64_tr_b16 v[144:145], v14 offset:0
    ds_read_b64_tr_b16 v[146:147], v14 offset:1024
    s_waitcnt lgkmcnt(6)
    v_mfma_f32_32x32x16_bf16 v[64:79], v[148:151], v[216:219], v[64:79]
    buffer_load_dwordx4 v[212:215], v8, s[4:7], s55 offen offset:2048 sc1
    v_mfma_f32_32x32x16_bf16 v[80:95], v[148:151], v[220:223], v[80:95]
    ds_read_b64_tr_b16 v[148:149], v15 offset:0
    ds_read_b64_tr_b16 v[150:151], v15 offset:1024
    s_waitcnt lgkmcnt(6)
    v_mfma_f32_32x32x16_bf16 v[96:111], v[152:155], v[216:219], v[96:111]
    v_mfma_f32_32x32x16_bf16 v[112:127], v[152:155], v[220:223], v[112:127]
    ds_read_b64_tr_b16 v[152:153], v16 offset:0
    ds_read_b64_tr_b16 v[154:155], v16 offset:1024
    s_waitcnt lgkmcnt(6)
    v_mfma_f32_32x32x16_bf16 v[128:143], v[156:159], v[216:219], v[128:143]
    ds_read_b64_tr_b16 v[156:157], v17 offset:0
    ds_read_b64_tr_b16 v[158:159], v17 offset:1024
    s_barrier
    s_waitcnt vmcnt(13)
    s_waitcnt lgkmcnt(6)
    v_mfma_f32_32x32x16_bf16 v[32:47], v[144:147], v[160:163], v[32:47]
    buffer_load_dwordx4 v[216:219], v8, s[4:7], s54 offen offset:3072 sc1
    s_waitcnt vmcnt(13)
    v_mfma_f32_32x32x16_bf16 v[48:63], v[144:147], v[164:167], v[48:63]
    ds_read_b64_tr_b16 v[144:145], v14 offset:2048
    ds_read_b64_tr_b16 v[146:147], v14 offset:3072
    s_waitcnt lgkmcnt(6)
    v_mfma_f32_32x32x16_bf16 v[64:79], v[148:151], v[160:163], v[64:79]
    buffer_load_dwordx4 v[220:223], v8, s[4:7], s55 offen offset:3072 sc1
    v_mfma_f32_32x32x16_bf16 v[80:95], v[148:151], v[164:167], v[80:95]
    ds_read_b64_tr_b16 v[148:149], v15 offset:2048
    ds_read_b64_tr_b16 v[150:151], v15 offset:3072
    s_waitcnt lgkmcnt(6)
    v_mfma_f32_32x32x16_bf16 v[96:111], v[152:155], v[160:163], v[96:111]
    v_mfma_f32_32x32x16_bf16 v[112:127], v[152:155], v[164:167], v[112:127]
    ds_read_b64_tr_b16 v[152:153], v16 offset:2048
    ds_read_b64_tr_b16 v[154:155], v16 offset:3072
    s_waitcnt lgkmcnt(6)
    v_mfma_f32_32x32x16_bf16 v[128:143], v[156:159], v[160:163], v[128:143]
    ds_read_b64_tr_b16 v[156:157], v17 offset:2048
    ds_read_b64_tr_b16 v[158:159], v17 offset:3072
    s_waitcnt vmcnt(13)
    s_waitcnt lgkmcnt(6)
    v_mfma_f32_32x32x16_bf16 v[32:47], v[144:147], v[168:171], v[32:47]
    s_add_u32 s54, s52, 24576
    s_add_u32 s55, s53, 24576
    buffer_load_dwordx4 v[160:163], v8, s[4:7], s54 offen offset:0 sc1
    s_waitcnt vmcnt(13)
    v_mfma_f32_32x32x16_bf16 v[48:63], v[144:147], v[172:175], v[48:63]
    ds_read_b64_tr_b16 v[144:145], v14 offset:4096
    ds_read_b64_tr_b16 v[146:147], v14 offset:5120
    s_waitcnt lgkmcnt(6)
    v_mfma_f32_32x32x16_bf16 v[64:79], v[148:151], v[168:171], v[64:79]
    buffer_load_dwordx4 v[164:167], v8, s[4:7], s55 offen offset:0 sc1
    v_mfma_f32_32x32x16_bf16 v[80:95], v[148:151], v[172:175], v[80:95]
    ds_read_b64_tr_b16 v[148:149], v15 offset:4096
    ds_read_b64_tr_b16 v[150:151], v15 offset:5120
    s_waitcnt lgkmcnt(6)
    v_mfma_f32_32x32x16_bf16 v[96:111], v[152:155], v[168:171], v[96:111]
    v_mfma_f32_32x32x16_bf16 v[112:127], v[152:155], v[172:175], v[112:127]
    ds_read_b64_tr_b16 v[152:153], v16 offset:4096
    ds_read_b64_tr_b16 v[154:155], v16 offset:5120
    s_waitcnt lgkmcnt(6)
    v_mfma_f32_32x32x16_bf16 v[128:143], v[156:159], v[168:171], v[128:143]
    ds_read_b64_tr_b16 v[156:157], v17 offset:4096
    ds_read_b64_tr_b16 v[158:159], v17 offset:5120
    s_waitcnt vmcnt(13)
    s_waitcnt lgkmcnt(6)
    v_mfma_f32_32x32x16_bf16 v[32:47], v[144:147], v[176:179], v[32:47]
    buffer_load_dwordx4 v[168:171], v8, s[4:7], s54 offen offset:1024 sc1
    s_waitcnt vmcnt(13)
    v_mfma_f32_32x32x16_bf16 v[48:63], v[144:147], v[180:183], v[48:63]
    ds_read_b64_tr_b16 v[144:145], v14 offset:6144
    ds_read_b64_tr_b16 v[146:147], v14 offset:7168
    s_waitcnt lgkmcnt(6)
    v_mfma_f32_32x32x16_bf16 v[64:79], v[148:151], v[176:179], v[64:79]
    buffer_load_dwordx4 v[172:175], v8, s[4:7], s55 offen offset:1024 sc1
    v_mfma_f32_32x32x16_bf16 v[80:95], v[148:151], v[180:183], v[80:95]
    ds_read_b64_tr_b16 v[148:149], v15 offset:6144
    ds_read_b64_tr_b16 v[150:151], v15 offset:7168
    s_waitcnt lgkmcnt(6)
    v_mfma_f32_32x32x16_bf16 v[96:111], v[152:155], v[176:179], v[96:111]
    v_mfma_f32_32x32x16_bf16 v[112:127], v[152:155], v[180:183], v[112:127]
    ds_read_b64_tr_b16 v[152:153], v16 offset:6144
    ds_read_b64_tr_b16 v[154:155], v16 offset:7168
    s_waitcnt lgkmcnt(6)
    v_mfma_f32_32x32x16_bf16 v[128:143], v[156:159], v[176:179], v[128:143]
    ds_read_b64_tr_b16 v[156:157], v17 offset:6144
    ds_read_b64_tr_b16 v[158:159], v17 offset:7168
    s_waitcnt vmcnt(13)
    s_waitcnt lgkmcnt(6)
    v_mfma_f32_32x32x16_bf16 v[32:47], v[144:147], v[184:187], v[32:47]
    buffer_load_dwordx4 v[176:179], v8, s[4:7], s54 offen offset:2048 sc1
    s_waitcnt vmcnt(13)
    v_mfma_f32_32x32x16_bf16 v[48:63], v[144:147], v[188:191], v[48:63]
    ds_read_b64_tr_b16 v[144:145], v14 offset:8192
    ds_read_b64_tr_b16 v[146:147], v14 offset:9216
    s_waitcnt lgkmcnt(6)
    v_mfma_f32_32x32x16_bf16 v[64:79], v[148:151], v[184:187], v[64:79]
    buffer_load_dwordx4 v[180:183], v8, s[4:7], s55 offen offset:2048 sc1
    v_mfma_f32_32x32x16_bf16 v[80:95], v[148:151], v[188:191], v[80:95]
    ds_read_b64_tr_b16 v[148:149], v15 offset:8192
    ds_read_b64_tr_b16 v[150:151], v15 offset:9216
    s_waitcnt lgkmcnt(6)
    v_mfma_f32_32x32x16_bf16 v[96:111], v[152:155], v[184:187], v[96:111]
    v_mfma_f32_32x32x16_bf16 v[112:127], v[152:155], v[188:191], v[112:127]
    ds_read_b64_tr_b16 v[152:153], v16 offset:8192
    ds_read_b64_tr_b16 v[154:155], v16 offset:9216
    s_waitcnt lgkmcnt(6)
    v_mfma_f32_32x32x16_bf16 v[128:143], v[156:159], v[184:187], v[128:143]
    ds_read_b64_tr_b16 v[156:157], v17 offset:8192
    ds_read_b64_tr_b16 v[158:159], v17 offset:9216
    s_waitcnt vmcnt(13)
    s_waitcnt lgkmcnt(6)
    v_mfma_f32_32x32x16_bf16 v[32:47], v[144:147], v[192:195], v[32:47]
    buffer_load_dwordx4 v[184:187], v8, s[4:7], s54 offen offset:3072 sc1
    s_waitcnt vmcnt(13)
    v_mfma_f32_32x32x16_bf16 v[48:63], v[144:147], v[196:199], v[48:63]
    ds_read_b64_tr_b16 v[144:145], v14 offset:10240
    ds_read_b64_tr_b16 v[146:147], v14 offset:11264
    s_waitcnt lgkmcnt(6)
    v_mfma_f32_32x32x16_bf16 v[64:79], v[148:151], v[192:195], v[64:79]
    buffer_load_dwordx4 v[188:191], v8, s[4:7], s55 offen offset:3072 sc1
    v_mfma_f32_32x32x16_bf16 v[80:95], v[148:151], v[196:199], v[80:95]
    ds_read_b64_tr_b16 v[148:149], v15 offset:10240
    ds_read_b64_tr_b16 v[150:151], v15 offset:11264
    s_waitcnt lgkmcnt(6)
    v_mfma_f32_32x32x16_bf16 v[96:111], v[152:155], v[192:195], v[96:111]
    v_mfma_f32_32x32x16_bf16 v[112:127], v[152:155], v[196:199], v[112:127]
    ds_read_b64_tr_b16 v[152:153], v16 offset:10240
    ds_read_b64_tr_b16 v[154:155], v16 offset:11264
    s_waitcnt lgkmcnt(6)
    v_mfma_f32_32x32x16_bf16 v[128:143], v[156:159], v[192:195], v[128:143]
    ds_read_b64_tr_b16 v[156:157], v17 offset:10240
    ds_read_b64_tr_b16 v[158:159], v17 offset:11264
    s_waitcnt vmcnt(13)
    s_waitcnt lgkmcnt(6)
    v_mfma_f32_32x32x16_bf16 v[32:47], v[144:147], v[200:203], v[32:47]
    s_add_u32 s54, s52, 28672
    s_add_u32 s55, s53, 28672
    buffer_load_dwordx4 v[192:195], v8, s[4:7], s54 offen offset:0 sc1
    s_waitcnt vmcnt(13)
    v_mfma_f32_32x32x16_bf16 v[48:63], v[144:147], v[204:207], v[48:63]
    ds_read_b64_tr_b16 v[144:145], v14 offset:12288
    ds_read_b64_tr_b16 v[146:147], v14 offset:13312
    s_waitcnt lgkmcnt(6)
    v_mfma_f32_32x32x16_bf16 v[64:79], v[148:151], v[200:203], v[64:79]
    buffer_load_dwordx4 v[196:199], v8, s[4:7], s55 offen offset:0 sc1
    v_mfma_f32_32x32x16_bf16 v[80:95], v[148:151], v[204:207], v[80:95]
    ds_read_b64_tr_b16 v[148:149], v15 offset:12288
    ds_read_b64_tr_b16 v[150:151], v15 offset:13312
    s_waitcnt lgkmcnt(6)
    v_mfma_f32_32x32x16_bf16 v[96:111], v[152:155], v[200:203], v[96:111]
    v_mfma_f32_32x32x16_bf16 v[112:127], v[152:155], v[204:207], v[112:127]
    ds_read_b64_tr_b16 v[152:153], v16 offset:12288
    ds_read_b64_tr_b16 v[154:155], v16 offset:13312
    s_waitcnt lgkmcnt(6)
    v_mfma_f32_32x32x16_bf16 v[128:143], v[156:159], v[200:203], v[128:143]
    ds_read_b64_tr_b16 v[156:157], v17 offset:12288
    ds_read_b64_tr_b16 v[158:159], v17 offset:13312
    s_waitcnt vmcnt(13)
    s_waitcnt lgkmcnt(6)
    v_mfma_f32_32x32x16_bf16 v[32:47], v[144:147], v[208:211], v[32:47]
    buffer_load_dwordx4 v[200:203], v8, s[4:7], s54 offen offset:1024 sc1
    s_waitcnt vmcnt(13)
    v_mfma_f32_32x32x16_bf16 v[48:63], v[144:147], v[212:215], v[48:63]
    ds_read_b64_tr_b16 v[144:145], v14 offset:14336
    ds_read_b64_tr_b16 v[146:147], v14 offset:15360
    s_waitcnt lgkmcnt(6)
    v_mfma_f32_32x32x16_bf16 v[64:79], v[148:151], v[208:211], v[64:79]
    buffer_load_dwordx4 v[204:207], v8, s[4:7], s55 offen offset:1024 sc1
    v_mfma_f32_32x32x16_bf16 v[80:95], v[148:151], v[212:215], v[80:95]
    ds_read_b64_tr_b16 v[148:149], v15 offset:14336
    ds_read_b64_tr_b16 v[150:151], v15 offset:15360
    s_waitcnt lgkmcnt(6)
    v_mfma_f32_32x32x16_bf16 v[96:111], v[152:155], v[208:211], v[96:111]
    v_mfma_f32_32x32x16_bf16 v[112:127], v[152:155], v[212:215], v[112:127]
    ds_read_b64_tr_b16 v[152:153], v16 offset:14336
    ds_read_b64_tr_b16 v[154:155], v16 offset:15360
    s_waitcnt lgkmcnt(6)
    v_mfma_f32_32x32x16_bf16 v[128:143], v[156:159], v[208:211], v[128:143]
    ds_read_b64_tr_b16 v[156:157], v17 offset:14336
    ds_read_b64_tr_b16 v[158:159], v17 offset:15360
    s_waitcnt vmcnt(13)
    s_waitcnt lgkmcnt(6)
    v_mfma_f32_32x32x16_bf16 v[32:47], v[144:147], v[216:219], v[32:47]
    buffer_load_dwordx4 v[208:211], v8, s[4:7], s54 offen offset:2048 sc1
    s_waitcnt vmcnt(13)
    v_mfma_f32_32x32x16_bf16 v[48:63], v[144:147], v[220:223], v[48:63]
    ds_read_b64_tr_b16 v[144:145], v14 offset:32768
    ds_read_b64_tr_b16 v[146:147], v14 offset:33792
    s_waitcnt lgkmcnt(6)
    v_mfma_f32_32x32x16_bf16 v[64:79], v[148:151], v[216:219], v[64:79]
    buffer_load_dwordx4 v[212:215], v8, s[4:7], s55 offen offset:2048 sc1
    v_mfma_f32_32x32x16_bf16 v[80:95], v[148:151], v[220:223], v[80:95]
    ds_read_b64_tr_b16 v[148:149], v15 offset:32768
    ds_read_b64_tr_b16 v[150:151], v15 offset:33792
    s_waitcnt lgkmcnt(6)
    v_mfma_f32_32x32x16_bf16 v[96:111], v[152:155], v[216:219], v[96:111]
    v_mfma_f32_32x32x16_bf16 v[112:127], v[152:155], v[220:223], v[112:127]
    ds_read_b64_tr_b16 v[152:153], v16 offset:32768
    ds_read_b64_tr_b16 v[154:155], v16 offset:33792
    s_waitcnt lgkmcnt(6)
    v_mfma_f32_32x32x16_bf16 v[128:143], v[156:159], v[216:219], v[128:143]
    ds_read_b64_tr_b16 v[156:157], v17 offset:32768
    ds_read_b64_tr_b16 v[158:159], v17 offset:33792
    s_barrier
    s_waitcnt vmcnt(13)
    s_waitcnt lgkmcnt(6)
    v_mfma_f32_32x32x16_bf16 v[32:47], v[144:147], v[160:163], v[32:47]
    buffer_load_dwordx4 v[216:219], v8, s[4:7], s54 offen offset:3072 sc1
    v_and_b32 v4, 31, v0
    v_lshlrev_b32 v4, 3, v4
    s_add_u32 s57, s56, 0
    s_and_b32 s57, s57, 3
    s_lshl_b32 s57, s57, 8
    s_add_u32 s57, s57, 162304
    v_add_u32 v5, s57, v4
    ds_read_b64 v[232:233], v5
    s_add_u32 s57, s56, 1
    s_and_b32 s57, s57, 3
    s_lshl_b32 s57, s57, 8
    s_add_u32 s57, s57, 162304
    v_add_u32 v5, s57, v4
    ds_read_b64 v[236:237], v5
    s_waitcnt vmcnt(13)
    v_mfma_f32_32x32x16_bf16 v[48:63], v[144:147], v[164:167], v[48:63]
    ds_read_b64_tr_b16 v[144:145], v14 offset:34816
    ds_read_b64_tr_b16 v[146:147], v14 offset:35840
    s_add_u32 s57, s56, 2
    s_and_b32 s57, s57, 3
    s_lshl_b32 s57, s57, 8
    s_add_u32 s57, s57, 162304
    v_add_u32 v5, s57, v4
    ds_read_b64 v[240:241], v5
    s_add_u32 s57, s56, 3
    s_and_b32 s57, s57, 3
    s_lshl_b32 s57, s57, 8
    s_add_u32 s57, s57, 162304
    v_add_u32 v5, s57, v4
    ds_read_b64 v[244:245], v5
    s_waitcnt lgkmcnt(10)
    v_mfma_f32_32x32x16_bf16 v[64:79], v[148:151], v[160:163], v[64:79]
    buffer_load_dwordx4 v[220:223], v8, s[4:7], s55 offen offset:3072 sc1
    v_mfma_f32_32x32x16_bf16 v[80:95], v[148:151], v[164:167], v[80:95]
    ds_read_b64_tr_b16 v[148:149], v15 offset:34816
    ds_read_b64_tr_b16 v[150:151], v15 offset:35840
    s_waitcnt lgkmcnt(10)
    v_mfma_f32_32x32x16_bf16 v[96:111], v[152:155], v[160:163], v[96:111]
    v_mfma_f32_32x32x16_bf16 v[112:127], v[152:155], v[164:167], v[112:127]
    ds_read_b64_tr_b16 v[152:153], v16 offset:34816
    ds_read_b64_tr_b16 v[154:155], v16 offset:35840
    s_waitcnt lgkmcnt(10)
    v_mfma_f32_32x32x16_bf16 v[128:143], v[156:159], v[160:163], v[128:143]
    ds_read_b64_tr_b16 v[156:157], v17 offset:34816
    ds_read_b64_tr_b16 v[158:159], v17 offset:35840
    s_waitcnt vmcnt(13)
    s_waitcnt lgkmcnt(8)
    v_mfma_f32_32x32x16_bf16 v[32:47], v[144:147], v[168:171], v[32:47]
    buffer_load_dwordx4 v[160:163], v8, s[4:7], s62 offen offset:0 sc1
    s_waitcnt vmcnt(13)
    v_mfma_f32_32x32x16_bf16 v[48:63], v[144:147], v[172:175], v[48:63]
    ds_read_b64_tr_b16 v[144:145], v14 offset:36864
    ds_read_b64_tr_b16 v[146:147], v14 offset:37888
    s_waitcnt lgkmcnt(6)
    v_mfma_f32_32x32x16_bf16 v[64:79], v[148:151], v[168:171], v[64:79]
    buffer_load_dwordx4 v[164:167], v8, s[4:7], s62 offen offset:1024 sc1
    v_mfma_f32_32x32x16_bf16 v[80:95], v[148:151], v[172:175], v[80:95]
    ds_read_b64_tr_b16 v[148:149], v15 offset:36864
    ds_read_b64_tr_b16 v[150:151], v15 offset:37888
    s_waitcnt lgkmcnt(6)
    v_mfma_f32_32x32x16_bf16 v[96:111], v[152:155], v[168:171], v[96:111]
    v_mfma_f32_32x32x16_bf16 v[112:127], v[152:155], v[172:175], v[112:127]
    ds_read_b64_tr_b16 v[152:153], v16 offset:36864
    ds_read_b64_tr_b16 v[154:155], v16 offset:37888
    s_waitcnt lgkmcnt(6)
    v_mfma_f32_32x32x16_bf16 v[128:143], v[156:159], v[168:171], v[128:143]
    ds_read_b64_tr_b16 v[156:157], v17 offset:36864
    ds_read_b64_tr_b16 v[158:159], v17 offset:37888
    s_waitcnt vmcnt(13)
    s_waitcnt lgkmcnt(6)
    v_mfma_f32_32x32x16_bf16 v[32:47], v[144:147], v[176:179], v[32:47]
    buffer_load_dwordx4 v[168:171], v8, s[4:7], s62 offen offset:2048 sc1
    s_waitcnt vmcnt(13)
    v_mfma_f32_32x32x16_bf16 v[48:63], v[144:147], v[180:183], v[48:63]
    ds_read_b64_tr_b16 v[144:145], v14 offset:38912
    ds_read_b64_tr_b16 v[146:147], v14 offset:39936
    s_waitcnt lgkmcnt(6)
    v_mfma_f32_32x32x16_bf16 v[64:79], v[148:151], v[176:179], v[64:79]
    buffer_load_dwordx4 v[172:175], v8, s[4:7], s62 offen offset:3072 sc1
    v_mfma_f32_32x32x16_bf16 v[80:95], v[148:151], v[180:183], v[80:95]
    ds_read_b64_tr_b16 v[148:149], v15 offset:38912
    ds_read_b64_tr_b16 v[150:151], v15 offset:39936
    s_waitcnt lgkmcnt(6)
    v_mfma_f32_32x32x16_bf16 v[96:111], v[152:155], v[176:179], v[96:111]
    v_mfma_f32_32x32x16_bf16 v[112:127], v[152:155], v[180:183], v[112:127]
    ds_read_b64_tr_b16 v[152:153], v16 offset:38912
    ds_read_b64_tr_b16 v[154:155], v16 offset:39936
    s_waitcnt lgkmcnt(6)
    v_mfma_f32_32x32x16_bf16 v[128:143], v[156:159], v[176:179], v[128:143]
    ds_read_b64_tr_b16 v[156:157], v17 offset:38912
    ds_read_b64_tr_b16 v[158:159], v17 offset:39936
    s_waitcnt vmcnt(13)
    s_waitcnt lgkmcnt(6)
    v_mfma_f32_32x32x16_bf16 v[32:47], v[144:147], v[184:187], v[32:47]
    buffer_load_dwordx4 v[176:179], v8, s[4:7], s63 offen offset:0 sc1
    s_waitcnt vmcnt(13)
    v_mfma_f32_32x32x16_bf16 v[48:63], v[144:147], v[188:191], v[48:63]
    ds_read_b64_tr_b16 v[144:145], v14 offset:40960
    ds_read_b64_tr_b16 v[146:147], v14 offset:41984
    s_waitcnt lgkmcnt(6)
    v_mfma_f32_32x32x16_bf16 v[64:79], v[148:151], v[184:187], v[64:79]
    buffer_load_dwordx4 v[180:183], v8, s[4:7], s63 offen offset:1024 sc1
    v_mfma_f32_32x32x16_bf16 v[80:95], v[148:151], v[188:191], v[80:95]
    ds_read_b64_tr_b16 v[148:149], v15 offset:40960
    ds_read_b64_tr_b16 v[150:151], v15 offset:41984
    s_waitcnt lgkmcnt(6)
    v_mfma_f32_32x32x16_bf16 v[96:111], v[152:155], v[184:187], v[96:111]
    v_mfma_f32_32x32x16_bf16 v[112:127], v[152:155], v[188:191], v[112:127]
    ds_read_b64_tr_b16 v[152:153], v16 offset:40960
    ds_read_b64_tr_b16 v[154:155], v16 offset:41984
    s_waitcnt lgkmcnt(6)
    v_mfma_f32_32x32x16_bf16 v[128:143], v[156:159], v[184:187], v[128:143]
    ds_read_b64_tr_b16 v[156:157], v17 offset:40960
    ds_read_b64_tr_b16 v[158:159], v17 offset:41984
    s_waitcnt vmcnt(13)
    s_waitcnt lgkmcnt(6)
    v_mfma_f32_32x32x16_bf16 v[32:47], v[144:147], v[192:195], v[32:47]
    buffer_load_dwordx4 v[184:187], v8, s[4:7], s63 offen offset:2048 sc1
    s_waitcnt vmcnt(13)
    v_mfma_f32_32x32x16_bf16 v[48:63], v[144:147], v[196:199], v[48:63]
    ds_read_b64_tr_b16 v[144:145], v14 offset:43008
    ds_read_b64_tr_b16 v[146:147], v14 offset:44032
    s_waitcnt lgkmcnt(6)
    v_mfma_f32_32x32x16_bf16 v[64:79], v[148:151], v[192:195], v[64:79]
    buffer_load_dwordx4 v[188:191], v8, s[4:7], s63 offen offset:3072 sc1
    v_mfma_f32_32x32x16_bf16 v[80:95], v[148:151], v[196:199], v[80:95]
    ds_read_b64_tr_b16 v[148:149], v15 offset:43008
    ds_read_b64_tr_b16 v[150:151], v15 offset:44032
    s_waitcnt lgkmcnt(6)
    v_mfma_f32_32x32x16_bf16 v[96:111], v[152:155], v[192:195], v[96:111]
    v_mfma_f32_32x32x16_bf16 v[112:127], v[152:155], v[196:199], v[112:127]
    ds_read_b64_tr_b16 v[152:153], v16 offset:43008
    ds_read_b64_tr_b16 v[154:155], v16 offset:44032
    s_waitcnt lgkmcnt(6)
    v_mfma_f32_32x32x16_bf16 v[128:143], v[156:159], v[192:195], v[128:143]
    ds_read_b64_tr_b16 v[156:157], v17 offset:43008
    ds_read_b64_tr_b16 v[158:159], v17 offset:44032
    s_waitcnt vmcnt(13)
    s_waitcnt lgkmcnt(6)
    v_mfma_f32_32x32x16_bf16 v[32:47], v[144:147], v[200:203], v[32:47]
    s_waitcnt vmcnt(4)
    v_pk_add_f32 v[160:161], v[160:161], v[164:165]
    v_pk_add_f32 v[162:163], v[162:163], v[166:167]
    v_pk_add_f32 v[168:169], v[168:169], v[172:173]
    v_mfma_f32_32x32x16_bf16 v[48:63], v[144:147], v[204:207], v[48:63]
    ds_read_b64_tr_b16 v[144:145], v14 offset:45056
    ds_read_b64_tr_b16 v[146:147], v14 offset:46080
    v_pk_add_f32 v[170:171], v[170:171], v[174:175]
    v_pk_add_f32 v[160:161], v[160:161], v[168:169]
    s_waitcnt lgkmcnt(6)
    v_mfma_f32_32x32x16_bf16 v[64:79], v[148:151], v[200:203], v[64:79]
    v_pk_add_f32 v[162:163], v[162:163], v[170:171]
    s_nop 1
    v_permlane16_swap_b32 v160, v162
    v_permlane16_swap_b32 v161, v163
    v_add_f32 v26, v160, v162
    v_mfma_f32_32x32x16_bf16 v[80:95], v[148:151], v[204:207], v[80:95]
    ds_read_b64_tr_b16 v[148:149], v15 offset:45056
    ds_read_b64_tr_b16 v[150:151], v15 offset:46080
    v_add_f32 v27, v161, v163
    s_waitcnt lgkmcnt(6)
    v_mfma_f32_32x32x16_bf16 v[96:111], v[152:155], v[200:203], v[96:111]
    v_mfma_f32_32x32x16_bf16 v[112:127], v[152:155], v[204:207], v[112:127]
    ds_read_b64_tr_b16 v[152:153], v16 offset:45056
    ds_read_b64_tr_b16 v[154:155], v16 offset:46080
    s_waitcnt lgkmcnt(6)
    v_mfma_f32_32x32x16_bf16 v[128:143], v[156:159], v[200:203], v[128:143]
    ds_read_b64_tr_b16 v[156:157], v17 offset:45056
    ds_read_b64_tr_b16 v[158:159], v17 offset:46080
    s_waitcnt lgkmcnt(6)
    v_mfma_f32_32x32x16_bf16 v[32:47], v[144:147], v[208:211], v[32:47]
    v_mfma_f32_32x32x16_bf16 v[48:63], v[144:147], v[212:215], v[48:63]
    ds_read_b64_tr_b16 v[144:145], v14 offset:47104
    ds_read_b64_tr_b16 v[146:147], v14 offset:48128
    s_waitcnt lgkmcnt(6)
    v_mfma_f32_32x32x16_bf16 v[64:79], v[148:151], v[208:211], v[64:79]
    v_mfma_f32_32x32x16_bf16 v[80:95], v[148:151], v[212:215], v[80:95]
    ds_read_b64_tr_b16 v[148:149], v15 offset:47104
    ds_read_b64_tr_b16 v[150:151], v15 offset:48128
    s_waitcnt lgkmcnt(6)
    v_mfma_f32_32x32x16_bf16 v[96:111], v[152:155], v[208:211], v[96:111]
    v_mfma_f32_32x32x16_bf16 v[112:127], v[152:155], v[212:215], v[112:127]
    ds_read_b64_tr_b16 v[152:153], v16 offset:47104
    ds_read_b64_tr_b16 v[154:155], v16 offset:48128
    s_waitcnt lgkmcnt(6)
    v_mfma_f32_32x32x16_bf16 v[128:143], v[156:159], v[208:211], v[128:143]
    ds_read_b64_tr_b16 v[156:157], v17 offset:47104
    ds_read_b64_tr_b16 v[158:159], v17 offset:48128
    s_waitcnt lgkmcnt(6)
    v_mfma_f32_32x32x16_bf16 v[32:47], v[144:147], v[216:219], v[32:47]
    s_waitcnt vmcnt(0)
    v_pk_add_f32 v[176:177], v[176:177], v[180:181]
    v_pk_add_f32 v[178:179], v[178:179], v[182:183]
    v_pk_add_f32 v[184:185], v[184:185], v[188:189]
    v_pk_add_f32 v[186:187], v[186:187], v[190:191]
    v_pk_add_f32 v[176:177], v[176:177], v[184:185]
    v_mfma_f32_32x32x16_bf16 v[48:63], v[144:147], v[220:223], v[48:63]
    v_pk_add_f32 v[178:179], v[178:179], v[186:187]
    s_nop 1
    v_permlane16_swap_b32 v176, v178
    v_permlane16_swap_b32 v177, v179
    v_add_f32 v28, v176, v178
    v_add_f32 v29, v177, v179
    v_permlane32_swap_b32 v26, v27
    s_waitcnt lgkmcnt(4)
    v_mfma_f32_32x32x16_bf16 v[64:79], v[148:151], v[216:219], v[64:79]
    v_permlane32_swap_b32 v28, v29
    v_add_f32 v26, v26, v27
    v_add_f32 v28, v28, v29
    v_mov_b32 v27, v26
    v_mov_b32 v29, v28
    s_nop 0
    v_permlane32_swap_b32 v26, v27
    v_mfma_f32_32x32x16_bf16 v[80:95], v[148:151], v[220:223], v[80:95]
    v_permlane32_swap_b32 v28, v29
    v_mul_f32 v18, 0xbb000000, v26
    v_mul_f32 v20, 0xbb000000, v28
    v_mul_f32 v27, 0x3b000000, v27
    v_mul_f32 v29, 0x3b000000, v29
    v_fma_f32 v27, -v18, v18, v27
    s_waitcnt lgkmcnt(2)
    v_mfma_f32_32x32x16_bf16 v[96:111], v[152:155], v[216:219], v[96:111]
    v_fma_f32 v29, -v20, v20, v29
    v_max_f32 v27, 0, v27
    v_max_f32 v29, 0, v29
    v_add_f32 v27, 0x3727c5ac, v27
    v_add_f32 v29, 0x3727c5ac, v29
    v_rsq_f32 v22, v27
    v_mfma_f32_32x32x16_bf16 v[112:127], v[152:155], v[220:223], v[112:127]
    v_rsq_f32 v24, v29
    v_cmp_gt_u32 vcc, 32, v0
    v_cvt_pk_bf16_f32 v4, v18, v18
    v_cvt_pk_bf16_f32 v6, v20, v20
    v_lshlrev_b32 v4, 16, v4
    v_lshlrev_b32 v6, 16, v6
    s_waitcnt lgkmcnt(0)
    v_mfma_f32_32x32x16_bf16 v[128:143], v[156:159], v[216:219], v[128:143]
    v_sub_f32 v5, v18, v4
    v_sub_f32 v7, v20, v6
    v_cvt_pk_bf16_f32 v4, v4, v5
    v_cvt_pk_bf16_f32 v6, v6, v7
    v_cndmask_b32 v224, 0, v4, vcc
    v_cndmask_b32 v228, 0, v6, vcc
    v_mov_b32 v225, v224
    v_mov_b32 v229, v228
    v_mul_f32 v22, v22, v22
    v_mul_f32 v24, v24, v24
    s_barrier
    s_waitcnt lgkmcnt(0)
    v_mfma_f32_32x32x16_bf16 v[32:47], v[232:235], v[224:227], v[32:47]
    v_mfma_f32_32x32x16_bf16 v[48:63], v[232:235], v[228:231], v[48:63]
    v_mfma_f32_32x32x16_bf16 v[64:79], v[236:239], v[224:227], v[64:79]
    v_mfma_f32_32x32x16_bf16 v[80:95], v[236:239], v[228:231], v[80:95]
    v_mfma_f32_32x32x16_bf16 v[96:111], v[240:243], v[224:227], v[96:111]
    v_mfma_f32_32x32x16_bf16 v[112:127], v[240:243], v[228:231], v[112:127]
    v_mfma_f32_32x32x16_bf16 v[128:143], v[244:247], v[224:227], v[128:143]
    s_lshr_b32 s57, s41, 1
    s_mul_i32 s57, s57, 7
    s_mul_i32 s58, s56, 3
    s_add_u32 s57, s57, s58
    s_mul_i32 s58, s50, 112
    s_add_u32 s58, s58, s57
    s_lshl_b32 s58, s58, 10
    s_add_u32 s58, s58, 7077888
    s_add_u32 s58, s58, s94
    s_mul_i32 s59, s51, 112
    s_add_u32 s59, s59, s57
    s_lshl_b32 s59, s59, 10
    s_add_u32 s59, s59, 7077888
    s_add_u32 s59, s59, s94
    s_add_u32 s57, s56, 0
    s_and_b32 s57, s57, 3
    s_lshl_b32 s57, s57, 10
    v_pk_mul_f32 v[32:33], v[32:33], v[40:41]
    v_pk_mul_f32 v[34:35], v[34:35], v[42:43]
    v_pk_mul_f32 v[36:37], v[36:37], v[44:45]
    v_pk_mul_f32 v[38:39], v[38:39], v[46:47]
    v_pk_mul_f32 v[32:33], v[32:33], v[22:23] op_sel_hi:[1,0]
    v_pk_mul_f32 v[34:35], v[34:35], v[22:23] op_sel_hi:[1,0]
    v_pk_mul_f32 v[36:37], v[36:37], v[22:23] op_sel_hi:[1,0]
    v_pk_mul_f32 v[38:39], v[38:39], v[22:23] op_sel_hi:[1,0]
    v_cvt_pk_bf16_f32 v160, v32, v33
    v_cvt_pk_bf16_f32 v161, v34, v35
    v_cvt_pk_bf16_f32 v162, v36, v37
    v_cvt_pk_bf16_f32 v163, v38, v39
    s_add_u32 s60, s57, s58
    buffer_store_dwordx4 v[160:163], v8, s[4:7], s60 offen
    v_pk_mul_f32 v[48:49], v[48:49], v[56:57]
    v_pk_mul_f32 v[50:51], v[50:51], v[58:59]
    v_pk_mul_f32 v[52:53], v[52:53], v[60:61]
    v_pk_mul_f32 v[54:55], v[54:55], v[62:63]
    v_pk_mul_f32 v[48:49], v[48:49], v[24:25] op_sel_hi:[1,0]
    v_pk_mul_f32 v[50:51], v[50:51], v[24:25] op_sel_hi:[1,0]
    v_pk_mul_f32 v[52:53], v[52:53], v[24:25] op_sel_hi:[1,0]
    v_pk_mul_f32 v[54:55], v[54:55], v[24:25] op_sel_hi:[1,0]
    v_cvt_pk_bf16_f32 v164, v48, v49
    v_cvt_pk_bf16_f32 v165, v50, v51
    v_cvt_pk_bf16_f32 v166, v52, v53
    v_cvt_pk_bf16_f32 v167, v54, v55
    s_add_u32 s60, s57, s59
    buffer_store_dwordx4 v[164:167], v8, s[4:7], s60 offen
    s_add_u32 s57, s56, 1
    s_and_b32 s57, s57, 3
    s_lshl_b32 s57, s57, 10
    v_pk_mul_f32 v[64:65], v[64:65], v[72:73]
    v_pk_mul_f32 v[66:67], v[66:67], v[74:75]
    v_pk_mul_f32 v[68:69], v[68:69], v[76:77]
    v_pk_mul_f32 v[70:71], v[70:71], v[78:79]
    v_pk_mul_f32 v[64:65], v[64:65], v[22:23] op_sel_hi:[1,0]
    v_pk_mul_f32 v[66:67], v[66:67], v[22:23] op_sel_hi:[1,0]
    v_pk_mul_f32 v[68:69], v[68:69], v[22:23] op_sel_hi:[1,0]
    v_pk_mul_f32 v[70:71], v[70:71], v[22:23] op_sel_hi:[1,0]
    v_cvt_pk_bf16_f32 v168, v64, v65
    v_cvt_pk_bf16_f32 v169, v66, v67
    v_cvt_pk_bf16_f32 v170, v68, v69
    v_cvt_pk_bf16_f32 v171, v70, v71
    s_add_u32 s60, s57, s58
    buffer_store_dwordx4 v[168:171], v8, s[4:7], s60 offen
    v_pk_mul_f32 v[80:81], v[80:81], v[88:89]
    v_pk_mul_f32 v[82:83], v[82:83], v[90:91]
    v_pk_mul_f32 v[84:85], v[84:85], v[92:93]
    v_pk_mul_f32 v[86:87], v[86:87], v[94:95]
    v_pk_mul_f32 v[80:81], v[80:81], v[24:25] op_sel_hi:[1,0]
    v_pk_mul_f32 v[82:83], v[82:83], v[24:25] op_sel_hi:[1,0]
    v_pk_mul_f32 v[84:85], v[84:85], v[24:25] op_sel_hi:[1,0]
    v_pk_mul_f32 v[86:87], v[86:87], v[24:25] op_sel_hi:[1,0]
    v_cvt_pk_bf16_f32 v172, v80, v81
    v_cvt_pk_bf16_f32 v173, v82, v83
    v_cvt_pk_bf16_f32 v174, v84, v85
    v_cvt_pk_bf16_f32 v175, v86, v87
    s_add_u32 s60, s57, s59
    buffer_store_dwordx4 v[172:175], v8, s[4:7], s60 offen
    s_add_u32 s57, s56, 2
    s_and_b32 s57, s57, 3
    s_lshl_b32 s57, s57, 10
    v_pk_mul_f32 v[96:97], v[96:97], v[104:105]
    v_pk_mul_f32 v[98:99], v[98:99], v[106:107]
    v_pk_mul_f32 v[100:101], v[100:101], v[108:109]
    v_pk_mul_f32 v[102:103], v[102:103], v[110:111]
    v_pk_mul_f32 v[96:97], v[96:97], v[22:23] op_sel_hi:[1,0]
    v_pk_mul_f32 v[98:99], v[98:99], v[22:23] op_sel_hi:[1,0]
    v_pk_mul_f32 v[100:101], v[100:101], v[22:23] op_sel_hi:[1,0]
    v_pk_mul_f32 v[102:103], v[102:103], v[22:23] op_sel_hi:[1,0]
    v_cvt_pk_bf16_f32 v176, v96, v97
    v_cvt_pk_bf16_f32 v177, v98, v99
    v_cvt_pk_bf16_f32 v178, v100, v101
    v_cvt_pk_bf16_f32 v179, v102, v103
    s_add_u32 s60, s57, s58
    buffer_store_dwordx4 v[176:179], v8, s[4:7], s60 offen
    v_pk_mul_f32 v[112:113], v[112:113], v[120:121]
    v_pk_mul_f32 v[114:115], v[114:115], v[122:123]
    v_pk_mul_f32 v[116:117], v[116:117], v[124:125]
    v_pk_mul_f32 v[118:119], v[118:119], v[126:127]
    v_pk_mul_f32 v[112:113], v[112:113], v[24:25] op_sel_hi:[1,0]
    v_pk_mul_f32 v[114:115], v[114:115], v[24:25] op_sel_hi:[1,0]
    v_pk_mul_f32 v[116:117], v[116:117], v[24:25] op_sel_hi:[1,0]
    v_pk_mul_f32 v[118:119], v[118:119], v[24:25] op_sel_hi:[1,0]
    v_cvt_pk_bf16_f32 v180, v112, v113
    v_cvt_pk_bf16_f32 v181, v114, v115
    v_cvt_pk_bf16_f32 v182, v116, v117
    v_cvt_pk_bf16_f32 v183, v118, v119
    s_add_u32 s60, s57, s59
    buffer_store_dwordx4 v[180:183], v8, s[4:7], s60 offen
    s_add_u32 s57, s56, 3
    s_and_b32 s57, s57, 3
    s_lshl_b32 s57, s57, 10
    v_pk_mul_f32 v[128:129], v[128:129], v[136:137]
    v_pk_mul_f32 v[130:131], v[130:131], v[138:139]
    v_pk_mul_f32 v[132:133], v[132:133], v[140:141]
    v_pk_mul_f32 v[134:135], v[134:135], v[142:143]
    v_pk_mul_f32 v[128:129], v[128:129], v[22:23] op_sel_hi:[1,0]
    v_pk_mul_f32 v[130:131], v[130:131], v[22:23] op_sel_hi:[1,0]
    v_pk_mul_f32 v[132:133], v[132:133], v[22:23] op_sel_hi:[1,0]
    v_pk_mul_f32 v[134:135], v[134:135], v[22:23] op_sel_hi:[1,0]
    v_cvt_pk_bf16_f32 v184, v128, v129
    v_cvt_pk_bf16_f32 v185, v130, v131
    v_cvt_pk_bf16_f32 v186, v132, v133
    v_cvt_pk_bf16_f32 v187, v134, v135
    s_add_u32 s60, s57, s58
    buffer_store_dwordx4 v[184:187], v8, s[4:7], s60 offen
    s_waitcnt vmcnt(0)
    s_barrier
    s_cmp_eq_u32 s42, 0
    s_cbranch_scc0 L_nosig_44
    s_lshl_b32 s46, s40, 8
    s_add_u32 s46, s46, 41947136
    s_add_u32 s46, s46, s95
    s_lshl_b32 s47, s41, 2
    v_mov_b32 v5, s47
    v_mov_b32 v6, s97
    s_mov_b64 exec, 1
    s_cmp_eq_u32 s43, 0
    s_cbranch_scc0 L_slowsig_45
    buffer_store_dword v6, v5, s[4:7], s46 offen
    s_branch L_sigdone_46
L_slowsig_45:
    buffer_wbl2 sc1
    s_waitcnt vmcnt(0)
    buffer_store_dword v6, v5, s[4:7], s46 offen sc1
L_sigdone_46:
    s_mov_b64 exec, -1
L_nosig_44:
    s_lshr_b32 s50, s41, 3
    s_lshl_b32 s50, s50, 1
    s_and_b32 s51, s42, 1
    s_add_u32 s50, s50, s51
    s_lshl_b32 s51, s40, 3
    s_add_u32 s50, s50, s51
    s_and_b32 s51, s41, 7
    s_lshr_b32 s52, s42, 1
    v_lshlrev_b32 v8, 4, v0
    s_mul_i32 s53, s50, 32768
    s_lshl_b32 s54, s51, 12
    s_add_u32 s53, s53, s54
    s_lshl_b32 s54, s52, 11
    s_add_u32 s53, s53, s54
    s_add_u32 s54, s53, 2359296
    s_add_u32 s54, s54, s94
    buffer_load_dwordx4 v[64:67], v8, s[4:7], s54 offen sc1
    buffer_load_dwordx4 v[68:71], v8, s[4:7], s54 offen offset:1024 sc1
    s_mul_i32 s55, s52, 14336
    v_lshrrev_b32 v4, 5, v0
    v_lshlrev_b32 v4, 2, v4
    v_bfe_u32 v1, v0, 2, 2
    v_add_u32 v1, v1, v4
    v_bfe_u32 v2, v0, 4, 1
    v_and_b32 v3, 3, v0
    v_lshlrev_b32 v3, 3, v3
    v_bfe_u32 v4, v1, 1, 1
    v_xor_b32 v4, s52, v4
    v_lshlrev_b32 v9, 7, v1
    v_lshl_add_u32 v9, v4, 6, v9
    v_lshl_add_u32 v9, v2, 5, v9
    v_add_u32 v9, v9, v3
    v_add_u32 v9, s55, v9
    v_xor_b32 v10, 64, v9
    v_add_u32 v12, 131072, v9
    v_add_u32 v13, 131072, v10
    ds_read_b64_tr_b16 v[72:73], v12 offset:0
    ds_read_b64_tr_b16 v[74:75], v12 offset:1024
    ds_read_b64_tr_b16 v[76:77], v13 offset:0
    ds_read_b64_tr_b16 v[78:79], v13 offset:1024
    ds_read_b64_tr_b16 v[80:81], v12 offset:2048
    ds_read_b64_tr_b16 v[82:83], v12 offset:3072
    ds_read_b64_tr_b16 v[84:85], v13 offset:2048
    ds_read_b64_tr_b16 v[86:87], v13 offset:3072
    s_waitcnt vmcnt(0)
    v_lshlrev_b32 v32, 16, v64
    v_and_b32 v33, 0xffff0000, v64
    v_lshlrev_b32 v34, 16, v65
    v_and_b32 v35, 0xffff0000, v65
    v_lshlrev_b32 v36, 16, v66
    v_and_b32 v37, 0xffff0000, v66
    v_lshlrev_b32 v38, 16, v67
    v_and_b32 v39, 0xffff0000, v67
    v_lshlrev_b32 v40, 16, v68
    v_and_b32 v41, 0xffff0000, v68
    v_lshlrev_b32 v42, 16, v69
    v_and_b32 v43, 0xffff0000, v69
    v_lshlrev_b32 v44, 16, v70
    v_and_b32 v45, 0xffff0000, v70
    v_lshlrev_b32 v46, 16, v71
    v_and_b32 v47, 0xffff0000, v71
    s_mul_i32 s56, s50, 112
    s_mul_i32 s57, s52, 56
    s_add_u32 s56, s56, s57
    s_lshl_b32 s56, s56, 10
    s_add_u32 s60, s56, 7077888
    s_add_u32 s60, s60, s94
    s_lshl_b32 s46, s40, 8
    s_add_u32 s46, s46, 41947136
    s_add_u32 s46, s46, s95
    v_lshlrev_b32 v5, 2, v0
    s_mov_b32 exec_lo, 0xffffffff
    s_mov_b32 exec_hi, 0x0
    s_mov_b32 s45, 0
L_poll_47:
    buffer_load_dword v6, v5, s[4:7], s46 offen sc1
    s_waitcnt vmcnt(0)
    v_subrev_u32 v6, s97, v6
    v_cmp_gt_u32 vcc, 2, v6
    s_cmp_eq_u64 vcc, exec
    s_cbranch_scc1 L_polldone_48
    s_add_u32 s45, s45, 1
    s_cmp_lt_u32 s45, 200000
    s_cbranch_scc1 L_poll_47
    v_mov_b32 v6, 102
    v_mov_b32 v7, 20
    buffer_store_dword v6, v7, s[36:39], 0 offen
    s_waitcnt vmcnt(0)
L_polldone_48:
    s_mov_b64 exec, -1
    s_cmp_eq_u32 s43, 0
    s_cbranch_scc1 L_noinv_49
    buffer_inv sc1
    s_waitcnt vmcnt(0)
L_noinv_49:
    buffer_load_dwordx4 v[96:99], v8, s[4:7], s60 offen offset:0 sc1
    buffer_load_dwordx4 v[100:103], v8, s[4:7], s60 offen offset:1024 sc1
    buffer_load_dwordx4 v[104:107], v8, s[4:7], s60 offen offset:2048 sc1
    buffer_load_dwordx4 v[108:111], v8, s[4:7], s60 offen offset:3072 sc1
    s_add_u32 s60, s60, 4096
    buffer_load_dwordx4 v[112:115], v8, s[4:7], s60 offen offset:0 sc1
    buffer_load_dwordx4 v[116:119], v8, s[4:7], s60 offen offset:1024 sc1
    s_waitcnt vmcnt(5)
    s_waitcnt lgkmcnt(4)
    v_mfma_f32_32x32x16_bf16 v[32:47], v[72:75], v[96:99], v[32:47]
    ds_read_b64_tr_b16 v[88:89], v12 offset:4096
    ds_read_b64_tr_b16 v[90:91], v12 offset:5120
    buffer_load_dwordx4 v[120:123], v8, s[4:7], s60 offen offset:2048 sc1
    v_mfma_f32_32x32x16_bf16 v[48:63], v[76:79], v[96:99], 0
    ds_read_b64_tr_b16 v[92:93], v13 offset:4096
    ds_read_b64_tr_b16 v[94:95], v13 offset:5120
    buffer_load_dwordx4 v[124:127], v8, s[4:7], s60 offen offset:3072 sc1
    s_waitcnt vmcnt(6)
    s_waitcnt lgkmcnt(4)
    v_mfma_f32_32x32x16_bf16 v[32:47], v[80:83], v[100:103], v[32:47]
    ds_read_b64_tr_b16 v[72:73], v12 offset:6144
    ds_read_b64_tr_b16 v[74:75], v12 offset:7168
    s_add_u32 s60, s60, 4096
    buffer_load_dwordx4 v[128:131], v8, s[4:7], s60 offen offset:0 sc1
    v_mfma_f32_32x32x16_bf16 v[48:63], v[84:87], v[100:103], v[48:63]
    ds_read_b64_tr_b16 v[76:77], v13 offset:6144
    ds_read_b64_tr_b16 v[78:79], v13 offset:7168
    buffer_load_dwordx4 v[132:135], v8, s[4:7], s60 offen offset:1024 sc1
    s_waitcnt vmcnt(7)
    s_waitcnt lgkmcnt(4)
    v_mfma_f32_32x32x16_bf16 v[32:47], v[88:91], v[104:107], v[32:47]
    ds_read_b64_tr_b16 v[80:81], v12 offset:8192
    ds_read_b64_tr_b16 v[82:83], v12 offset:9216
    buffer_load_dwordx4 v[136:139], v8, s[4:7], s60 offen offset:2048 sc1
    v_mfma_f32_32x32x16_bf16 v[48:63], v[92:95], v[104:107], v[48:63]
    ds_read_b64_tr_b16 v[84:85], v13 offset:8192
    ds_read_b64_tr_b16 v[86:87], v13 offset:9216
    buffer_load_dwordx4 v[140:143], v8, s[4:7], s60 offen offset:3072 sc1
    s_waitcnt vmcnt(8)
    s_waitcnt lgkmcnt(4)
    v_mfma_f32_32x32x16_bf16 v[32:47], v[72:75], v[108:111], v[32:47]
    ds_read_b64_tr_b16 v[88:89], v12 offset:10240
    ds_read_b64_tr_b16 v[90:91], v12 offset:11264
    s_add_u32 s60, s60, 4096
    buffer_load_dwordx4 v[96:99], v8, s[4:7], s60 offen offset:0 sc1
    v_mfma_f32_32x32x16_bf16 v[48:63], v[76:79], v[108:111], v[48:63]
    ds_read_b64_tr_b16 v[92:93], v13 offset:10240
    ds_read_b64_tr_b16 v[94:95], v13 offset:11264
    buffer_load_dwordx4 v[100:103], v8, s[4:7], s60 offen offset:1024 sc1
    s_waitcnt vmcnt(9)
    s_waitcnt lgkmcnt(4)
    v_mfma_f32_32x32x16_bf16 v[32:47], v[80:83], v[112:115], v[32:47]
    ds_read_b64_tr_b16 v[72:73], v12 offset:12288
    ds_read_b64_tr_b16 v[74:75], v12 offset:13312
    buffer_load_dwordx4 v[104:107], v8, s[4:7], s60 offen offset:2048 sc1
    v_mfma_f32_32x32x16_bf16 v[48:63], v[84:87], v[112:115], v[48:63]
    ds_read_b64_tr_b16 v[76:77], v13 offset:12288
    ds_read_b64_tr_b16 v[78:79], v13 offset:13312
    buffer_load_dwordx4 v[108:111], v8, s[4:7], s60 offen offset:3072 sc1
    s_waitcnt vmcnt(10)
    s_waitcnt lgkmcnt(4)
    v_mfma_f32_32x32x16_bf16 v[32:47], v[88:91], v[116:119], v[32:47]
    v_add_u32 v14, 0, v9
    v_add_u32 v15, 0, v10
    ds_read_b64_tr_b16 v[80:81], v14 offset:0
    ds_read_b64_tr_b16 v[82:83], v14 offset:1024
    s_add_u32 s60, s60, 4096
    buffer_load_dwordx4 v[112:115], v8, s[4:7], s60 offen offset:0 sc1
    v_mfma_f32_32x32x16_bf16 v[48:63], v[92:95], v[116:119], v[48:63]
    ds_read_b64_tr_b16 v[84:85], v15 offset:0
    ds_read_b64_tr_b16 v[86:87], v15 offset:1024
    s_waitcnt vmcnt(10)
    s_waitcnt lgkmcnt(4)
    v_mfma_f32_32x32x16_bf16 v[32:47], v[72:75], v[120:123], v[32:47]
    ds_read_b64_tr_b16 v[88:89], v14 offset:2048
    ds_read_b64_tr_b16 v[90:91], v14 offset:3072
    buffer_load_dwordx4 v[116:119], v8, s[4:7], s60 offen offset:1024 sc1
    v_mfma_f32_32x32x16_bf16 v[48:63], v[76:79], v[120:123], v[48:63]
    ds_read_b64_tr_b16 v[92:93], v15 offset:2048
    ds_read_b64_tr_b16 v[94:95], v15 offset:3072
    s_barrier
    s_waitcnt vmcnt(10)
    s_waitcnt lgkmcnt(4)
    v_mfma_f32_32x32x16_bf16 v[32:47], v[80:83], v[124:127], v[32:47]
    ds_read_b64_tr_b16 v[72:73], v14 offset:4096
    ds_read_b64_tr_b16 v[74:75], v14 offset:5120
    buffer_load_dwordx4 v[120:123], v8, s[4:7], s60 offen offset:2048 sc1
    v_mfma_f32_32x32x16_bf16 v[48:63], v[84:87], v[124:127], v[48:63]
    ds_read_b64_tr_b16 v[76:77], v15 offset:4096
    ds_read_b64_tr_b16 v[78:79], v15 offset:5120
    s_waitcnt vmcnt(10)
    s_waitcnt lgkmcnt(4)
    v_mfma_f32_32x32x16_bf16 v[32:47], v[88:91], v[128:131], v[32:47]
    ds_read_b64_tr_b16 v[80:81], v14 offset:6144
    ds_read_b64_tr_b16 v[82:83], v14 offset:7168
    buffer_load_dwordx4 v[124:127], v8, s[4:7], s60 offen offset:3072 sc1
    v_mfma_f32_32x32x16_bf16 v[48:63], v[92:95], v[128:131], v[48:63]
    ds_read_b64_tr_b16 v[84:85], v15 offset:6144
    ds_read_b64_tr_b16 v[86:87], v15 offset:7168
    s_waitcnt vmcnt(10)
    s_waitcnt lgkmcnt(4)
    v_mfma_f32_32x32x16_bf16 v[32:47], v[72:75], v[132:135], v[32:47]
    ds_read_b64_tr_b16 v[88:89], v14 offset:8192
    ds_read_b64_tr_b16 v[90:91], v14 offset:9216
    s_add_u32 s60, s60, 4096
    buffer_load_dwordx4 v[128:131], v8, s[4:7], s60 offen offset:0 sc1
    v_mfma_f32_32x32x16_bf16 v[48:63], v[76:79], v[132:135], v[48:63]
    ds_read_b64_tr_b16 v[92:93], v15 offset:8192
    ds_read_b64_tr_b16 v[94:95], v15 offset:9216
    s_waitcnt vmcnt(10)
    s_waitcnt lgkmcnt(4)
    v_mfma_f32_32x32x16_bf16 v[32:47], v[80:83], v[136:139], v[32:47]
    ds_read_b64_tr_b16 v[72:73], v14 offset:10240
    ds_read_b64_tr_b16 v[74:75], v14 offset:11264
    buffer_load_dwordx4 v[132:135], v8, s[4:7], s60 offen offset:1024 sc1
    v_mfma_f32_32x32x16_bf16 v[48:63], v[84:87], v[136:139], v[48:63]
    ds_read_b64_tr_b16 v[76:77], v15 offset:10240
    ds_read_b64_tr_b16 v[78:79], v15 offset:11264
    s_waitcnt vmcnt(10)
    s_waitcnt lgkmcnt(4)
    v_mfma_f32_32x32x16_bf16 v[32:47], v[88:91], v[140:143], v[32:47]
    ds_read_b64_tr_b16 v[80:81], v14 offset:12288
    ds_read_b64_tr_b16 v[82:83], v14 offset:13312
    buffer_load_dwordx4 v[136:139], v8, s[4:7], s60 offen offset:2048 sc1
    v_mfma_f32_32x32x16_bf16 v[48:63], v[92:95], v[140:143], v[48:63]
    ds_read_b64_tr_b16 v[84:85], v15 offset:12288
    ds_read_b64_tr_b16 v[86:87], v15 offset:13312
    s_waitcnt vmcnt(10)
    s_waitcnt lgkmcnt(4)
    v_mfma_f32_32x32x16_bf16 v[32:47], v[72:75], v[96:99], v[32:47]
    v_add_u32 v12, 32768, v9
    v_add_u32 v13, 32768, v10
    ds_read_b64_tr_b16 v[88:89], v12 offset:0
    ds_read_b64_tr_b16 v[90:91], v12 offset:1024
    buffer_load_dwordx4 v[140:143], v8, s[4:7], s60 offen offset:3072 sc1
    v_mfma_f32_32x32x16_bf16 v[48:63], v[76:79], v[96:99], v[48:63]
    ds_read_b64_tr_b16 v[92:93], v13 offset:0
    ds_read_b64_tr_b16 v[94:95], v13 offset:1024
    s_waitcnt vmcnt(10)
    s_waitcnt lgkmcnt(4)
    v_mfma_f32_32x32x16_bf16 v[32:47], v[80:83], v[100:103], v[32:47]
    ds_read_b64_tr_b16 v[72:73], v12 offset:2048
    ds_read_b64_tr_b16 v[74:75], v12 offset:3072
    s_add_u32 s60, s60, 4096
    buffer_load_dwordx4 v[96:99], v8, s[4:7], s60 offen offset:0 sc1
    v_mfma_f32_32x32x16_bf16 v[48:63], v[84:87], v[100:103], v[48:63]
    ds_read_b64_tr_b16 v[76:77], v13 offset:2048
    ds_read_b64_tr_b16 v[78:79], v13 offset:3072
    s_barrier
    s_waitcnt vmcnt(10)
    s_waitcnt lgkmcnt(4)
    v_mfma_f32_32x32x16_bf16 v[32:47], v[88:91], v[104:107], v[32:47]
    ds_read_b64_tr_b16 v[80:81], v12 offset:4096
    ds_read_b64_tr_b16 v[82:83], v12 offset:5120
    buffer_load_dwordx4 v[100:103], v8, s[4:7], s60 offen offset:1024 sc1
    v_mfma_f32_32x32x16_bf16 v[48:63], v[92:95], v[104:107], v[48:63]
    ds_read_b64_tr_b16 v[84:85], v13 offset:4096
    ds_read_b64_tr_b16 v[86:87], v13 offset:5120
    s_waitcnt vmcnt(10)
    s_waitcnt lgkmcnt(4)
    v_mfma_f32_32x32x16_bf16 v[32:47], v[72:75], v[108:111], v[32:47]
    ds_read_b64_tr_b16 v[88:89], v12 offset:6144
    ds_read_b64_tr_b16 v[90:91], v12 offset:7168
    buffer_load_dwordx4 v[104:107], v8, s[4:7], s60 offen offset:2048 sc1
    v_mfma_f32_32x32x16_bf16 v[48:63], v[76:79], v[108:111], v[48:63]
    ds_read_b64_tr_b16 v[92:93], v13 offset:6144
    ds_read_b64_tr_b16 v[94:95], v13 offset:7168
    s_waitcnt vmcnt(10)
    s_waitcnt lgkmcnt(4)
    v_mfma_f32_32x32x16_bf16 v[32:47], v[80:83], v[112:115], v[32:47]
    ds_read_b64_tr_b16 v[72:73], v12 offset:8192
    ds_read_b64_tr_b16 v[74:75], v12 offset:9216
    buffer_load_dwordx4 v[108:111], v8, s[4:7], s60 offen offset:3072 sc1
    v_mfma_f32_32x32x16_bf16 v[48:63], v[84:87], v[112:115], v[48:63]
    ds_read_b64_tr_b16 v[76:77], v13 offset:8192
    ds_read_b64_tr_b16 v[78:79], v13 offset:9216
    s_waitcnt vmcnt(10)
    s_waitcnt lgkmcnt(4)
    v_mfma_f32_32x32x16_bf16 v[32:47], v[88:91], v[116:119], v[32:47]
    ds_read_b64_tr_b16 v[80:81], v12 offset:10240
    ds_read_b64_tr_b16 v[82:83], v12 offset:11264
    s_add_u32 s60, s60, 4096
    buffer_load_dwordx4 v[112:115], v8, s[4:7], s60 offen offset:0 sc1
    v_mfma_f32_32x32x16_bf16 v[48:63], v[92:95], v[116:119], v[48:63]
    ds_read_b64_tr_b16 v[84:85], v13 offset:10240
    ds_read_b64_tr_b16 v[86:87], v13 offset:11264
    s_waitcnt vmcnt(10)
    s_waitcnt lgkmcnt(4)
    v_mfma_f32_32x32x16_bf16 v[32:47], v[72:75], v[120:123], v[32:47]
    ds_read_b64_tr_b16 v[88:89], v12 offset:12288
    ds_read_b64_tr_b16 v[90:91], v12 offset:13312
    buffer_load_dwordx4 v[116:119], v8, s[4:7], s60 offen offset:1024 sc1
    v_mfma_f32_32x32x16_bf16 v[48:63], v[76:79], v[120:123], v[48:63]
    ds_read_b64_tr_b16 v[92:93], v13 offset:12288
    ds_read_b64_tr_b16 v[94:95], v13 offset:13312
    s_waitcnt vmcnt(10)
    s_waitcnt lgkmcnt(4)
    v_mfma_f32_32x32x16_bf16 v[32:47], v[80:83], v[124:127], v[32:47]
    v_add_u32 v14, 65536, v9
    v_add_u32 v15, 65536, v10
    ds_read_b64_tr_b16 v[72:73], v14 offset:0
    ds_read_b64_tr_b16 v[74:75], v14 offset:1024
    buffer_load_dwordx4 v[120:123], v8, s[4:7], s60 offen offset:2048 sc1
    v_mfma_f32_32x32x16_bf16 v[48:63], v[84:87], v[124:127], v[48:63]
    ds_read_b64_tr_b16 v[76:77], v15 offset:0
    ds_read_b64_tr_b16 v[78:79], v15 offset:1024
    s_waitcnt vmcnt(10)
    s_waitcnt lgkmcnt(4)
    v_mfma_f32_32x32x16_bf16 v[32:47], v[88:91], v[128:131], v[32:47]
    ds_read_b64_tr_b16 v[80:81], v14 offset:2048
    ds_read_b64_tr_b16 v[82:83], v14 offset:3072
    buffer_load_dwordx4 v[124:127], v8, s[4:7], s60 offen offset:3072 sc1
    v_mfma_f32_32x32x16_bf16 v[48:63], v[92:95], v[128:131], v[48:63]
    ds_read_b64_tr_b16 v[84:85], v15 offset:2048
    ds_read_b64_tr_b16 v[86:87], v15 offset:3072
    s_barrier
    s_waitcnt vmcnt(10)
    s_waitcnt lgkmcnt(4)
    v_mfma_f32_32x32x16_bf16 v[32:47], v[72:75], v[132:135], v[32:47]
    ds_read_b64_tr_b16 v[88:89], v14 offset:4096
    ds_read_b64_tr_b16 v[90:91], v14 offset:5120
    s_add_u32 s60, s60, 4096
    buffer_load_dwordx4 v[128:131], v8, s[4:7], s60 offen offset:0 sc1
    v_mfma_f32_32x32x16_bf16 v[48:63], v[76:79], v[132:135], v[48:63]
    ds_read_b64_tr_b16 v[92:93], v15 offset:4096
    ds_read_b64_tr_b16 v[94:95], v15 offset:5120
    s_waitcnt vmcnt(10)
    s_waitcnt lgkmcnt(4)
    v_mfma_f32_32x32x16_bf16 v[32:47], v[80:83], v[136:139], v[32:47]
    ds_read_b64_tr_b16 v[72:73], v14 offset:6144
    ds_read_b64_tr_b16 v[74:75], v14 offset:7168
    buffer_load_dwordx4 v[132:135], v8, s[4:7], s60 offen offset:1024 sc1
    v_mfma_f32_32x32x16_bf16 v[48:63], v[84:87], v[136:139], v[48:63]
    ds_read_b64_tr_b16 v[76:77], v15 offset:6144
    ds_read_b64_tr_b16 v[78:79], v15 offset:7168
    s_waitcnt vmcnt(10)
    s_waitcnt lgkmcnt(4)
    v_mfma_f32_32x32x16_bf16 v[32:47], v[88:91], v[140:143], v[32:47]
    ds_read_b64_tr_b16 v[80:81], v14 offset:8192
    ds_read_b64_tr_b16 v[82:83], v14 offset:9216
    buffer_load_dwordx4 v[136:139], v8, s[4:7], s60 offen offset:2048 sc1
    v_mfma_f32_32x32x16_bf16 v[48:63], v[92:95], v[140:143], v[48:63]
    ds_read_b64_tr_b16 v[84:85], v15 offset:8192
    ds_read_b64_tr_b16 v[86:87], v15 offset:9216
    s_waitcnt vmcnt(10)
    s_waitcnt lgkmcnt(4)
    v_mfma_f32_32x32x16_bf16 v[32:47], v[72:75], v[96:99], v[32:47]
    ds_read_b64_tr_b16 v[88:89], v14 offset:10240
    ds_read_b64_tr_b16 v[90:91], v14 offset:11264
    buffer_load_dwordx4 v[140:143], v8, s[4:7], s60 offen offset:3072 sc1
    v_mfma_f32_32x32x16_bf16 v[48:63], v[76:79], v[96:99], v[48:63]
    ds_read_b64_tr_b16 v[92:93], v15 offset:10240
    ds_read_b64_tr_b16 v[94:95], v15 offset:11264
    s_waitcnt vmcnt(10)
    s_waitcnt lgkmcnt(4)
    v_mfma_f32_32x32x16_bf16 v[32:47], v[80:83], v[100:103], v[32:47]
    ds_read_b64_tr_b16 v[72:73], v14 offset:12288
    ds_read_b64_tr_b16 v[74:75], v14 offset:13312
    s_add_u32 s60, s60, 4096
    buffer_load_dwordx4 v[96:99], v8, s[4:7], s60 offen offset:0 sc1
    v_mfma_f32_32x32x16_bf16 v[48:63], v[84:87], v[100:103], v[48:63]
    ds_read_b64_tr_b16 v[76:77], v15 offset:12288
    ds_read_b64_tr_b16 v[78:79], v15 offset:13312
    s_waitcnt vmcnt(10)
    s_waitcnt lgkmcnt(4)
    v_mfma_f32_32x32x16_bf16 v[32:47], v[88:91], v[104:107], v[32:47]
    v_add_u32 v12, 98304, v9
    v_add_u32 v13, 98304, v10
    ds_read_b64_tr_b16 v[80:81], v12 offset:0
    ds_read_b64_tr_b16 v[82:83], v12 offset:1024
    buffer_load_dwordx4 v[100:103], v8, s[4:7], s60 offen offset:1024 sc1
    v_mfma_f32_32x32x16_bf16 v[48:63], v[92:95], v[104:107], v[48:63]
    ds_read_b64_tr_b16 v[84:85], v13 offset:0
    ds_read_b64_tr_b16 v[86:87], v13 offset:1024
    s_waitcnt vmcnt(10)
    s_waitcnt lgkmcnt(4)
    v_mfma_f32_32x32x16_bf16 v[32:47], v[72:75], v[108:111], v[32:47]
    ds_read_b64_tr_b16 v[88:89], v12 offset:2048
    ds_read_b64_tr_b16 v[90:91], v12 offset:3072
    buffer_load_dwordx4 v[104:107], v8, s[4:7], s60 offen offset:2048 sc1
    v_mfma_f32_32x32x16_bf16 v[48:63], v[76:79], v[108:111], v[48:63]
    ds_read_b64_tr_b16 v[92:93], v13 offset:2048
    ds_read_b64_tr_b16 v[94:95], v13 offset:3072
    s_barrier
    s_waitcnt vmcnt(10)
    s_waitcnt lgkmcnt(4)
    v_mfma_f32_32x32x16_bf16 v[32:47], v[80:83], v[112:115], v[32:47]
    ds_read_b64_tr_b16 v[72:73], v12 offset:4096
    ds_read_b64_tr_b16 v[74:75], v12 offset:5120
    buffer_load_dwordx4 v[108:111], v8, s[4:7], s60 offen offset:3072 sc1
    v_mfma_f32_32x32x16_bf16 v[48:63], v[84:87], v[112:115], v[48:63]
    ds_read_b64_tr_b16 v[76:77], v13 offset:4096
    ds_read_b64_tr_b16 v[78:79], v13 offset:5120
    s_waitcnt vmcnt(10)
    s_waitcnt lgkmcnt(4)
    v_mfma_f32_32x32x16_bf16 v[32:47], v[88:91], v[116:119], v[32:47]
    ds_read_b64_tr_b16 v[80:81], v12 offset:6144
    ds_read_b64_tr_b16 v[82:83], v12 offset:7168
    s_add_u32 s60, s60, 4096
    buffer_load_dwordx4 v[112:115], v8, s[4:7], s60 offen offset:0 sc1
    v_mfma_f32_32x32x16_bf16 v[48:63], v[92:95], v[116:119], v[48:63]
    ds_read_b64_tr_b16 v[84:85], v13 offset:6144
    ds_read_b64_tr_b16 v[86:87], v13 offset:7168
    s_waitcnt vmcnt(10)
    s_waitcnt lgkmcnt(4)
    v_mfma_f32_32x32x16_bf16 v[32:47], v[72:75], v[120:123], v[32:47]
    ds_read_b64_tr_b16 v[88:89], v12 offset:8192
    ds_read_b64_tr_b16 v[90:91], v12 offset:9216
    buffer_load_dwordx4 v[116:119], v8, s[4:7], s60 offen offset:1024 sc1
    v_mfma_f32_32x32x16_bf16 v[48:63], v[76:79], v[120:123], v[48:63]
    ds_read_b64_tr_b16 v[92:93], v13 offset:8192
    ds_read_b64_tr_b16 v[94:95], v13 offset:9216
    s_waitcnt vmcnt(10)
    s_waitcnt lgkmcnt(4)
    v_mfma_f32_32x32x16_bf16 v[32:47], v[80:83], v[124:127], v[32:47]
    ds_read_b64_tr_b16 v[72:73], v12 offset:10240
    ds_read_b64_tr_b16 v[74:75], v12 offset:11264
    buffer_load_dwordx4 v[120:123], v8, s[4:7], s60 offen offset:2048 sc1
    v_mfma_f32_32x32x16_bf16 v[48:63], v[84:87], v[124:127], v[48:63]
    ds_read_b64_tr_b16 v[76:77], v13 offset:10240
    ds_read_b64_tr_b16 v[78:79], v13 offset:11264
    s_waitcnt vmcnt(10)
    s_waitcnt lgkmcnt(4)
    v_mfma_f32_32x32x16_bf16 v[32:47], v[88:91], v[128:131], v[32:47]
    ds_read_b64_tr_b16 v[80:81], v12 offset:12288
    ds_read_b64_tr_b16 v[82:83], v12 offset:13312
    buffer_load_dwordx4 v[124:127], v8, s[4:7], s60 offen offset:3072 sc1
    v_mfma_f32_32x32x16_bf16 v[48:63], v[92:95], v[128:131], v[48:63]
    ds_read_b64_tr_b16 v[84:85], v13 offset:12288
    ds_read_b64_tr_b16 v[86:87], v13 offset:13312
    s_waitcnt vmcnt(10)
    s_waitcnt lgkmcnt(4)
    v_mfma_f32_32x32x16_bf16 v[32:47], v[72:75], v[132:135], v[32:47]
    v_add_u32 v14, 131072, v9
    v_add_u32 v15, 131072, v10
    ds_read_b64_tr_b16 v[88:89], v14 offset:0
    ds_read_b64_tr_b16 v[90:91], v14 offset:1024
    s_add_u32 s60, s60, 4096
    buffer_load_dwordx4 v[128:131], v8, s[4:7], s60 offen offset:0 sc1
    v_mfma_f32_32x32x16_bf16 v[48:63], v[76:79], v[132:135], v[48:63]
    ds_read_b64_tr_b16 v[92:93], v15 offset:0
    ds_read_b64_tr_b16 v[94:95], v15 offset:1024
    s_waitcnt vmcnt(10)
    s_waitcnt lgkmcnt(4)
    v_mfma_f32_32x32x16_bf16 v[32:47], v[80:83], v[136:139], v[32:47]
    ds_read_b64_tr_b16 v[72:73], v14 offset:2048
    ds_read_b64_tr_b16 v[74:75], v14 offset:3072
    buffer_load_dwordx4 v[132:135], v8, s[4:7], s60 offen offset:1024 sc1
    v_mfma_f32_32x32x16_bf16 v[48:63], v[84:87], v[136:139], v[48:63]
    ds_read_b64_tr_b16 v[76:77], v15 offset:2048
    ds_read_b64_tr_b16 v[78:79], v15 offset:3072
    s_barrier
    s_waitcnt vmcnt(10)
    s_waitcnt lgkmcnt(4)
    v_mfma_f32_32x32x16_bf16 v[32:47], v[88:91], v[140:143], v[32:47]
    ds_read_b64_tr_b16 v[80:81], v14 offset:4096
    ds_read_b64_tr_b16 v[82:83], v14 offset:5120
    buffer_load_dwordx4 v[136:139], v8, s[4:7], s60 offen offset:2048 sc1
    v_mfma_f32_32x32x16_bf16 v[48:63], v[92:95], v[140:143], v[48:63]
    ds_read_b64_tr_b16 v[84:85], v15 offset:4096
    ds_read_b64_tr_b16 v[86:87], v15 offset:5120
    s_waitcnt vmcnt(10)
    s_waitcnt lgkmcnt(4)
    v_mfma_f32_32x32x16_bf16 v[32:47], v[72:75], v[96:99], v[32:47]
    ds_read_b64_tr_b16 v[88:89], v14 offset:6144
    ds_read_b64_tr_b16 v[90:91], v14 offset:7168
    buffer_load_dwordx4 v[140:143], v8, s[4:7], s60 offen offset:3072 sc1
    v_mfma_f32_32x32x16_bf16 v[48:63], v[76:79], v[96:99], v[48:63]
    ds_read_b64_tr_b16 v[92:93], v15 offset:6144
    ds_read_b64_tr_b16 v[94:95], v15 offset:7168
    s_waitcnt vmcnt(10)
    s_waitcnt lgkmcnt(4)
    v_mfma_f32_32x32x16_bf16 v[32:47], v[80:83], v[100:103], v[32:47]
    ds_read_b64_tr_b16 v[72:73], v14 offset:8192
    ds_read_b64_tr_b16 v[74:75], v14 offset:9216
    s_add_u32 s60, s60, 4096
    buffer_load_dwordx4 v[96:99], v8, s[4:7], s60 offen offset:0 sc1
    v_mfma_f32_32x32x16_bf16 v[48:63], v[84:87], v[100:103], v[48:63]
    ds_read_b64_tr_b16 v[76:77], v15 offset:8192
    ds_read_b64_tr_b16 v[78:79], v15 offset:9216
    s_waitcnt vmcnt(10)
    s_waitcnt lgkmcnt(4)
    v_mfma_f32_32x32x16_bf16 v[32:47], v[88:91], v[104:107], v[32:47]
    ds_read_b64_tr_b16 v[80:81], v14 offset:10240
    ds_read_b64_tr_b16 v[82:83], v14 offset:11264
    buffer_load_dwordx4 v[100:103], v8, s[4:7], s60 offen offset:1024 sc1
    v_mfma_f32_32x32x16_bf16 v[48:63], v[92:95], v[104:107], v[48:63]
    ds_read_b64_tr_b16 v[84:85], v15 offset:10240
    ds_read_b64_tr_b16 v[86:87], v15 offset:11264
    s_waitcnt vmcnt(10)
    s_waitcnt lgkmcnt(4)
    v_mfma_f32_32x32x16_bf16 v[32:47], v[72:75], v[108:111], v[32:47]
    ds_read_b64_tr_b16 v[88:89], v14 offset:12288
    ds_read_b64_tr_b16 v[90:91], v14 offset:13312
    buffer_load_dwordx4 v[104:107], v8, s[4:7], s60 offen offset:2048 sc1
    v_mfma_f32_32x32x16_bf16 v[48:63], v[76:79], v[108:111], v[48:63]
    ds_read_b64_tr_b16 v[92:93], v15 offset:12288
    ds_read_b64_tr_b16 v[94:95], v15 offset:13312
    s_waitcnt vmcnt(10)
    s_waitcnt lgkmcnt(4)
    v_mfma_f32_32x32x16_bf16 v[32:47], v[80:83], v[112:115], v[32:47]
    v_add_u32 v12, 0, v9
    v_add_u32 v13, 0, v10
    ds_read_b64_tr_b16 v[72:73], v12 offset:0
    ds_read_b64_tr_b16 v[74:75], v12 offset:1024
    buffer_load_dwordx4 v[108:111], v8, s[4:7], s60 offen offset:3072 sc1
    v_mfma_f32_32x32x16_bf16 v[48:63], v[84:87], v[112:115], v[48:63]
    ds_read_b64_tr_b16 v[76:77], v13 offset:0
    ds_read_b64_tr_b16 v[78:79], v13 offset:1024
    s_waitcnt vmcnt(10)
    s_waitcnt lgkmcnt(4)
    v_mfma_f32_32x32x16_bf16 v[32:47], v[88:91], v[116:119], v[32:47]
    ds_read_b64_tr_b16 v[80:81], v12 offset:2048
    ds_read_b64_tr_b16 v[82:83], v12 offset:3072
    s_add_u32 s60, s60, 4096
    buffer_load_dwordx4 v[112:115], v8, s[4:7], s60 offen offset:0 sc1
    v_mfma_f32_32x32x16_bf16 v[48:63], v[92:95], v[116:119], v[48:63]
    ds_read_b64_tr_b16 v[84:85], v13 offset:2048
    ds_read_b64_tr_b16 v[86:87], v13 offset:3072
    s_barrier
    s_waitcnt vmcnt(10)
    s_waitcnt lgkmcnt(4)
    v_mfma_f32_32x32x16_bf16 v[32:47], v[72:75], v[120:123], v[32:47]
    ds_read_b64_tr_b16 v[88:89], v12 offset:4096
    ds_read_b64_tr_b16 v[90:91], v12 offset:5120
    buffer_load_dwordx4 v[116:119], v8, s[4:7], s60 offen offset:1024 sc1
    v_mfma_f32_32x32x16_bf16 v[48:63], v[76:79], v[120:123], v[48:63]
    ds_read_b64_tr_b16 v[92:93], v13 offset:4096
    ds_read_b64_tr_b16 v[94:95], v13 offset:5120
    s_waitcnt vmcnt(10)
    s_waitcnt lgkmcnt(4)
    v_mfma_f32_32x32x16_bf16 v[32:47], v[80:83], v[124:127], v[32:47]
    ds_read_b64_tr_b16 v[72:73], v12 offset:6144
    ds_read_b64_tr_b16 v[74:75], v12 offset:7168
    buffer_load_dwordx4 v[120:123], v8, s[4:7], s60 offen offset:2048 sc1
    v_mfma_f32_32x32x16_bf16 v[48:63], v[84:87], v[124:127], v[48:63]
    ds_read_b64_tr_b16 v[76:77], v13 offset:6144
    ds_read_b64_tr_b16 v[78:79], v13 offset:7168
    s_waitcnt vmcnt(10)
    s_waitcnt lgkmcnt(4)
    v_mfma_f32_32x32x16_bf16 v[32:47], v[88:91], v[128:131], v[32:47]
    ds_read_b64_tr_b16 v[80:81], v12 offset:8192
    ds_read_b64_tr_b16 v[82:83], v12 offset:9216
    buffer_load_dwordx4 v[124:127], v8, s[4:7], s60 offen offset:3072 sc1
    v_mfma_f32_32x32x16_bf16 v[48:63], v[92:95], v[128:131], v[48:63]
    ds_read_b64_tr_b16 v[84:85], v13 offset:8192
    ds_read_b64_tr_b16 v[86:87], v13 offset:9216
    s_waitcnt vmcnt(10)
    s_waitcnt lgkmcnt(4)
    v_mfma_f32_32x32x16_bf16 v[32:47], v[72:75], v[132:135], v[32:47]
    ds_read_b64_tr_b16 v[88:89], v12 offset:10240
    ds_read_b64_tr_b16 v[90:91], v12 offset:11264
    v_mfma_f32_32x32x16_bf16 v[48:63], v[76:79], v[132:135], v[48:63]
    ds_read_b64_tr_b16 v[92:93], v13 offset:10240
    ds_read_b64_tr_b16 v[94:95], v13 offset:11264
    s_waitcnt vmcnt(9)
    s_waitcnt lgkmcnt(4)
    v_mfma_f32_32x32x16_bf16 v[32:47], v[80:83], v[136:139], v[32:47]
    ds_read_b64_tr_b16 v[72:73], v12 offset:12288
    ds_read_b64_tr_b16 v[74:75], v12 offset:13312
    v_mfma_f32_32x32x16_bf16 v[48:63], v[84:87], v[136:139], v[48:63]
    ds_read_b64_tr_b16 v[76:77], v13 offset:12288
    ds_read_b64_tr_b16 v[78:79], v13 offset:13312
    s_waitcnt vmcnt(8)
    s_waitcnt lgkmcnt(4)
    v_mfma_f32_32x32x16_bf16 v[32:47], v[88:91], v[140:143], v[32:47]
    v_add_u32 v14, 32768, v9
    v_add_u32 v15, 32768, v10
    ds_read_b64_tr_b16 v[80:81], v14 offset:0
    ds_read_b64_tr_b16 v[82:83], v14 offset:1024
    v_mfma_f32_32x32x16_bf16 v[48:63], v[92:95], v[140:143], v[48:63]
    ds_read_b64_tr_b16 v[84:85], v15 offset:0
    ds_read_b64_tr_b16 v[86:87], v15 offset:1024
    s_waitcnt vmcnt(7)
    s_waitcnt lgkmcnt(4)
    v_mfma_f32_32x32x16_bf16 v[32:47], v[72:75], v[96:99], v[32:47]
    ds_read_b64_tr_b16 v[88:89], v14 offset:2048
    ds_read_b64_tr_b16 v[90:91], v14 offset:3072
    v_mfma_f32_32x32x16_bf16 v[48:63], v[76:79], v[96:99], v[48:63]
    ds_read_b64_tr_b16 v[92:93], v15 offset:2048
    ds_read_b64_tr_b16 v[94:95], v15 offset:3072
    s_waitcnt vmcnt(6)
    s_waitcnt lgkmcnt(4)
    v_mfma_f32_32x32x16_bf16 v[32:47], v[80:83], v[100:103], v[32:47]
    ds_read_b64_tr_b16 v[72:73], v14 offset:4096
    ds_read_b64_tr_b16 v[74:75], v14 offset:5120
    v_mfma_f32_32x32x16_bf16 v[48:63], v[84:87], v[100:103], v[48:63]
    ds_read_b64_tr_b16 v[76:77], v15 offset:4096
    ds_read_b64_tr_b16 v[78:79], v15 offset:5120
    s_waitcnt vmcnt(5)
    s_waitcnt lgkmcnt(4)
    v_mfma_f32_32x32x16_bf16 v[32:47], v[88:91], v[104:107], v[32:47]
    ds_read_b64_tr_b16 v[80:81], v14 offset:6144
    ds_read_b64_tr_b16 v[82:83], v14 offset:7168
    v_mfma_f32_32x32x16_bf16 v[48:63], v[92:95], v[104:107], v[48:63]
    ds_read_b64_tr_b16 v[84:85], v15 offset:6144
    ds_read_b64_tr_b16 v[86:87], v15 offset:7168
    s_waitcnt vmcnt(4)
    s_waitcnt lgkmcnt(4)
    v_mfma_f32_32x32x16_bf16 v[32:47], v[72:75], v[108:111], v[32:47]
    ds_read_b64_tr_b16 v[88:89], v14 offset:8192
    ds_read_b64_tr_b16 v[90:91], v14 offset:9216
    v_mfma_f32_32x32x16_bf16 v[48:63], v[76:79], v[108:111], v[48:63]
    ds_read_b64_tr_b16 v[92:93], v15 offset:8192
    ds_read_b64_tr_b16 v[94:95], v15 offset:9216
    s_waitcnt vmcnt(3)
    s_waitcnt lgkmcnt(4)
    v_mfma_f32_32x32x16_bf16 v[32:47], v[80:83], v[112:115], v[32:47]
    ds_read_b64_tr_b16 v[72:73], v14 offset:10240
    ds_read_b64_tr_b16 v[74:75], v14 offset:11264
    v_mfma_f32_32x32x16_bf16 v[48:63], v[84:87], v[112:115], v[48:63]
    ds_read_b64_tr_b16 v[76:77], v15 offset:10240
    ds_read_b64_tr_b16 v[78:79], v15 offset:11264
    s_waitcnt vmcnt(2)
    s_waitcnt lgkmcnt(4)
    v_mfma_f32_32x32x16_bf16 v[32:47], v[88:91], v[116:119], v[32:47]
    ds_read_b64_tr_b16 v[80:81], v14 offset:12288
    ds_read_b64_tr_b16 v[82:83], v14 offset:13312
    v_mfma_f32_32x32x16_bf16 v[48:63], v[92:95], v[116:119], v[48:63]
    ds_read_b64_tr_b16 v[84:85], v15 offset:12288
    ds_read_b64_tr_b16 v[86:87], v15 offset:13312
    s_waitcnt vmcnt(1)
    s_waitcnt lgkmcnt(4)
    v_mfma_f32_32x32x16_bf16 v[32:47], v[72:75], v[120:123], v[32:47]
    v_mfma_f32_32x32x16_bf16 v[48:63], v[76:79], v[120:123], v[48:63]
    s_waitcnt vmcnt(0)
    s_waitcnt lgkmcnt(0)
    v_mfma_f32_32x32x16_bf16 v[32:47], v[80:83], v[124:127], v[32:47]
    v_mfma_f32_32x32x16_bf16 v[48:63], v[84:87], v[124:127], v[48:63]
    s_lshl_b32 s56, s42, 12
    s_add_u32 s57, s56, 65536
    s_xor_b32 s56, s56, 0x2000
    s_add_u32 s58, s56, 65536
    v_add_u32 v4, s57, v8
    v_add_u32 v5, s58, v8
    s_nop 5
    ds_write_b128 v4, v[48:51] offset:0
    ds_write_b128 v4, v[52:55] offset:1024
    ds_write_b128 v4, v[56:59] offset:2048
    ds_write_b128 v4, v[60:63] offset:3072
    s_waitcnt lgkmcnt(0)
    s_barrier
    ds_read_b128 v[48:51], v5 offset:0
    ds_read_b128 v[52:55], v5 offset:1024
    ds_read_b128 v[56:59], v5 offset:2048
    ds_read_b128 v[60:63], v5 offset:3072
    s_waitcnt lgkmcnt(3)
    v_pk_add_f32 v[32:33], v[32:33], v[48:49]
    v_pk_add_f32 v[34:35], v[34:35], v[50:51]
    s_waitcnt lgkmcnt(2)
    v_pk_add_f32 v[36:37], v[36:37], v[52:53]
    v_pk_add_f32 v[38:39], v[38:39], v[54:55]
    s_waitcnt lgkmcnt(1)
    v_pk_add_f32 v[40:41], v[40:41], v[56:57]
    v_pk_add_f32 v[42:43], v[42:43], v[58:59]
    s_waitcnt lgkmcnt(0)
    v_pk_add_f32 v[44:45], v[44:45], v[60:61]
    v_pk_add_f32 v[46:47], v[46:47], v[62:63]
    v_cvt_pk_bf16_f32 v16, v32, v33
    v_cvt_pk_bf16_f32 v17, v34, v35
    v_cvt_pk_bf16_f32 v18, v36, v37
    v_cvt_pk_bf16_f32 v19, v38, v39
    v_cvt_pk_bf16_f32 v20, v40, v41
    v_cvt_pk_bf16_f32 v21, v42, v43
    v_cvt_pk_bf16_f32 v22, v44, v45
    v_cvt_pk_bf16_f32 v23, v46, v47
    s_cmp_eq_u32 s96, 0
    s_cbranch_scc0 L_final_50
    s_add_u32 s54, s53, 0
    s_add_u32 s54, s54, s93
    buffer_store_dwordx4 v[16:19], v8, s[4:7], s54 offen
    buffer_store_dwordx4 v[20:23], v8, s[4:7], s54 offen offset:1024
    v_mov_b32 v26, 0x3f803f80
    v_mov_b32 v24, 0
    v_mov_b32 v25, 0
    v_dot2_f32_bf16 v24, v16, v26, v24
    v_dot2_f32_bf16 v25, v16, v16, v25
    v_dot2_f32_bf16 v24, v17, v26, v24
    v_dot2_f32_bf16 v25, v17, v17, v25
    v_dot2_f32_bf16 v24, v18, v26, v24
    v_dot2_f32_bf16 v25, v18, v18, v25
    v_dot2_f32_bf16 v24, v19, v26, v24
    v_dot2_f32_bf16 v25, v19, v19, v25
    v_dot2_f32_bf16 v24, v20, v26, v24
    v_dot2_f32_bf16 v25, v20, v20, v25
    v_dot2_f32_bf16 v24, v21, v26, v24
    v_dot2_f32_bf16 v25, v21, v21, v25
    v_dot2_f32_bf16 v24, v22, v26, v24
    v_dot2_f32_bf16 v25, v22, v22, v25
    v_dot2_f32_bf16 v24, v23, v26, v24
    v_dot2_f32_bf16 v25, v23, v23, v25
    s_nop 2
    v_permlane32_swap_b32 v24, v25
    v_add_f32 v24, v24, v25
    v_mov_b32 v25, v24
    s_nop 1
    v_permlane32_swap_b32 v24, v25
    s_lshl_b32 s55, s50, 12
    s_lshl_b32 s56, s51, 9
    s_add_u32 s55, s55, s56
    s_lshl_b32 s56, s52, 8
    s_add_u32 s55, s55, s56
    s_add_u32 s55, s55, 14680064
    s_add_u32 s55, s55, s93
    v_mov_b32 v26, v24
    v_mov_b32 v27, v25
    s_nop 0
    v_permlane16_swap_b32 v24, v26
    v_permlane16_swap_b32 v25, v27
    s_mov_b32 exec_lo, 0xffff
    s_mov_b32 exec_hi, 0x0
    buffer_store_dwordx4 v[24:27], v8, s[4:7], s55 offen
    s_mov_b64 exec, -1
    s_waitcnt vmcnt(0)
    s_barrier
    s_cmp_eq_u32 s42, 0
    s_cbranch_scc0 L_nosig_51
    s_lshl_b32 s46, s40, 8
    s_add_u32 s46, s46, 41949184
    s_lshl_b32 s47, s41, 2
    v_mov_b32 v5, s47
    v_mov_b32 v6, s97
    s_mov_b64 exec, 1
    s_cmp_eq_u32 s43, 0
    s_cbranch_scc0 L_slowsig_52
    buffer_store_dword v6, v5, s[4:7], s46 offen
    s_branch L_sigdone_53
L_slowsig_52:
    buffer_wbl2 sc1
    s_waitcnt vmcnt(0)
    buffer_store_dword v6, v5, s[4:7], s46 offen sc1
L_sigdone_53:
    s_mov_b64 exec, -1
L_nosig_51:
    s_mov_b32 s96, 1
    s_mov_b32 s94, s93
    s_mov_b32 s95, 8192
    s_branch L_LOOP
L_final_50:
    v_permlane32_swap_b32 v16, v18
    v_permlane32_swap_b32 v17, v19
    v_permlane32_swap_b32 v20, v22
    v_permlane32_swap_b32 v21, v23
    s_lshl_b32 s55, s50, 15
    s_lshl_b32 s56, s51, 7
    s_add_u32 s55, s55, s56
    s_lshl_b32 s56, s52, 6
    s_add_u32 s55, s55, s56
    v_and_b32 v4, 31, v0
    v_lshlrev_b32 v4, 10, v4
    v_lshrrev_b32 v5, 5, v0
    v_lshl_add_u32 v4, v5, 4, v4
    buffer_store_dwordx4 v[16:19], v4, s[32:35], s55 offen
    buffer_store_dwordx4 v[20:23], v4, s[32:35], s55 offen offset:32
    s_or_b32 s45, s41, s42
    s_cmp_eq_u32 s45, 0
    s_cbranch_scc0 L_noep_54
    s_lshl_b32 s46, s40, 6
    s_add_u32 s46, s46, 41975808
    v_mov_b32 v5, 0
    v_mov_b32 v6, s97
    s_mov_b64 exec, 1
    buffer_store_dword v6, v5, s[4:7], s46 offen sc1
    s_mov_b64 exec, -1
L_noep_54:
    s_waitcnt vmcnt(0)
    s_endpgm
L_HELPER:
    s_sub_u32 s50, s42, 4
    v_lshlrev_b32 v1, 4, v0
    v_mov_b32 v9, 0x3f803f80
    v_lshrrev_b32 v10, 3, v0
    v_bfe_u32 v11, v0, 2, 1
    v_bfe_u32 v12, v0, 4, 1
    v_xor_b32 v11, v11, v12
    v_lshlrev_b32 v2, 10, v10
    v_lshl_add_u32 v2, v11, 6, v2
    v_and_b32 v11, 3, v0
    v_lshl_add_u32 v2, v11, 4, v2
    s_movk_i32 s57, 3584
    v_mul_lo_u32 v3, v10, s57
    v_and_b32 v11, 7, v0
    v_lshl_add_u32 v3, v11, 4, v3
    s_lshr_b32 s58, s50, 1
    s_and_b32 s59, s50, 1
    v_bfe_u32 v11, v0, 1, 2
    s_lshl_b32 s60, s58, 1
    v_xor_b32 v11, s60, v11
    v_xor_b32 v11, v11, v12
    v_lshlrev_b32 v4, 7, v10
    v_lshl_add_u32 v4, v11, 5, v4
    v_and_b32 v11, 1, v0
    v_lshl_add_u32 v4, v11, 4, v4
    s_lshl_b32 s60, s58, 14
    s_lshl_b32 s61, s59, 13
    s_add_u32 s60, s60, s61
    v_add_u32 v4, s60, v4
    v_add_u32 v8, 0x10000, v4
    s_cmp_eq_u32 s58, 0
    s_cselect_b32 s52, s20, s24
    s_cselect_b32 s53, s21, s25
    s_mov_b32 s54, 0x1c0000
    s_mov_b32 s55, 0x20000
    s_mul_i32 s56, s59, 229376
    s_lshr_b32 s60, s41, 1
    s_mul_i32 s60, s60, 224
    s_add_u32 s56, s56, s60
    s_and_b32 s60, s41, 1
    s_mul_i32 s60, s60, 96
    s_add_u32 s56, s56, s60
    s_and_b32 s51, s41, 7
    s_lshl_b32 s51, s51, 7
    s_mul_i32 s64, s41, 14336
    s_and_b32 s65, s50, 1
    s_mul_i32 s65, s65, 7168
    s_add_u32 s64, s64, s65
    s_add_u32 s64, s64, s52
    s_addc_u32 s65, s53, 0
    s_load_dword s66, s[64:65], 5376
    s_load_dword s66, s[64:65], 5504
    s_load_dword s66, s[64:65], 5632
    s_load_dword s66, s[64:65], 5760
    s_load_dword s66, s[64:65], 5888
    s_load_dword s66, s[64:65], 6016
    s_load_dword s66, s[64:65], 6144
    s_load_dword s66, s[64:65], 6272
    s_load_dword s66, s[64:65], 6400
    s_load_dword s66, s[64:65], 6528
    s_load_dword s66, s[64:65], 6656
    s_load_dword s66, s[64:65], 6784
    s_load_dword s66, s[64:65], 6912
    s_load_dword s66, s[64:65], 7040
    s_barrier
    s_movk_i32 s57, 3072
    v_lshrrev_b32 v10, 2, v0
    v_mul_lo_u32 v10, v10, s57
    v_bfe_u32 v11, v0, 1, 1
    v_lshl_add_u32 v10, v11, 10, v10
    v_and_b32 v12, 1, v0
    v_lshl_add_u32 v10, v12, 4, v10
    v_lshrrev_b32 v11, 1, v0
    v_mul_lo_u32 v11, v11, s57
    v_lshl_add_u32 v11, v12, 4, v11
    v_add_u32 v11, 2048, v11
    s_lshl_b32 s58, s41, 5
    s_mul_i32 s61, s50, 49152
    s_add_u32 s61, s61, s58
    s_mul_i32 s62, s50, 98304
    s_add_u32 s62, s62, s58
    s_add_u32 s59, s61, 0
    buffer_load_dwordx4 v[16:19], v10, s[12:15], s59 offen
    s_add_u32 s59, s61, 196608
    buffer_load_dwordx4 v[20:23], v10, s[12:15], s59 offen
    s_add_u32 s59, s62, 0
    buffer_load_dwordx4 v[48:51], v11, s[12:15], s59 offen
    s_lshl_b32 s58, s50, 10
    v_add_u32 v13, s58, v1
    s_waitcnt vmcnt(0)
    ds_write_b128 v13, v[16:19] offset:0
    ds_write_b128 v13, v[20:23] offset:4096
    ds_write_b128 v13, v[48:51] offset:32768
    s_add_u32 s59, s61, 393216
    buffer_load_dwordx4 v[24:27], v10, s[12:15], s59 offen
    s_add_u32 s59, s61, 589824
    buffer_load_dwordx4 v[28:31], v10, s[12:15], s59 offen
    s_add_u32 s59, s62, 393216
    buffer_load_dwordx4 v[52:55], v11, s[12:15], s59 offen
    s_add_u32 s59, s61, 786432
    buffer_load_dwordx4 v[32:35], v10, s[12:15], s59 offen
    s_add_u32 s59, s61, 983040
    buffer_load_dwordx4 v[36:39], v10, s[12:15], s59 offen
    s_add_u32 s59, s61, 1179648
    buffer_load_dwordx4 v[40:43], v10, s[12:15], s59 offen
    s_add_u32 s59, s61, 1376256
    buffer_load_dwordx4 v[44:47], v10, s[12:15], s59 offen
    s_add_u32 s59, s62, 786432
    buffer_load_dwordx4 v[56:59], v11, s[12:15], s59 offen
    s_add_u32 s59, s62, 1179648
    buffer_load_dwordx4 v[60:63], v11, s[12:15], s59 offen
    s_waitcnt lgkmcnt(0)
    s_barrier
    v_mov_b32 v10, 159792
    ds_read_b32 v10, v10
    s_waitcnt lgkmcnt(0)
    v_readfirstlane_b32 s93, v10
    s_load_dword s66, s[64:65], 0
    s_load_dword s66, s[64:65], 128
    s_load_dword s66, s[64:65], 256
    s_load_dword s66, s[64:65], 384
    s_load_dword s66, s[64:65], 512
    s_load_dword s66, s[64:65], 640
    s_load_dword s66, s[64:65], 768
    s_load_dword s66, s[64:65], 896
    s_load_dword s66, s[64:65], 1024
    s_load_dword s66, s[64:65], 1152
    s_load_dword s66, s[64:65], 1280
    s_load_dword s66, s[64:65], 1408
    s_load_dword s66, s[64:65], 1536
    s_load_dword s66, s[64:65], 1664
    s_lshl_b32 s58, s50, 10
    v_add_u32 v13, s58, v1
    s_waitcnt vmcnt(6)
    ds_write_b128 v13, v[24:27] offset:8192
    ds_write_b128 v13, v[28:31] offset:12288
    ds_write_b128 v13, v[52:55] offset:36864
    s_waitcnt lgkmcnt(0)
    s_barrier
    s_load_dword s66, s[64:65], 1792
    s_load_dword s66, s[64:65], 1920
    s_load_dword s66, s[64:65], 2048
    s_load_dword s66, s[64:65], 2176
    s_load_dword s66, s[64:65], 2304
    s_load_dword s66, s[64:65], 2432
    s_load_dword s66, s[64:65], 2560
    s_load_dword s66, s[64:65], 2688
    s_load_dword s66, s[64:65], 2816
    s_load_dword s66, s[64:65], 2944
    s_load_dword s66, s[64:65], 3072
    s_load_dword s66, s[64:65], 3200
    s_load_dword s66, s[64:65], 3328
    s_load_dword s66, s[64:65], 3456
    s_lshl_b32 s58, s50, 10
    v_add_u32 v13, s58, v1
    s_waitcnt vmcnt(0)
    ds_write_b128 v13, v[32:35] offset:16384
    ds_write_b128 v13, v[36:39] offset:20480
    ds_write_b128 v13, v[40:43] offset:24576
    ds_write_b128 v13, v[44:47] offset:28672
    ds_write_b128 v13, v[56:59] offset:40960
    ds_write_b128 v13, v[60:63] offset:45056
    s_waitcnt lgkmcnt(0)
    s_barrier
    s_waitcnt lgkmcnt(0)
    s_cmp_eq_u32 s50, 0
    s_cbranch_scc0 L_csv_55
    v_lshrrev_b32 v6, 5, v0
    v_lshlrev_b32 v6, 2, v6
    v_bfe_u32 v10, v0, 2, 2
    v_add_u32 v10, v10, v6
    v_bfe_u32 v11, v0, 4, 1
    v_and_b32 v5, 3, v0
    v_lshlrev_b32 v5, 3, v5
    v_lshlrev_b32 v6, 6, v10
    v_lshl_add_u32 v6, v11, 5, v6
    v_add_u32 v6, v6, v5
    v_mov_b32 v12, 0
    v_mov_b32 v13, 0
    v_mov_b32 v14, 0
    v_mov_b32 v15, 0
    ds_read_b64_tr_b16 v[192:193], v6 offset:0
    ds_read_b64_tr_b16 v[194:195], v6 offset:512
    ds_read_b64_tr_b16 v[196:197], v6 offset:1024
    ds_read_b64_tr_b16 v[198:199], v6 offset:1536
    ds_read_b64_tr_b16 v[200:201], v6 offset:2048
    ds_read_b64_tr_b16 v[202:203], v6 offset:2560
    ds_read_b64_tr_b16 v[204:205], v6 offset:3072
    ds_read_b64_tr_b16 v[206:207], v6 offset:3584
    ds_read_b64_tr_b16 v[208:209], v6 offset:4096
    ds_read_b64_tr_b16 v[210:211], v6 offset:4608
    ds_read_b64_tr_b16 v[212:213], v6 offset:5120
    ds_read_b64_tr_b16 v[214:215], v6 offset:5632
    ds_read_b64_tr_b16 v[216:217], v6 offset:6144
    ds_read_b64_tr_b16 v[218:219], v6 offset:6656
    ds_read_b64_tr_b16 v[220:221], v6 offset:7168
    ds_read_b64_tr_b16 v[222:223], v6 offset:7680
    s_waitcnt lgkmcnt(14)
    v_dot2_f32_bf16 v12, v192, v9, v12
    v_dot2_f32_bf16 v13, v193, v9, v13
    v_dot2_f32_bf16 v14, v194, v9, v14
    v_dot2_f32_bf16 v15, v195, v9, v15
    s_waitcnt lgkmcnt(12)
    v_dot2_f32_bf16 v12, v196, v9, v12
    v_dot2_f32_bf16 v13, v197, v9, v13
    v_dot2_f32_bf16 v14, v198, v9, v14
    v_dot2_f32_bf16 v15, v199, v9, v15
    s_waitcnt lgkmcnt(10)
    v_dot2_f32_bf16 v12, v200, v9, v12
    v_dot2_f32_bf16 v13, v201, v9, v13
    v_dot2_f32_bf16 v14, v202, v9, v14
    v_dot2_f32_bf16 v15, v203, v9, v15
    s_waitcnt lgkmcnt(8)
    v_dot2_f32_bf16 v12, v204, v9, v12
    v_dot2_f32_bf16 v13, v205, v9, v13
    v_dot2_f32_bf16 v14, v206, v9, v14
    v_dot2_f32_bf16 v15, v207, v9, v15
    s_waitcnt lgkmcnt(6)
    v_dot2_f32_bf16 v12, v208, v9, v12
    v_dot2_f32_bf16 v13, v209, v9, v13
    v_dot2_f32_bf16 v14, v210, v9, v14
    v_dot2_f32_bf16 v15, v211, v9, v15
    s_waitcnt lgkmcnt(4)
    v_dot2_f32_bf16 v12, v212, v9, v12
    v_dot2_f32_bf16 v13, v213, v9, v13
    v_dot2_f32_bf16 v14, v214, v9, v14
    v_dot2_f32_bf16 v15, v215, v9, v15
    s_waitcnt lgkmcnt(2)
    v_dot2_f32_bf16 v12, v216, v9, v12
    v_dot2_f32_bf16 v13, v217, v9, v13
    v_dot2_f32_bf16 v14, v218, v9, v14
    v_dot2_f32_bf16 v15, v219, v9, v15
    s_waitcnt lgkmcnt(0)
    v_dot2_f32_bf16 v12, v220, v9, v12
    v_dot2_f32_bf16 v13, v221, v9, v13
    v_dot2_f32_bf16 v14, v222, v9, v14
    v_dot2_f32_bf16 v15, v223, v9, v15
    ds_read_b64_tr_b16 v[192:193], v6 offset:8192
    ds_read_b64_tr_b16 v[194:195], v6 offset:8704
    ds_read_b64_tr_b16 v[196:197], v6 offset:9216
    ds_read_b64_tr_b16 v[198:199], v6 offset:9728
    ds_read_b64_tr_b16 v[200:201], v6 offset:10240
    ds_read_b64_tr_b16 v[202:203], v6 offset:10752
    ds_read_b64_tr_b16 v[204:205], v6 offset:11264
    ds_read_b64_tr_b16 v[206:207], v6 offset:11776
    ds_read_b64_tr_b16 v[208:209], v6 offset:12288
    ds_read_b64_tr_b16 v[210:211], v6 offset:12800
    ds_read_b64_tr_b16 v[212:213], v6 offset:13312
    ds_read_b64_tr_b16 v[214:215], v6 offset:13824
    ds_read_b64_tr_b16 v[216:217], v6 offset:14336
    ds_read_b64_tr_b16 v[218:219], v6 offset:14848
    ds_read_b64_tr_b16 v[220:221], v6 offset:15360
    ds_read_b64_tr_b16 v[222:223], v6 offset:15872
    s_waitcnt lgkmcnt(14)
    v_dot2_f32_bf16 v12, v192, v9, v12
    v_dot2_f32_bf16 v13, v193, v9, v13
    v_dot2_f32_bf16 v14, v194, v9, v14
    v_dot2_f32_bf16 v15, v195, v9, v15
    s_waitcnt lgkmcnt(12)
    v_dot2_f32_bf16 v12, v196, v9, v12
    v_dot2_f32_bf16 v13, v197, v9, v13
    v_dot2_f32_bf16 v14, v198, v9, v14
    v_dot2_f32_bf16 v15, v199, v9, v15
    s_waitcnt lgkmcnt(10)
    v_dot2_f32_bf16 v12, v200, v9, v12
    v_dot2_f32_bf16 v13, v201, v9, v13
    v_dot2_f32_bf16 v14, v202, v9, v14
    v_dot2_f32_bf16 v15, v203, v9, v15
    s_waitcnt lgkmcnt(8)
    v_dot2_f32_bf16 v12, v204, v9, v12
    v_dot2_f32_bf16 v13, v205, v9, v13
    v_dot2_f32_bf16 v14, v206, v9, v14
    v_dot2_f32_bf16 v15, v207, v9, v15
    s_waitcnt lgkmcnt(6)
    v_dot2_f32_bf16 v12, v208, v9, v12
    v_dot2_f32_bf16 v13, v209, v9, v13
    v_dot2_f32_bf16 v14, v210, v9, v14
    v_dot2_f32_bf16 v15, v211, v9, v15
    s_waitcnt lgkmcnt(4)
    v_dot2_f32_bf16 v12, v212, v9, v12
    v_dot2_f32_bf16 v13, v213, v9, v13
    v_dot2_f32_bf16 v14, v214, v9, v14
    v_dot2_f32_bf16 v15, v215, v9, v15
    s_waitcnt lgkmcnt(2)
    v_dot2_f32_bf16 v12, v216, v9, v12
    v_dot2_f32_bf16 v13, v217, v9, v13
    v_dot2_f32_bf16 v14, v218, v9, v14
    v_dot2_f32_bf16 v15, v219, v9, v15
    s_waitcnt lgkmcnt(0)
    v_dot2_f32_bf16 v12, v220, v9, v12
    v_dot2_f32_bf16 v13, v221, v9, v13
    v_dot2_f32_bf16 v14, v222, v9, v14
    v_dot2_f32_bf16 v15, v223, v9, v15
    ds_read_b64_tr_b16 v[192:193], v6 offset:16384
    ds_read_b64_tr_b16 v[194:195], v6 offset:16896
    ds_read_b64_tr_b16 v[196:197], v6 offset:17408
    ds_read_b64_tr_b16 v[198:199], v6 offset:17920
    ds_read_b64_tr_b16 v[200:201], v6 offset:18432
    ds_read_b64_tr_b16 v[202:203], v6 offset:18944
    ds_read_b64_tr_b16 v[204:205], v6 offset:19456
    ds_read_b64_tr_b16 v[206:207], v6 offset:19968
    ds_read_b64_tr_b16 v[208:209], v6 offset:20480
    ds_read_b64_tr_b16 v[210:211], v6 offset:20992
    ds_read_b64_tr_b16 v[212:213], v6 offset:21504
    ds_read_b64_tr_b16 v[214:215], v6 offset:22016
    ds_read_b64_tr_b16 v[216:217], v6 offset:22528
    ds_read_b64_tr_b16 v[218:219], v6 offset:23040
    ds_read_b64_tr_b16 v[220:221], v6 offset:23552
    ds_read_b64_tr_b16 v[222:223], v6 offset:24064
    s_waitcnt lgkmcnt(14)
    v_dot2_f32_bf16 v12, v192, v9, v12
    v_dot2_f32_bf16 v13, v193, v9, v13
    v_dot2_f32_bf16 v14, v194, v9, v14
    v_dot2_f32_bf16 v15, v195, v9, v15
    s_waitcnt lgkmcnt(12)
    v_dot2_f32_bf16 v12, v196, v9, v12
    v_dot2_f32_bf16 v13, v197, v9, v13
    v_dot2_f32_bf16 v14, v198, v9, v14
    v_dot2_f32_bf16 v15, v199, v9, v15
    s_waitcnt lgkmcnt(10)
    v_dot2_f32_bf16 v12, v200, v9, v12
    v_dot2_f32_bf16 v13, v201, v9, v13
    v_dot2_f32_bf16 v14, v202, v9, v14
    v_dot2_f32_bf16 v15, v203, v9, v15
    s_waitcnt lgkmcnt(8)
    v_dot2_f32_bf16 v12, v204, v9, v12
    v_dot2_f32_bf16 v13, v205, v9, v13
    v_dot2_f32_bf16 v14, v206, v9, v14
    v_dot2_f32_bf16 v15, v207, v9, v15
    s_waitcnt lgkmcnt(6)
    v_dot2_f32_bf16 v12, v208, v9, v12
    v_dot2_f32_bf16 v13, v209, v9, v13
    v_dot2_f32_bf16 v14, v210, v9, v14
    v_dot2_f32_bf16 v15, v211, v9, v15
    s_waitcnt lgkmcnt(4)
    v_dot2_f32_bf16 v12, v212, v9, v12
    v_dot2_f32_bf16 v13, v213, v9, v13
    v_dot2_f32_bf16 v14, v214, v9, v14
    v_dot2_f32_bf16 v15, v215, v9, v15
    s_waitcnt lgkmcnt(2)
    v_dot2_f32_bf16 v12, v216, v9, v12
    v_dot2_f32_bf16 v13, v217, v9, v13
    v_dot2_f32_bf16 v14, v218, v9, v14
    v_dot2_f32_bf16 v15, v219, v9, v15
    s_waitcnt lgkmcnt(0)
    v_dot2_f32_bf16 v12, v220, v9, v12
    v_dot2_f32_bf16 v13, v221, v9, v13
    v_dot2_f32_bf16 v14, v222, v9, v14
    v_dot2_f32_bf16 v15, v223, v9, v15
    ds_read_b64_tr_b16 v[192:193], v6 offset:24576
    ds_read_b64_tr_b16 v[194:195], v6 offset:25088
    ds_read_b64_tr_b16 v[196:197], v6 offset:25600
    ds_read_b64_tr_b16 v[198:199], v6 offset:26112
    ds_read_b64_tr_b16 v[200:201], v6 offset:26624
    ds_read_b64_tr_b16 v[202:203], v6 offset:27136
    ds_read_b64_tr_b16 v[204:205], v6 offset:27648
    ds_read_b64_tr_b16 v[206:207], v6 offset:28160
    ds_read_b64_tr_b16 v[208:209], v6 offset:28672
    ds_read_b64_tr_b16 v[210:211], v6 offset:29184
    ds_read_b64_tr_b16 v[212:213], v6 offset:29696
    ds_read_b64_tr_b16 v[214:215], v6 offset:30208
    ds_read_b64_tr_b16 v[216:217], v6 offset:30720
    ds_read_b64_tr_b16 v[218:219], v6 offset:31232
    ds_read_b64_tr_b16 v[220:221], v6 offset:31744
    ds_read_b64_tr_b16 v[222:223], v6 offset:32256
    s_waitcnt lgkmcnt(14)
    v_dot2_f32_bf16 v12, v192, v9, v12
    v_dot2_f32_bf16 v13, v193, v9, v13
    v_dot2_f32_bf16 v14, v194, v9, v14
    v_dot2_f32_bf16 v15, v195, v9, v15
    s_waitcnt lgkmcnt(12)
    v_dot2_f32_bf16 v12, v196, v9, v12
    v_dot2_f32_bf16 v13, v197, v9, v13
    v_dot2_f32_bf16 v14, v198, v9, v14
    v_dot2_f32_bf16 v15, v199, v9, v15
    s_waitcnt lgkmcnt(10)
    v_dot2_f32_bf16 v12, v200, v9, v12
    v_dot2_f32_bf16 v13, v201, v9, v13
    v_dot2_f32_bf16 v14, v202, v9, v14
    v_dot2_f32_bf16 v15, v203, v9, v15
    s_waitcnt lgkmcnt(8)
    v_dot2_f32_bf16 v12, v204, v9, v12
    v_dot2_f32_bf16 v13, v205, v9, v13
    v_dot2_f32_bf16 v14, v206, v9, v14
    v_dot2_f32_bf16 v15, v207, v9, v15
    s_waitcnt lgkmcnt(6)
    v_dot2_f32_bf16 v12, v208, v9, v12
    v_dot2_f32_bf16 v13, v209, v9, v13
    v_dot2_f32_bf16 v14, v210, v9, v14
    v_dot2_f32_bf16 v15, v211, v9, v15
    s_waitcnt lgkmcnt(4)
    v_dot2_f32_bf16 v12, v212, v9, v12
    v_dot2_f32_bf16 v13, v213, v9, v13
    v_dot2_f32_bf16 v14, v214, v9, v14
    v_dot2_f32_bf16 v15, v215, v9, v15
    s_waitcnt lgkmcnt(2)
    v_dot2_f32_bf16 v12, v216, v9, v12
    v_dot2_f32_bf16 v13, v217, v9, v13
    v_dot2_f32_bf16 v14, v218, v9, v14
    v_dot2_f32_bf16 v15, v219, v9, v15
    s_waitcnt lgkmcnt(0)
    v_dot2_f32_bf16 v12, v220, v9, v12
    v_dot2_f32_bf16 v13, v221, v9, v13
    v_dot2_f32_bf16 v14, v222, v9, v14
    v_dot2_f32_bf16 v15, v223, v9, v15
    s_nop 0
    v_add_f32 v12, v12, v13
    s_nop 0
    v_add_f32 v14, v14, v15
    v_add_f32 v12, v12, v14
    v_mov_b32 v13, v12
    s_nop 1
    v_permlane32_swap_b32 v12, v13
    v_add_f32 v12, v12, v13
    v_cvt_pk_bf16_f32 v14, v12, v12
    v_lshlrev_b32 v13, 16, v14
    v_sub_f32 v13, v12, v13
    v_cvt_pk_bf16_f32 v15, v13, v13
    s_mov_b32 s58, 161792
    v_and_b32 v10, 31, v0
    v_lshl_add_u32 v10, v10, 3, s58
    s_mov_b32 exec_lo, 0xffffffff
    s_mov_b32 exec_hi, 0x0
    ds_write_b64 v10, v[14:15]
    s_mov_b64 exec, -1
    s_waitcnt lgkmcnt(0)
    s_branch L_csd_56
L_csv_55:
    s_cmp_eq_u32 s50, 1
    s_cbranch_scc0 L_csd_56
    v_lshrrev_b32 v6, 5, v0
    v_lshlrev_b32 v6, 2, v6
    v_bfe_u32 v10, v0, 2, 2
    v_add_u32 v10, v10, v6
    v_bfe_u32 v11, v0, 4, 1
    v_and_b32 v5, 3, v0
    v_lshlrev_b32 v5, 3, v5
    v_lshl_add_u32 v6, v10, 5, v5
    v_add_u32 v6, 32768, v6
    v_mov_b32 v12, 0
    v_mov_b32 v13, 0
    v_mov_b32 v14, 0
    v_mov_b32 v15, 0
    ds_read_b64_tr_b16 v[192:193], v6 offset:0
    ds_read_b64_tr_b16 v[194:195], v6 offset:256
    ds_read_b64_tr_b16 v[196:197], v6 offset:512
    ds_read_b64_tr_b16 v[198:199], v6 offset:768
    ds_read_b64_tr_b16 v[200:201], v6 offset:1024
    ds_read_b64_tr_b16 v[202:203], v6 offset:1280
    ds_read_b64_tr_b16 v[204:205], v6 offset:1536
    ds_read_b64_tr_b16 v[206:207], v6 offset:1792
    ds_read_b64_tr_b16 v[208:209], v6 offset:2048
    ds_read_b64_tr_b16 v[210:211], v6 offset:2304
    ds_read_b64_tr_b16 v[212:213], v6 offset:2560
    ds_read_b64_tr_b16 v[214:215], v6 offset:2816
    ds_read_b64_tr_b16 v[216:217], v6 offset:3072
    ds_read_b64_tr_b16 v[218:219], v6 offset:3328
    ds_read_b64_tr_b16 v[220:221], v6 offset:3584
    ds_read_b64_tr_b16 v[222:223], v6 offset:3840
    s_waitcnt lgkmcnt(14)
    v_dot2_f32_bf16 v12, v192, v9, v12
    v_dot2_f32_bf16 v13, v193, v9, v13
    v_dot2_f32_bf16 v14, v194, v9, v14
    v_dot2_f32_bf16 v15, v195, v9, v15
    s_waitcnt lgkmcnt(12)
    v_dot2_f32_bf16 v12, v196, v9, v12
    v_dot2_f32_bf16 v13, v197, v9, v13
    v_dot2_f32_bf16 v14, v198, v9, v14
    v_dot2_f32_bf16 v15, v199, v9, v15
    s_waitcnt lgkmcnt(10)
    v_dot2_f32_bf16 v12, v200, v9, v12
    v_dot2_f32_bf16 v13, v201, v9, v13
    v_dot2_f32_bf16 v14, v202, v9, v14
    v_dot2_f32_bf16 v15, v203, v9, v15
    s_waitcnt lgkmcnt(8)
    v_dot2_f32_bf16 v12, v204, v9, v12
    v_dot2_f32_bf16 v13, v205, v9, v13
    v_dot2_f32_bf16 v14, v206, v9, v14
    v_dot2_f32_bf16 v15, v207, v9, v15
    s_waitcnt lgkmcnt(6)
    v_dot2_f32_bf16 v12, v208, v9, v12
    v_dot2_f32_bf16 v13, v209, v9, v13
    v_dot2_f32_bf16 v14, v210, v9, v14
    v_dot2_f32_bf16 v15, v211, v9, v15
    s_waitcnt lgkmcnt(4)
    v_dot2_f32_bf16 v12, v212, v9, v12
    v_dot2_f32_bf16 v13, v213, v9, v13
    v_dot2_f32_bf16 v14, v214, v9, v14
    v_dot2_f32_bf16 v15, v215, v9, v15
    s_waitcnt lgkmcnt(2)
    v_dot2_f32_bf16 v12, v216, v9, v12
    v_dot2_f32_bf16 v13, v217, v9, v13
    v_dot2_f32_bf16 v14, v218, v9, v14
    v_dot2_f32_bf16 v15, v219, v9, v15
    s_waitcnt lgkmcnt(0)
    v_dot2_f32_bf16 v12, v220, v9, v12
    v_dot2_f32_bf16 v13, v221, v9, v13
    v_dot2_f32_bf16 v14, v222, v9, v14
    v_dot2_f32_bf16 v15, v223, v9, v15
    ds_read_b64_tr_b16 v[192:193], v6 offset:4096
    ds_read_b64_tr_b16 v[194:195], v6 offset:4352
    ds_read_b64_tr_b16 v[196:197], v6 offset:4608
    ds_read_b64_tr_b16 v[198:199], v6 offset:4864
    ds_read_b64_tr_b16 v[200:201], v6 offset:5120
    ds_read_b64_tr_b16 v[202:203], v6 offset:5376
    ds_read_b64_tr_b16 v[204:205], v6 offset:5632
    ds_read_b64_tr_b16 v[206:207], v6 offset:5888
    ds_read_b64_tr_b16 v[208:209], v6 offset:6144
    ds_read_b64_tr_b16 v[210:211], v6 offset:6400
    ds_read_b64_tr_b16 v[212:213], v6 offset:6656
    ds_read_b64_tr_b16 v[214:215], v6 offset:6912
    ds_read_b64_tr_b16 v[216:217], v6 offset:7168
    ds_read_b64_tr_b16 v[218:219], v6 offset:7424
    ds_read_b64_tr_b16 v[220:221], v6 offset:7680
    ds_read_b64_tr_b16 v[222:223], v6 offset:7936
    s_waitcnt lgkmcnt(14)
    v_dot2_f32_bf16 v12, v192, v9, v12
    v_dot2_f32_bf16 v13, v193, v9, v13
    v_dot2_f32_bf16 v14, v194, v9, v14
    v_dot2_f32_bf16 v15, v195, v9, v15
    s_waitcnt lgkmcnt(12)
    v_dot2_f32_bf16 v12, v196, v9, v12
    v_dot2_f32_bf16 v13, v197, v9, v13
    v_dot2_f32_bf16 v14, v198, v9, v14
    v_dot2_f32_bf16 v15, v199, v9, v15
    s_waitcnt lgkmcnt(10)
    v_dot2_f32_bf16 v12, v200, v9, v12
    v_dot2_f32_bf16 v13, v201, v9, v13
    v_dot2_f32_bf16 v14, v202, v9, v14
    v_dot2_f32_bf16 v15, v203, v9, v15
    s_waitcnt lgkmcnt(8)
    v_dot2_f32_bf16 v12, v204, v9, v12
    v_dot2_f32_bf16 v13, v205, v9, v13
    v_dot2_f32_bf16 v14, v206, v9, v14
    v_dot2_f32_bf16 v15, v207, v9, v15
    s_waitcnt lgkmcnt(6)
    v_dot2_f32_bf16 v12, v208, v9, v12
    v_dot2_f32_bf16 v13, v209, v9, v13
    v_dot2_f32_bf16 v14, v210, v9, v14
    v_dot2_f32_bf16 v15, v211, v9, v15
    s_waitcnt lgkmcnt(4)
    v_dot2_f32_bf16 v12, v212, v9, v12
    v_dot2_f32_bf16 v13, v213, v9, v13
    v_dot2_f32_bf16 v14, v214, v9, v14
    v_dot2_f32_bf16 v15, v215, v9, v15
    s_waitcnt lgkmcnt(2)
    v_dot2_f32_bf16 v12, v216, v9, v12
    v_dot2_f32_bf16 v13, v217, v9, v13
    v_dot2_f32_bf16 v14, v218, v9, v14
    v_dot2_f32_bf16 v15, v219, v9, v15
    s_waitcnt lgkmcnt(0)
    v_dot2_f32_bf16 v12, v220, v9, v12
    v_dot2_f32_bf16 v13, v221, v9, v13
    v_dot2_f32_bf16 v14, v222, v9, v14
    v_dot2_f32_bf16 v15, v223, v9, v15
    ds_read_b64_tr_b16 v[192:193], v6 offset:8192
    ds_read_b64_tr_b16 v[194:195], v6 offset:8448
    ds_read_b64_tr_b16 v[196:197], v6 offset:8704
    ds_read_b64_tr_b16 v[198:199], v6 offset:8960
    ds_read_b64_tr_b16 v[200:201], v6 offset:9216
    ds_read_b64_tr_b16 v[202:203], v6 offset:9472
    ds_read_b64_tr_b16 v[204:205], v6 offset:9728
    ds_read_b64_tr_b16 v[206:207], v6 offset:9984
    ds_read_b64_tr_b16 v[208:209], v6 offset:10240
    ds_read_b64_tr_b16 v[210:211], v6 offset:10496
    ds_read_b64_tr_b16 v[212:213], v6 offset:10752
    ds_read_b64_tr_b16 v[214:215], v6 offset:11008
    ds_read_b64_tr_b16 v[216:217], v6 offset:11264
    ds_read_b64_tr_b16 v[218:219], v6 offset:11520
    ds_read_b64_tr_b16 v[220:221], v6 offset:11776
    ds_read_b64_tr_b16 v[222:223], v6 offset:12032
    s_waitcnt lgkmcnt(14)
    v_dot2_f32_bf16 v12, v192, v9, v12
    v_dot2_f32_bf16 v13, v193, v9, v13
    v_dot2_f32_bf16 v14, v194, v9, v14
    v_dot2_f32_bf16 v15, v195, v9, v15
    s_waitcnt lgkmcnt(12)
    v_dot2_f32_bf16 v12, v196, v9, v12
    v_dot2_f32_bf16 v13, v197, v9, v13
    v_dot2_f32_bf16 v14, v198, v9, v14
    v_dot2_f32_bf16 v15, v199, v9, v15
    s_waitcnt lgkmcnt(10)
    v_dot2_f32_bf16 v12, v200, v9, v12
    v_dot2_f32_bf16 v13, v201, v9, v13
    v_dot2_f32_bf16 v14, v202, v9, v14
    v_dot2_f32_bf16 v15, v203, v9, v15
    s_waitcnt lgkmcnt(8)
    v_dot2_f32_bf16 v12, v204, v9, v12
    v_dot2_f32_bf16 v13, v205, v9, v13
    v_dot2_f32_bf16 v14, v206, v9, v14
    v_dot2_f32_bf16 v15, v207, v9, v15
    s_waitcnt lgkmcnt(6)
    v_dot2_f32_bf16 v12, v208, v9, v12
    v_dot2_f32_bf16 v13, v209, v9, v13
    v_dot2_f32_bf16 v14, v210, v9, v14
    v_dot2_f32_bf16 v15, v211, v9, v15
    s_waitcnt lgkmcnt(4)
    v_dot2_f32_bf16 v12, v212, v9, v12
    v_dot2_f32_bf16 v13, v213, v9, v13
    v_dot2_f32_bf16 v14, v214, v9, v14
    v_dot2_f32_bf16 v15, v215, v9, v15
    s_waitcnt lgkmcnt(2)
    v_dot2_f32_bf16 v12, v216, v9, v12
    v_dot2_f32_bf16 v13, v217, v9, v13
    v_dot2_f32_bf16 v14, v218, v9, v14
    v_dot2_f32_bf16 v15, v219, v9, v15
    s_waitcnt lgkmcnt(0)
    v_dot2_f32_bf16 v12, v220, v9, v12
    v_dot2_f32_bf16 v13, v221, v9, v13
    v_dot2_f32_bf16 v14, v222, v9, v14
    v_dot2_f32_bf16 v15, v223, v9, v15
    ds_read_b64_tr_b16 v[192:193], v6 offset:12288
    ds_read_b64_tr_b16 v[194:195], v6 offset:12544
    ds_read_b64_tr_b16 v[196:197], v6 offset:12800
    ds_read_b64_tr_b16 v[198:199], v6 offset:13056
    ds_read_b64_tr_b16 v[200:201], v6 offset:13312
    ds_read_b64_tr_b16 v[202:203], v6 offset:13568
    ds_read_b64_tr_b16 v[204:205], v6 offset:13824
    ds_read_b64_tr_b16 v[206:207], v6 offset:14080
    ds_read_b64_tr_b16 v[208:209], v6 offset:14336
    ds_read_b64_tr_b16 v[210:211], v6 offset:14592
    ds_read_b64_tr_b16 v[212:213], v6 offset:14848
    ds_read_b64_tr_b16 v[214:215], v6 offset:15104
    ds_read_b64_tr_b16 v[216:217], v6 offset:15360
    ds_read_b64_tr_b16 v[218:219], v6 offset:15616
    ds_read_b64_tr_b16 v[220:221], v6 offset:15872
    ds_read_b64_tr_b16 v[222:223], v6 offset:16128
    s_waitcnt lgkmcnt(14)
    v_dot2_f32_bf16 v12, v192, v9, v12
    v_dot2_f32_bf16 v13, v193, v9, v13
    v_dot2_f32_bf16 v14, v194, v9, v14
    v_dot2_f32_bf16 v15, v195, v9, v15
    s_waitcnt lgkmcnt(12)
    v_dot2_f32_bf16 v12, v196, v9, v12
    v_dot2_f32_bf16 v13, v197, v9, v13
    v_dot2_f32_bf16 v14, v198, v9, v14
    v_dot2_f32_bf16 v15, v199, v9, v15
    s_waitcnt lgkmcnt(10)
    v_dot2_f32_bf16 v12, v200, v9, v12
    v_dot2_f32_bf16 v13, v201, v9, v13
    v_dot2_f32_bf16 v14, v202, v9, v14
    v_dot2_f32_bf16 v15, v203, v9, v15
    s_waitcnt lgkmcnt(8)
    v_dot2_f32_bf16 v12, v204, v9, v12
    v_dot2_f32_bf16 v13, v205, v9, v13
    v_dot2_f32_bf16 v14, v206, v9, v14
    v_dot2_f32_bf16 v15, v207, v9, v15
    s_waitcnt lgkmcnt(6)
    v_dot2_f32_bf16 v12, v208, v9, v12
    v_dot2_f32_bf16 v13, v209, v9, v13
    v_dot2_f32_bf16 v14, v210, v9, v14
    v_dot2_f32_bf16 v15, v211, v9, v15
    s_waitcnt lgkmcnt(4)
    v_dot2_f32_bf16 v12, v212, v9, v12
    v_dot2_f32_bf16 v13, v213, v9, v13
    v_dot2_f32_bf16 v14, v214, v9, v14
    v_dot2_f32_bf16 v15, v215, v9, v15
    s_waitcnt lgkmcnt(2)
    v_dot2_f32_bf16 v12, v216, v9, v12
    v_dot2_f32_bf16 v13, v217, v9, v13
    v_dot2_f32_bf16 v14, v218, v9, v14
    v_dot2_f32_bf16 v15, v219, v9, v15
    s_waitcnt lgkmcnt(0)
    v_dot2_f32_bf16 v12, v220, v9, v12
    v_dot2_f32_bf16 v13, v221, v9, v13
    v_dot2_f32_bf16 v14, v222, v9, v14
    v_dot2_f32_bf16 v15, v223, v9, v15
    s_nop 0
    v_add_f32 v12, v12, v13
    s_nop 0
    v_add_f32 v14, v14, v15
    v_add_f32 v12, v12, v14
    v_mov_b32 v13, v12
    s_nop 1
    v_permlane32_swap_b32 v12, v13
    v_add_f32 v12, v12, v13
    v_cvt_pk_bf16_f32 v14, v12, v12
    v_lshlrev_b32 v13, 16, v14
    v_sub_f32 v13, v12, v13
    v_cvt_pk_bf16_f32 v15, v13, v13
    s_mov_b32 s58, 162048
    v_and_b32 v10, 31, v0
    v_lshl_add_u32 v10, v10, 3, s58
    s_mov_b32 exec_lo, 0xffffffff
    s_mov_b32 exec_hi, 0x0
    ds_write_b64 v10, v[14:15]
    s_mov_b64 exec, -1
    s_waitcnt lgkmcnt(0)
L_csd_56:
    s_load_dword s66, s[64:65], 3584
    s_load_dword s66, s[64:65], 3712
    s_load_dword s66, s[64:65], 3840
    s_load_dword s66, s[64:65], 3968
    s_load_dword s66, s[64:65], 4096
    s_load_dword s66, s[64:65], 4224
    s_load_dword s66, s[64:65], 4352
    s_load_dword s66, s[64:65], 4480
    s_load_dword s66, s[64:65], 4608
    s_load_dword s66, s[64:65], 4736
    s_load_dword s66, s[64:65], 4864
    s_load_dword s66, s[64:65], 4992
    s_load_dword s66, s[64:65], 5120
    s_load_dword s66, s[64:65], 5248
    v_lshrrev_b32 v7, 3, v0
    s_mov_b32 s58, 32768
    v_mul_lo_u32 v7, v7, s58
    v_and_b32 v6, 7, v0
    v_lshl_add_u32 v7, v6, 7, v7
    s_lshl_b32 s58, s40, 3
    s_lshl_b32 s59, s50, 1
    s_add_u32 s58, s58, s59
    s_mul_i32 s58, s58, 32768
    s_lshl_b32 s59, s41, 10
    s_add_u32 s58, s58, s59
    s_add_u32 s58, s58, 4718592
    s_mov_b32 exec_lo, 0xffff
    s_mov_b32 exec_hi, 0x0
    buffer_load_dword v255, v7, s[4:7], s58 offen sc1
    s_mov_b64 exec, -1
    s_barrier
    s_barrier
    s_waitcnt lgkmcnt(0)
    s_waitcnt vmcnt(0)
    s_cmp_eq_u32 s40, 7
    s_cbranch_scc1 L_nokv_57
    s_lshl_b32 s58, s50, 12
    s_add_u32 s59, s58, 131072
    v_add_u32 v10, s59, v1
    ds_read_b128 v[192:195], v10 offset:0
    ds_read_b128 v[196:199], v10 offset:1024
    ds_read_b128 v[200:203], v10 offset:2048
    ds_read_b128 v[204:207], v10 offset:3072
    s_lshl_b32 s59, s40, 5
    s_add_u32 s59, s59, s41
    s_lshl_b32 s60, s59, 14
    s_add_u32 s60, s60, s58
    s_add_u32 s60, s60, 33554432
    s_waitcnt lgkmcnt(3)
    buffer_store_dwordx4 v[192:195], v1, s[4:7], s60 offen offset:0 sc1
    s_waitcnt lgkmcnt(2)
    buffer_store_dwordx4 v[196:199], v1, s[4:7], s60 offen offset:1024 sc1
    s_waitcnt lgkmcnt(1)
    buffer_store_dwordx4 v[200:203], v1, s[4:7], s60 offen offset:2048 sc1
    s_waitcnt lgkmcnt(0)
    buffer_store_dwordx4 v[204:207], v1, s[4:7], s60 offen offset:3072 sc1
    s_lshl_b32 s59, s59, 7
    s_lshl_b32 s60, s50, 2
    s_add_u32 s59, s59, s60
    s_add_u32 s59, s59, 42336256
    v_mov_b32 v10, 0
    v_mov_b32 v11, s98
    s_waitcnt vmcnt(0)
    s_mov_b64 exec, 1
    buffer_store_dword v11, v10, s[4:7], s59 offen sc1
    s_mov_b64 exec, -1
L_nokv_57:
    s_cmp_eq_u32 s40, 0
    s_cbranch_scc1 L_nohalo_58
    s_sub_u32 s59, s40, 1
    s_lshl_b32 s59, s59, 5
    s_add_u32 s59, s59, s41
    s_lshl_b32 s46, s59, 7
    s_lshl_b32 s60, s50, 2
    s_add_u32 s46, s46, s60
    s_add_u32 s46, s46, 42336256
    v_lshlrev_b32 v5, 2, v0
    s_mov_b32 exec_lo, 0x1
    s_mov_b32 exec_hi, 0x0
    s_mov_b32 s45, 0
L_poll_60:
    buffer_load_dword v6, v5, s[4:7], s46 offen sc1
    s_waitcnt vmcnt(0)
    v_subrev_u32 v6, s97, v6
    v_cmp_gt_u32 vcc, 2, v6
    s_cmp_eq_u64 vcc, exec
    s_cbranch_scc1 L_polldone_61
    s_add_u32 s45, s45, 1
    s_cmp_lt_u32 s45, 200000
    s_cbranch_scc1 L_poll_60
    v_mov_b32 v6, 110
    v_mov_b32 v7, 20
    buffer_store_dword v6, v7, s[36:39], 0 offen
    s_waitcnt vmcnt(0)
L_polldone_61:
    s_mov_b64 exec, -1
    s_lshl_b32 s60, s59, 14
    s_lshl_b32 s58, s50, 12
    s_add_u32 s60, s60, s58
    s_add_u32 s60, s60, 33554432
    s_add_u32 s58, s58, 49152
    s_mov_b32 m0, s58
    s_nop 0
    buffer_load_dwordx4 v1, s[4:7], s60 offen offset:0 sc1 lds
    buffer_load_dwordx4 v1, s[4:7], s60 offen offset:1024 sc1 lds
    buffer_load_dwordx4 v1, s[4:7], s60 offen offset:2048 sc1 lds
    buffer_load_dwordx4 v1, s[4:7], s60 offen offset:3072 sc1 lds
    s_branch L_halod_59
L_nohalo_58:
    s_waitcnt vmcnt(0)
L_halod_59:
    s_add_u32 s59, s56, 0
    buffer_load_dwordx4 v[64:67], v3, s[52:55], s59 offen
    s_add_u32 s59, s59, 28672
    buffer_load_dwordx4 v[68:71], v3, s[52:55], s59 offen
    s_add_u32 s59, s59, 28672
    buffer_load_dwordx4 v[72:75], v3, s[52:55], s59 offen
    s_add_u32 s59, s59, 28672
    buffer_load_dwordx4 v[76:79], v3, s[52:55], s59 offen
    s_add_u32 s59, s59, 28672
    buffer_load_dwordx4 v[80:83], v3, s[52:55], s59 offen
    s_add_u32 s59, s59, 28672
    buffer_load_dwordx4 v[84:87], v3, s[52:55], s59 offen
    s_add_u32 s59, s59, 28672
    buffer_load_dwordx4 v[88:91], v3, s[52:55], s59 offen
    s_add_u32 s59, s59, 28672
    buffer_load_dwordx4 v[92:95], v3, s[52:55], s59 offen
    s_waitcnt vmcnt(8)
    s_barrier
    s_lshl_b32 s58, s50, 14
    s_add_u32 s58, s58, 65536
    s_lshl_b32 s59, s50, 17
    s_add_u32 s59, s59, s51
    s_mov_b32 m0, s58
    s_nop 0
    buffer_load_dwordx4 v2, s[16:19], s59 offen lds
    s_add_u32 s58, s58, 1024
    s_add_u32 s59, s59, 8192
    s_mov_b32 m0, s58
    s_nop 0
    buffer_load_dwordx4 v2, s[16:19], s59 offen lds
    s_add_u32 s58, s58, 1024
    s_add_u32 s59, s59, 8192
    s_mov_b32 m0, s58
    s_nop 0
    buffer_load_dwordx4 v2, s[16:19], s59 offen lds
    s_add_u32 s58, s58, 1024
    s_add_u32 s59, s59, 8192
    s_mov_b32 m0, s58
    s_nop 0
    buffer_load_dwordx4 v2, s[16:19], s59 offen lds
    s_add_u32 s58, s58, 1024
    s_add_u32 s59, s59, 8192
    s_mov_b32 m0, s58
    s_nop 0
    buffer_load_dwordx4 v2, s[16:19], s59 offen lds
    s_add_u32 s58, s58, 1024
    s_add_u32 s59, s59, 8192
    s_mov_b32 m0, s58
    s_nop 0
    buffer_load_dwordx4 v2, s[16:19], s59 offen lds
    s_add_u32 s58, s58, 1024
    s_add_u32 s59, s59, 8192
    s_mov_b32 m0, s58
    s_nop 0
    buffer_load_dwordx4 v2, s[16:19], s59 offen lds
    s_add_u32 s58, s58, 1024
    s_add_u32 s59, s59, 8192
    s_mov_b32 m0, s58
    s_nop 0
    buffer_load_dwordx4 v2, s[16:19], s59 offen lds
    s_add_u32 s58, s58, 1024
    s_add_u32 s59, s59, 8192
    s_mov_b32 m0, s58
    s_nop 0
    buffer_load_dwordx4 v2, s[16:19], s59 offen lds
    s_add_u32 s58, s58, 1024
    s_add_u32 s59, s59, 8192
    s_mov_b32 m0, s58
    s_nop 0
    buffer_load_dwordx4 v2, s[16:19], s59 offen lds
    s_add_u32 s58, s58, 1024
    s_add_u32 s59, s59, 8192
    s_mov_b32 m0, s58
    s_nop 0
    buffer_load_dwordx4 v2, s[16:19], s59 offen lds
    s_add_u32 s58, s58, 1024
    s_add_u32 s59, s59, 8192
    s_mov_b32 m0, s58
    s_nop 0
    buffer_load_dwordx4 v2, s[16:19], s59 offen lds
    s_add_u32 s58, s58, 1024
    s_add_u32 s59, s59, 8192
    s_mov_b32 m0, s58
    s_nop 0
    buffer_load_dwordx4 v2, s[16:19], s59 offen lds
    s_add_u32 s58, s58, 1024
    s_add_u32 s59, s59, 8192
    s_mov_b32 m0, s58
    s_nop 0
    buffer_load_dwordx4 v2, s[16:19], s59 offen lds
    s_add_u32 s58, s58, 1024
    s_add_u32 s59, s59, 8192
    s_mov_b32 m0, s58
    s_nop 0
    buffer_load_dwordx4 v2, s[16:19], s59 offen lds
    s_add_u32 s58, s58, 1024
    s_add_u32 s59, s59, 8192
    s_mov_b32 m0, s58
    s_nop 0
    buffer_load_dwordx4 v2, s[16:19], s59 offen lds
    v_lshlrev_b32 v7, 7, v0
    s_lshr_b32 s58, s41, 3
    s_lshl_b32 s58, s58, 1
    s_lshr_b32 s59, s50, 1
    s_add_u32 s58, s58, s59
    s_lshl_b32 s59, s40, 3
    s_add_u32 s58, s58, s59
    s_and_b32 s59, s41, 7
    s_lshl_b32 s59, s59, 1
    s_and_b32 s60, s50, 1
    s_add_u32 s59, s59, s60
    s_mul_i32 s60, s58, 32768
    s_lshl_b32 s61, s59, 11
    s_add_u32 s60, s60, s61
    s_add_u32 s60, s60, 2359296
    s_mov_b32 exec_lo, 0xffff
    s_mov_b32 exec_hi, 0x0
    buffer_load_dword v255, v7, s[4:7], s60 offen sc1
    s_mov_b64 exec, -1
    s_lshl_b32 s60, s58, 12
    s_lshl_b32 s61, s59, 8
    s_add_u32 s60, s60, s61
    s_add_u32 s60, s60, 14942208
    s_mov_b32 exec_lo, 0x3
    s_mov_b32 exec_hi, 0x0
    buffer_load_dword v255, v7, s[4:7], s60 offen sc1
    s_mov_b64 exec, -1
    v_lshlrev_b32 v7, 7, v0
    s_lshr_b32 s58, s41, 3
    s_lshl_b32 s58, s58, 1
    s_lshr_b32 s59, s50, 1
    s_add_u32 s58, s58, s59
    s_lshl_b32 s59, s40, 3
    s_add_u32 s58, s58, s59
    s_and_b32 s59, s41, 7
    s_lshl_b32 s59, s59, 1
    s_and_b32 s60, s50, 1
    s_add_u32 s59, s59, s60
    s_mul_i32 s60, s58, 32768
    s_lshl_b32 s61, s59, 11
    s_add_u32 s60, s60, s61
    s_add_u32 s60, s60, 0
    s_add_u32 s60, s60, s93
    s_mov_b32 exec_lo, 0xffff
    s_mov_b32 exec_hi, 0x0
    buffer_load_dword v255, v7, s[4:7], s60 offen sc1
    s_mov_b64 exec, -1
    s_lshl_b32 s60, s58, 12
    s_lshl_b32 s61, s59, 8
    s_add_u32 s60, s60, s61
    s_add_u32 s60, s60, 14680064
    s_add_u32 s60, s60, s93
    s_mov_b32 exec_lo, 0x3
    s_mov_b32 exec_hi, 0x0
    buffer_load_dword v255, v7, s[4:7], s60 offen sc1
    s_mov_b64 exec, -1
    s_add_u32 s59, s56, 458752
    buffer_load_dwordx4 v[96:99], v3, s[52:55], s59 offen
    s_add_u32 s59, s59, 28672
    buffer_load_dwordx4 v[100:103], v3, s[52:55], s59 offen
    s_add_u32 s59, s59, 28672
    buffer_load_dwordx4 v[104:107], v3, s[52:55], s59 offen
    s_add_u32 s59, s59, 28672
    buffer_load_dwordx4 v[108:111], v3, s[52:55], s59 offen
    s_add_u32 s59, s59, 28672
    buffer_load_dwordx4 v[112:115], v3, s[52:55], s59 offen
    s_add_u32 s59, s59, 28672
    buffer_load_dwordx4 v[116:119], v3, s[52:55], s59 offen
    s_add_u32 s59, s59, 28672
    buffer_load_dwordx4 v[120:123], v3, s[52:55], s59 offen
    s_add_u32 s59, s59, 28672
    buffer_load_dwordx4 v[124:127], v3, s[52:55], s59 offen
    s_waitcnt vmcnt(12)
    s_barrier
    ds_write_b128 v4, v[64:67] offset:0
    ds_write_b128 v4, v[68:71] offset:1024
    ds_write_b128 v4, v[72:75] offset:2048
    ds_write_b128 v4, v[76:79] offset:3072
    ds_write_b128 v4, v[80:83] offset:4096
    ds_write_b128 v4, v[84:87] offset:5120
    ds_write_b128 v4, v[88:91] offset:6144
    ds_write_b128 v4, v[92:95] offset:7168
    s_add_u32 s59, s56, 917504
    buffer_load_dwordx4 v[128:131], v3, s[52:55], s59 offen
    s_add_u32 s59, s59, 28672
    buffer_load_dwordx4 v[132:135], v3, s[52:55], s59 offen
    s_add_u32 s59, s59, 28672
    buffer_load_dwordx4 v[136:139], v3, s[52:55], s59 offen
    s_add_u32 s59, s59, 28672
    buffer_load_dwordx4 v[140:143], v3, s[52:55], s59 offen
    s_add_u32 s59, s59, 28672
    buffer_load_dwordx4 v[144:147], v3, s[52:55], s59 offen
    s_add_u32 s59, s59, 28672
    buffer_load_dwordx4 v[148:151], v3, s[52:55], s59 offen
    s_add_u32 s59, s59, 28672
    buffer_load_dwordx4 v[152:155], v3, s[52:55], s59 offen
    s_add_u32 s59, s59, 28672
    buffer_load_dwordx4 v[156:159], v3, s[52:55], s59 offen
    s_waitcnt vmcnt(8)
    ds_write_b128 v4, v[96:99] offset:32768
    ds_write_b128 v4, v[100:103] offset:33792
    ds_write_b128 v4, v[104:107] offset:34816
    ds_write_b128 v4, v[108:111] offset:35840
    ds_write_b128 v4, v[112:115] offset:36864
    ds_write_b128 v4, v[116:119] offset:37888
    ds_write_b128 v4, v[120:123] offset:38912
    ds_write_b128 v4, v[124:127] offset:39936
    s_waitcnt lgkmcnt(0)
    s_barrier
    s_barrier
    s_add_u32 s59, s56, 1376256
    buffer_load_dwordx4 v[160:163], v3, s[52:55], s59 offen
    s_add_u32 s59, s59, 28672
    buffer_load_dwordx4 v[164:167], v3, s[52:55], s59 offen
    s_add_u32 s59, s59, 28672
    buffer_load_dwordx4 v[168:171], v3, s[52:55], s59 offen
    s_add_u32 s59, s59, 28672
    buffer_load_dwordx4 v[172:175], v3, s[52:55], s59 offen
    s_add_u32 s59, s59, 28672
    buffer_load_dwordx4 v[176:179], v3, s[52:55], s59 offen
    s_add_u32 s59, s59, 28672
    buffer_load_dwordx4 v[180:183], v3, s[52:55], s59 offen
    s_add_u32 s59, s59, 28672
    buffer_load_dwordx4 v[184:187], v3, s[52:55], s59 offen
    s_add_u32 s59, s59, 28672
    buffer_load_dwordx4 v[188:191], v3, s[52:55], s59 offen
    s_waitcnt vmcnt(8)
    ds_write_b128 v8, v[128:131] offset:0
    ds_write_b128 v8, v[132:135] offset:1024
    ds_write_b128 v8, v[136:139] offset:2048
    ds_write_b128 v8, v[140:143] offset:3072
    ds_write_b128 v8, v[144:147] offset:4096
    ds_write_b128 v8, v[148:151] offset:5120
    ds_write_b128 v8, v[152:155] offset:6144
    ds_write_b128 v8, v[156:159] offset:7168
    s_waitcnt lgkmcnt(0)
    v_lshrrev_b32 v6, 5, v0
    v_lshlrev_b32 v6, 2, v6
    v_bfe_u32 v10, v0, 2, 2
    v_add_u32 v10, v10, v6
    v_bfe_u32 v11, v0, 4, 1
    v_and_b32 v5, 3, v0
    v_lshlrev_b32 v5, 3, v5
    v_bfe_u32 v6, v10, 1, 1
    v_lshlrev_b32 v7, 1, v11
    v_xor_b32 v6, v6, v7
    v_xor_b32 v6, s50, v6
    v_lshlrev_b32 v7, 14, v11
    v_lshl_add_u32 v7, v10, 7, v7
    v_add_u32 v7, v7, v5
    v_lshl_add_u32 v6, v6, 5, v7
    v_mov_b32 v12, 0
    v_mov_b32 v13, 0
    v_mov_b32 v14, 0
    v_mov_b32 v15, 0
    ds_read_b64_tr_b16 v[192:193], v6 offset:0
    ds_read_b64_tr_b16 v[194:195], v6 offset:1024
    ds_read_b64_tr_b16 v[196:197], v6 offset:2048
    ds_read_b64_tr_b16 v[198:199], v6 offset:3072
    ds_read_b64_tr_b16 v[200:201], v6 offset:4096
    ds_read_b64_tr_b16 v[202:203], v6 offset:5120
    ds_read_b64_tr_b16 v[204:205], v6 offset:6144
    ds_read_b64_tr_b16 v[206:207], v6 offset:7168
    ds_read_b64_tr_b16 v[208:209], v6 offset:8192
    ds_read_b64_tr_b16 v[210:211], v6 offset:9216
    ds_read_b64_tr_b16 v[212:213], v6 offset:10240
    ds_read_b64_tr_b16 v[214:215], v6 offset:11264
    ds_read_b64_tr_b16 v[216:217], v6 offset:12288
    ds_read_b64_tr_b16 v[218:219], v6 offset:13312
    ds_read_b64_tr_b16 v[220:221], v6 offset:14336
    ds_read_b64_tr_b16 v[222:223], v6 offset:15360
    s_waitcnt lgkmcnt(14)
    v_dot2_f32_bf16 v12, v192, v9, v12
    v_dot2_f32_bf16 v13, v193, v9, v13
    v_dot2_f32_bf16 v14, v194, v9, v14
    v_dot2_f32_bf16 v15, v195, v9, v15
    s_waitcnt lgkmcnt(12)
    v_dot2_f32_bf16 v12, v196, v9, v12
    v_dot2_f32_bf16 v13, v197, v9, v13
    v_dot2_f32_bf16 v14, v198, v9, v14
    v_dot2_f32_bf16 v15, v199, v9, v15
    s_waitcnt lgkmcnt(10)
    v_dot2_f32_bf16 v12, v200, v9, v12
    v_dot2_f32_bf16 v13, v201, v9, v13
    v_dot2_f32_bf16 v14, v202, v9, v14
    v_dot2_f32_bf16 v15, v203, v9, v15
    s_waitcnt lgkmcnt(8)
    v_dot2_f32_bf16 v12, v204, v9, v12
    v_dot2_f32_bf16 v13, v205, v9, v13
    v_dot2_f32_bf16 v14, v206, v9, v14
    v_dot2_f32_bf16 v15, v207, v9, v15
    s_waitcnt lgkmcnt(6)
    v_dot2_f32_bf16 v12, v208, v9, v12
    v_dot2_f32_bf16 v13, v209, v9, v13
    v_dot2_f32_bf16 v14, v210, v9, v14
    v_dot2_f32_bf16 v15, v211, v9, v15
    s_waitcnt lgkmcnt(4)
    v_dot2_f32_bf16 v12, v212, v9, v12
    v_dot2_f32_bf16 v13, v213, v9, v13
    v_dot2_f32_bf16 v14, v214, v9, v14
    v_dot2_f32_bf16 v15, v215, v9, v15
    s_waitcnt lgkmcnt(2)
    v_dot2_f32_bf16 v12, v216, v9, v12
    v_dot2_f32_bf16 v13, v217, v9, v13
    v_dot2_f32_bf16 v14, v218, v9, v14
    v_dot2_f32_bf16 v15, v219, v9, v15
    s_waitcnt lgkmcnt(0)
    v_dot2_f32_bf16 v12, v220, v9, v12
    v_dot2_f32_bf16 v13, v221, v9, v13
    v_dot2_f32_bf16 v14, v222, v9, v14
    v_dot2_f32_bf16 v15, v223, v9, v15
    ds_read_b64_tr_b16 v[192:193], v6 offset:32768
    ds_read_b64_tr_b16 v[194:195], v6 offset:33792
    ds_read_b64_tr_b16 v[196:197], v6 offset:34816
    ds_read_b64_tr_b16 v[198:199], v6 offset:35840
    ds_read_b64_tr_b16 v[200:201], v6 offset:36864
    ds_read_b64_tr_b16 v[202:203], v6 offset:37888
    ds_read_b64_tr_b16 v[204:205], v6 offset:38912
    ds_read_b64_tr_b16 v[206:207], v6 offset:39936
    ds_read_b64_tr_b16 v[208:209], v6 offset:40960
    ds_read_b64_tr_b16 v[210:211], v6 offset:41984
    ds_read_b64_tr_b16 v[212:213], v6 offset:43008
    ds_read_b64_tr_b16 v[214:215], v6 offset:44032
    ds_read_b64_tr_b16 v[216:217], v6 offset:45056
    ds_read_b64_tr_b16 v[218:219], v6 offset:46080
    ds_read_b64_tr_b16 v[220:221], v6 offset:47104
    ds_read_b64_tr_b16 v[222:223], v6 offset:48128
    s_waitcnt lgkmcnt(14)
    v_dot2_f32_bf16 v12, v192, v9, v12
    v_dot2_f32_bf16 v13, v193, v9, v13
    v_dot2_f32_bf16 v14, v194, v9, v14
    v_dot2_f32_bf16 v15, v195, v9, v15
    s_waitcnt lgkmcnt(12)
    v_dot2_f32_bf16 v12, v196, v9, v12
    v_dot2_f32_bf16 v13, v197, v9, v13
    v_dot2_f32_bf16 v14, v198, v9, v14
    v_dot2_f32_bf16 v15, v199, v9, v15
    s_waitcnt lgkmcnt(10)
    v_dot2_f32_bf16 v12, v200, v9, v12
    v_dot2_f32_bf16 v13, v201, v9, v13
    v_dot2_f32_bf16 v14, v202, v9, v14
    v_dot2_f32_bf16 v15, v203, v9, v15
    s_waitcnt lgkmcnt(8)
    v_dot2_f32_bf16 v12, v204, v9, v12
    v_dot2_f32_bf16 v13, v205, v9, v13
    v_dot2_f32_bf16 v14, v206, v9, v14
    v_dot2_f32_bf16 v15, v207, v9, v15
    s_waitcnt lgkmcnt(6)
    v_dot2_f32_bf16 v12, v208, v9, v12
    v_dot2_f32_bf16 v13, v209, v9, v13
    v_dot2_f32_bf16 v14, v210, v9, v14
    v_dot2_f32_bf16 v15, v211, v9, v15
    s_waitcnt lgkmcnt(4)
    v_dot2_f32_bf16 v12, v212, v9, v12
    v_dot2_f32_bf16 v13, v213, v9, v13
    v_dot2_f32_bf16 v14, v214, v9, v14
    v_dot2_f32_bf16 v15, v215, v9, v15
    s_waitcnt lgkmcnt(2)
    v_dot2_f32_bf16 v12, v216, v9, v12
    v_dot2_f32_bf16 v13, v217, v9, v13
    v_dot2_f32_bf16 v14, v218, v9, v14
    v_dot2_f32_bf16 v15, v219, v9, v15
    s_waitcnt lgkmcnt(0)
    v_dot2_f32_bf16 v12, v220, v9, v12
    v_dot2_f32_bf16 v13, v221, v9, v13
    v_dot2_f32_bf16 v14, v222, v9, v14
    v_dot2_f32_bf16 v15, v223, v9, v15
    s_waitcnt lgkmcnt(0)
    s_barrier
    v_lshlrev_b32 v7, 7, v0
    s_and_b32 s58, s41, 1
    s_lshr_b32 s59, s41, 1
    s_mul_i32 s59, s59, 7
    s_lshl_b32 s60, s40, 3
    s_add_u32 s60, s60, s50
    s_lshl_b32 s61, s58, 2
    s_add_u32 s61, s61, s60
    s_mul_i32 s61, s61, 112
    s_add_u32 s61, s61, s59
    s_mul_i32 s62, s58, 3
    s_add_u32 s61, s61, s62
    s_lshl_b32 s61, s61, 10
    s_add_u32 s61, s61, 7077888
    s_mov_b32 exec_lo, 0xffffffff
    s_mov_b32 exec_hi, 0x0
    buffer_load_dword v255, v7, s[4:7], s61 offen sc1
    s_mov_b64 exec, -1
    s_xor_b32 s61, s58, 1
    s_lshl_b32 s61, s61, 2
    s_add_u32 s61, s61, s60
    s_mul_i32 s61, s61, 112
    s_add_u32 s61, s61, s59
    s_lshl_b32 s62, s58, 2
    s_add_u32 s61, s61, s62
    s_lshl_b32 s61, s61, 10
    s_add_u32 s61, s61, 7077888
    s_mov_b32 exec_lo, 0xffffff
    s_mov_b32 exec_hi, 0x0
    buffer_load_dword v255, v7, s[4:7], s61 offen sc1
    s_mov_b64 exec, -1
    s_waitcnt vmcnt(2)
    ds_write_b128 v8, v[160:163] offset:32768
    ds_write_b128 v8, v[164:167] offset:33792
    ds_write_b128 v8, v[168:171] offset:34816
    ds_write_b128 v8, v[172:175] offset:35840
    ds_write_b128 v8, v[176:179] offset:36864
    ds_write_b128 v8, v[180:183] offset:37888
    ds_write_b128 v8, v[184:187] offset:38912
    ds_write_b128 v8, v[188:191] offset:39936
    s_mul_i32 s58, s50, 7168
    s_add_u32 s58, s58, 131072
    s_lshr_b32 s59, s50, 1
    s_mul_i32 s59, s59, 896
    s_and_b32 s60, s50, 1
    s_mul_i32 s60, s60, 56
    s_add_u32 s59, s59, s60
    s_add_u32 s59, s59, 0
    s_lshl_b32 s59, s59, 10
    s_add_u32 s59, s59, s51
    s_mov_b32 m0, s58
    s_nop 0
    buffer_load_dwordx4 v2, s[28:31], s59 offen lds
    s_add_u32 s58, s58, 1024
    s_add_u32 s59, s59, 8192
    s_mov_b32 m0, s58
    s_nop 0
    buffer_load_dwordx4 v2, s[28:31], s59 offen lds
    s_add_u32 s58, s58, 1024
    s_add_u32 s59, s59, 8192
    s_mov_b32 m0, s58
    s_nop 0
    buffer_load_dwordx4 v2, s[28:31], s59 offen lds
    s_add_u32 s58, s58, 1024
    s_add_u32 s59, s59, 8192
    s_mov_b32 m0, s58
    s_nop 0
    buffer_load_dwordx4 v2, s[28:31], s59 offen lds
    s_add_u32 s58, s58, 1024
    s_add_u32 s59, s59, 8192
    s_mov_b32 m0, s58
    s_nop 0
    buffer_load_dwordx4 v2, s[28:31], s59 offen lds
    s_add_u32 s58, s58, 1024
    s_add_u32 s59, s59, 8192
    s_mov_b32 m0, s58
    s_nop 0
    buffer_load_dwordx4 v2, s[28:31], s59 offen lds
    s_add_u32 s58, s58, 1024
    s_add_u32 s59, s59, 8192
    s_mov_b32 m0, s58
    s_nop 0
    buffer_load_dwordx4 v2, s[28:31], s59 offen lds
    s_mul_i32 s58, s50, 7168
    s_add_u32 s58, s58, 0
    s_lshr_b32 s59, s50, 1
    s_mul_i32 s59, s59, 896
    s_and_b32 s60, s50, 1
    s_mul_i32 s60, s60, 56
    s_add_u32 s59, s59, s60
    s_add_u32 s59, s59, 112
    s_lshl_b32 s59, s59, 10
    s_add_u32 s59, s59, s51
    s_mov_b32 m0, s58
    s_nop 0
    buffer_load_dwordx4 v2, s[28:31], s59 offen lds
    s_add_u32 s58, s58, 1024
    s_add_u32 s59, s59, 8192
    s_mov_b32 m0, s58
    s_nop 0
    buffer_load_dwordx4 v2, s[28:31], s59 offen lds
    s_add_u32 s58, s58, 1024
    s_add_u32 s59, s59, 8192
    s_mov_b32 m0, s58
    s_nop 0
    buffer_load_dwordx4 v2, s[28:31], s59 offen lds
    s_add_u32 s58, s58, 1024
    s_add_u32 s59, s59, 8192
    s_mov_b32 m0, s58
    s_nop 0
    buffer_load_dwordx4 v2, s[28:31], s59 offen lds
    s_add_u32 s58, s58, 1024
    s_add_u32 s59, s59, 8192
    s_mov_b32 m0, s58
    s_nop 0
    buffer_load_dwordx4 v2, s[28:31], s59 offen lds
    s_add_u32 s58, s58, 1024
    s_add_u32 s59, s59, 8192
    s_mov_b32 m0, s58
    s_nop 0
    buffer_load_dwordx4 v2, s[28:31], s59 offen lds
    s_add_u32 s58, s58, 1024
    s_add_u32 s59, s59, 8192
    s_mov_b32 m0, s58
    s_nop 0
    buffer_load_dwordx4 v2, s[28:31], s59 offen lds
    s_waitcnt lgkmcnt(0)
    s_barrier
    v_lshrrev_b32 v6, 5, v0
    v_lshlrev_b32 v6, 2, v6
    v_bfe_u32 v10, v0, 2, 2
    v_add_u32 v10, v10, v6
    v_bfe_u32 v11, v0, 4, 1
    v_and_b32 v5, 3, v0
    v_lshlrev_b32 v5, 3, v5
    v_bfe_u32 v6, v10, 1, 1
    v_lshlrev_b32 v7, 1, v11
    v_xor_b32 v6, v6, v7
    v_xor_b32 v6, s50, v6
    v_lshlrev_b32 v7, 14, v11
    v_lshl_add_u32 v7, v10, 7, v7
    v_add_u32 v7, v7, v5
    v_lshl_add_u32 v6, v6, 5, v7
    v_add_u32 v6, 0x10000, v6
    ds_read_b64_tr_b16 v[192:193], v6 offset:0
    ds_read_b64_tr_b16 v[194:195], v6 offset:1024
    ds_read_b64_tr_b16 v[196:197], v6 offset:2048
    ds_read_b64_tr_b16 v[198:199], v6 offset:3072
    ds_read_b64_tr_b16 v[200:201], v6 offset:4096
    ds_read_b64_tr_b16 v[202:203], v6 offset:5120
    ds_read_b64_tr_b16 v[204:205], v6 offset:6144
    ds_read_b64_tr_b16 v[206:207], v6 offset:7168
    ds_read_b64_tr_b16 v[208:209], v6 offset:8192
    ds_read_b64_tr_b16 v[210:211], v6 offset:9216
    ds_read_b64_tr_b16 v[212:213], v6 offset:10240
    ds_read_b64_tr_b16 v[214:215], v6 offset:11264
    ds_read_b64_tr_b16 v[216:217], v6 offset:12288
    ds_read_b64_tr_b16 v[218:219], v6 offset:13312
    ds_read_b64_tr_b16 v[220:221], v6 offset:14336
    ds_read_b64_tr_b16 v[222:223], v6 offset:15360
    s_waitcnt lgkmcnt(14)
    v_dot2_f32_bf16 v12, v192, v9, v12
    v_dot2_f32_bf16 v13, v193, v9, v13
    v_dot2_f32_bf16 v14, v194, v9, v14
    v_dot2_f32_bf16 v15, v195, v9, v15
    s_waitcnt lgkmcnt(12)
    v_dot2_f32_bf16 v12, v196, v9, v12
    v_dot2_f32_bf16 v13, v197, v9, v13
    v_dot2_f32_bf16 v14, v198, v9, v14
    v_dot2_f32_bf16 v15, v199, v9, v15
    s_waitcnt lgkmcnt(10)
    v_dot2_f32_bf16 v12, v200, v9, v12
    v_dot2_f32_bf16 v13, v201, v9, v13
    v_dot2_f32_bf16 v14, v202, v9, v14
    v_dot2_f32_bf16 v15, v203, v9, v15
    s_waitcnt lgkmcnt(8)
    v_dot2_f32_bf16 v12, v204, v9, v12
    v_dot2_f32_bf16 v13, v205, v9, v13
    v_dot2_f32_bf16 v14, v206, v9, v14
    v_dot2_f32_bf16 v15, v207, v9, v15
    s_waitcnt lgkmcnt(6)
    v_dot2_f32_bf16 v12, v208, v9, v12
    v_dot2_f32_bf16 v13, v209, v9, v13
    v_dot2_f32_bf16 v14, v210, v9, v14
    v_dot2_f32_bf16 v15, v211, v9, v15
    s_waitcnt lgkmcnt(4)
    v_dot2_f32_bf16 v12, v212, v9, v12
    v_dot2_f32_bf16 v13, v213, v9, v13
    v_dot2_f32_bf16 v14, v214, v9, v14
    v_dot2_f32_bf16 v15, v215, v9, v15
    s_waitcnt lgkmcnt(2)
    v_dot2_f32_bf16 v12, v216, v9, v12
    v_dot2_f32_bf16 v13, v217, v9, v13
    v_dot2_f32_bf16 v14, v218, v9, v14
    v_dot2_f32_bf16 v15, v219, v9, v15
    s_waitcnt lgkmcnt(0)
    v_dot2_f32_bf16 v12, v220, v9, v12
    v_dot2_f32_bf16 v13, v221, v9, v13
    v_dot2_f32_bf16 v14, v222, v9, v14
    v_dot2_f32_bf16 v15, v223, v9, v15
    ds_read_b64_tr_b16 v[192:193], v6 offset:32768
    ds_read_b64_tr_b16 v[194:195], v6 offset:33792
    ds_read_b64_tr_b16 v[196:197], v6 offset:34816
    ds_read_b64_tr_b16 v[198:199], v6 offset:35840
    ds_read_b64_tr_b16 v[200:201], v6 offset:36864
    ds_read_b64_tr_b16 v[202:203], v6 offset:37888
    ds_read_b64_tr_b16 v[204:205], v6 offset:38912
    ds_read_b64_tr_b16 v[206:207], v6 offset:39936
    ds_read_b64_tr_b16 v[208:209], v6 offset:40960
    ds_read_b64_tr_b16 v[210:211], v6 offset:41984
    ds_read_b64_tr_b16 v[212:213], v6 offset:43008
    ds_read_b64_tr_b16 v[214:215], v6 offset:44032
    ds_read_b64_tr_b16 v[216:217], v6 offset:45056
    ds_read_b64_tr_b16 v[218:219], v6 offset:46080
    ds_read_b64_tr_b16 v[220:221], v6 offset:47104
    ds_read_b64_tr_b16 v[222:223], v6 offset:48128
    s_waitcnt lgkmcnt(14)
    v_dot2_f32_bf16 v12, v192, v9, v12
    v_dot2_f32_bf16 v13, v193, v9, v13
    v_dot2_f32_bf16 v14, v194, v9, v14
    v_dot2_f32_bf16 v15, v195, v9, v15
    s_waitcnt lgkmcnt(12)
    v_dot2_f32_bf16 v12, v196, v9, v12
    v_dot2_f32_bf16 v13, v197, v9, v13
    v_dot2_f32_bf16 v14, v198, v9, v14
    v_dot2_f32_bf16 v15, v199, v9, v15
    s_waitcnt lgkmcnt(10)
    v_dot2_f32_bf16 v12, v200, v9, v12
    v_dot2_f32_bf16 v13, v201, v9, v13
    v_dot2_f32_bf16 v14, v202, v9, v14
    v_dot2_f32_bf16 v15, v203, v9, v15
    s_waitcnt lgkmcnt(8)
    v_dot2_f32_bf16 v12, v204, v9, v12
    v_dot2_f32_bf16 v13, v205, v9, v13
    v_dot2_f32_bf16 v14, v206, v9, v14
    v_dot2_f32_bf16 v15, v207, v9, v15
    s_waitcnt lgkmcnt(6)
    v_dot2_f32_bf16 v12, v208, v9, v12
    v_dot2_f32_bf16 v13, v209, v9, v13
    v_dot2_f32_bf16 v14, v210, v9, v14
    v_dot2_f32_bf16 v15, v211, v9, v15
    s_waitcnt lgkmcnt(4)
    v_dot2_f32_bf16 v12, v212, v9, v12
    v_dot2_f32_bf16 v13, v213, v9, v13
    v_dot2_f32_bf16 v14, v214, v9, v14
    v_dot2_f32_bf16 v15, v215, v9, v15
    s_waitcnt lgkmcnt(2)
    v_dot2_f32_bf16 v12, v216, v9, v12
    v_dot2_f32_bf16 v13, v217, v9, v13
    v_dot2_f32_bf16 v14, v218, v9, v14
    v_dot2_f32_bf16 v15, v219, v9, v15
    s_waitcnt lgkmcnt(0)
    v_dot2_f32_bf16 v12, v220, v9, v12
    v_dot2_f32_bf16 v13, v221, v9, v13
    v_dot2_f32_bf16 v14, v222, v9, v14
    v_dot2_f32_bf16 v15, v223, v9, v15
    s_nop 0
    v_add_f32 v12, v12, v13
    s_nop 0
    v_add_f32 v14, v14, v15
    v_add_f32 v12, v12, v14
    v_mov_b32 v13, v12
    s_nop 1
    v_permlane32_swap_b32 v12, v13
    v_add_f32 v12, v12, v13
    v_cvt_pk_bf16_f32 v14, v12, v12
    v_lshlrev_b32 v13, 16, v14
    v_sub_f32 v13, v12, v13
    v_cvt_pk_bf16_f32 v15, v13, v13
    s_lshl_b32 s58, s50, 8
    s_add_u32 s58, s58, 162304
    v_and_b32 v10, 31, v0
    v_lshl_add_u32 v10, v10, 3, s58
    s_mov_b32 exec_lo, 0xffffffff
    s_mov_b32 exec_hi, 0x0
    ds_write_b64 v10, v[14:15]
    s_mov_b64 exec, -1
    s_waitcnt lgkmcnt(0)
    s_mul_i32 s58, s50, 7168
    s_add_u32 s58, s58, 32768
    s_lshr_b32 s59, s50, 1
    s_mul_i32 s59, s59, 896
    s_and_b32 s60, s50, 1
    s_mul_i32 s60, s60, 56
    s_add_u32 s59, s59, s60
    s_add_u32 s59, s59, 224
    s_lshl_b32 s59, s59, 10
    s_add_u32 s59, s59, s51
    s_mov_b32 m0, s58
    s_nop 0
    buffer_load_dwordx4 v2, s[28:31], s59 offen lds
    s_add_u32 s58, s58, 1024
    s_add_u32 s59, s59, 8192
    s_mov_b32 m0, s58
    s_nop 0
    buffer_load_dwordx4 v2, s[28:31], s59 offen lds
    s_add_u32 s58, s58, 1024
    s_add_u32 s59, s59, 8192
    s_mov_b32 m0, s58
    s_nop 0
    buffer_load_dwordx4 v2, s[28:31], s59 offen lds
    s_add_u32 s58, s58, 1024
    s_add_u32 s59, s59, 8192
    s_mov_b32 m0, s58
    s_nop 0
    buffer_load_dwordx4 v2, s[28:31], s59 offen lds
    s_add_u32 s58, s58, 1024
    s_add_u32 s59, s59, 8192
    s_mov_b32 m0, s58
    s_nop 0
    buffer_load_dwordx4 v2, s[28:31], s59 offen lds
    s_add_u32 s58, s58, 1024
    s_add_u32 s59, s59, 8192
    s_mov_b32 m0, s58
    s_nop 0
    buffer_load_dwordx4 v2, s[28:31], s59 offen lds
    s_add_u32 s58, s58, 1024
    s_add_u32 s59, s59, 8192
    s_mov_b32 m0, s58
    s_nop 0
    buffer_load_dwordx4 v2, s[28:31], s59 offen lds
    s_barrier
    s_mul_i32 s58, s50, 7168
    s_add_u32 s58, s58, 65536
    s_lshr_b32 s59, s50, 1
    s_mul_i32 s59, s59, 896
    s_and_b32 s60, s50, 1
    s_mul_i32 s60, s60, 56
    s_add_u32 s59, s59, s60
    s_add_u32 s59, s59, 336
    s_lshl_b32 s59, s59, 10
    s_add_u32 s59, s59, s51
    s_mov_b32 m0, s58
    s_nop 0
    buffer_load_dwordx4 v2, s[28:31], s59 offen lds
    s_add_u32 s58, s58, 1024
    s_add_u32 s59, s59, 8192
    s_mov_b32 m0, s58
    s_nop 0
    buffer_load_dwordx4 v2, s[28:31], s59 offen lds
    s_add_u32 s58, s58, 1024
    s_add_u32 s59, s59, 8192
    s_mov_b32 m0, s58
    s_nop 0
    buffer_load_dwordx4 v2, s[28:31], s59 offen lds
    s_add_u32 s58, s58, 1024
    s_add_u32 s59, s59, 8192
    s_mov_b32 m0, s58
    s_nop 0
    buffer_load_dwordx4 v2, s[28:31], s59 offen lds
    s_add_u32 s58, s58, 1024
    s_add_u32 s59, s59, 8192
    s_mov_b32 m0, s58
    s_nop 0
    buffer_load_dwordx4 v2, s[28:31], s59 offen lds
    s_add_u32 s58, s58, 1024
    s_add_u32 s59, s59, 8192
    s_mov_b32 m0, s58
    s_nop 0
    buffer_load_dwordx4 v2, s[28:31], s59 offen lds
    s_add_u32 s58, s58, 1024
    s_add_u32 s59, s59, 8192
    s_mov_b32 m0, s58
    s_nop 0
    buffer_load_dwordx4 v2, s[28:31], s59 offen lds
    s_barrier
    s_mul_i32 s58, s50, 7168
    s_add_u32 s58, s58, 98304
    s_lshr_b32 s59, s50, 1
    s_mul_i32 s59, s59, 896
    s_and_b32 s60, s50, 1
    s_mul_i32 s60, s60, 56
    s_add_u32 s59, s59, s60
    s_add_u32 s59, s59, 448
    s_lshl_b32 s59, s59, 10
    s_add_u32 s59, s59, s51
    s_mov_b32 m0, s58
    s_nop 0
    buffer_load_dwordx4 v2, s[28:31], s59 offen lds
    s_add_u32 s58, s58, 1024
    s_add_u32 s59, s59, 8192
    s_mov_b32 m0, s58
    s_nop 0
    buffer_load_dwordx4 v2, s[28:31], s59 offen lds
    s_add_u32 s58, s58, 1024
    s_add_u32 s59, s59, 8192
    s_mov_b32 m0, s58
    s_nop 0
    buffer_load_dwordx4 v2, s[28:31], s59 offen lds
    s_add_u32 s58, s58, 1024
    s_add_u32 s59, s59, 8192
    s_mov_b32 m0, s58
    s_nop 0
    buffer_load_dwordx4 v2, s[28:31], s59 offen lds
    s_add_u32 s58, s58, 1024
    s_add_u32 s59, s59, 8192
    s_mov_b32 m0, s58
    s_nop 0
    buffer_load_dwordx4 v2, s[28:31], s59 offen lds
    s_add_u32 s58, s58, 1024
    s_add_u32 s59, s59, 8192
    s_mov_b32 m0, s58
    s_nop 0
    buffer_load_dwordx4 v2, s[28:31], s59 offen lds
    s_add_u32 s58, s58, 1024
    s_add_u32 s59, s59, 8192
    s_mov_b32 m0, s58
    s_nop 0
    buffer_load_dwordx4 v2, s[28:31], s59 offen lds
    s_waitcnt vmcnt(21)
    s_barrier
    s_waitcnt vmcnt(14)
    s_barrier
    s_mul_i32 s58, s50, 7168
    s_add_u32 s58, s58, 131072
    s_lshr_b32 s59, s50, 1
    s_mul_i32 s59, s59, 896
    s_and_b32 s60, s50, 1
    s_mul_i32 s60, s60, 56
    s_add_u32 s59, s59, s60
    s_add_u32 s59, s59, 560
    s_lshl_b32 s59, s59, 10
    s_add_u32 s59, s59, s51
    s_mov_b32 m0, s58
    s_nop 0
    buffer_load_dwordx4 v2, s[28:31], s59 offen lds
    s_add_u32 s58, s58, 1024
    s_add_u32 s59, s59, 8192
    s_mov_b32 m0, s58
    s_nop 0
    buffer_load_dwordx4 v2, s[28:31], s59 offen lds
    s_add_u32 s58, s58, 1024
    s_add_u32 s59, s59, 8192
    s_mov_b32 m0, s58
    s_nop 0
    buffer_load_dwordx4 v2, s[28:31], s59 offen lds
    s_add_u32 s58, s58, 1024
    s_add_u32 s59, s59, 8192
    s_mov_b32 m0, s58
    s_nop 0
    buffer_load_dwordx4 v2, s[28:31], s59 offen lds
    s_add_u32 s58, s58, 1024
    s_add_u32 s59, s59, 8192
    s_mov_b32 m0, s58
    s_nop 0
    buffer_load_dwordx4 v2, s[28:31], s59 offen lds
    s_add_u32 s58, s58, 1024
    s_add_u32 s59, s59, 8192
    s_mov_b32 m0, s58
    s_nop 0
    buffer_load_dwordx4 v2, s[28:31], s59 offen lds
    s_add_u32 s58, s58, 1024
    s_add_u32 s59, s59, 8192
    s_mov_b32 m0, s58
    s_nop 0
    buffer_load_dwordx4 v2, s[28:31], s59 offen lds
    s_waitcnt vmcnt(14)
    s_barrier
    s_mul_i32 s58, s50, 7168
    s_add_u32 s58, s58, 0
    s_lshr_b32 s59, s50, 1
    s_mul_i32 s59, s59, 896
    s_and_b32 s60, s50, 1
    s_mul_i32 s60, s60, 56
    s_add_u32 s59, s59, s60
    s_add_u32 s59, s59, 672
    s_lshl_b32 s59, s59, 10
    s_add_u32 s59, s59, s51
    s_mov_b32 m0, s58
    s_nop 0
    buffer_load_dwordx4 v2, s[28:31], s59 offen lds
    s_add_u32 s58, s58, 1024
    s_add_u32 s59, s59, 8192
    s_mov_b32 m0, s58
    s_nop 0
    buffer_load_dwordx4 v2, s[28:31], s59 offen lds
    s_add_u32 s58, s58, 1024
    s_add_u32 s59, s59, 8192
    s_mov_b32 m0, s58
    s_nop 0
    buffer_load_dwordx4 v2, s[28:31], s59 offen lds
    s_add_u32 s58, s58, 1024
    s_add_u32 s59, s59, 8192
    s_mov_b32 m0, s58
    s_nop 0
    buffer_load_dwordx4 v2, s[28:31], s59 offen lds
    s_add_u32 s58, s58, 1024
    s_add_u32 s59, s59, 8192
    s_mov_b32 m0, s58
    s_nop 0
    buffer_load_dwordx4 v2, s[28:31], s59 offen lds
    s_add_u32 s58, s58, 1024
    s_add_u32 s59, s59, 8192
    s_mov_b32 m0, s58
    s_nop 0
    buffer_load_dwordx4 v2, s[28:31], s59 offen lds
    s_add_u32 s58, s58, 1024
    s_add_u32 s59, s59, 8192
    s_mov_b32 m0, s58
    s_nop 0
    buffer_load_dwordx4 v2, s[28:31], s59 offen lds
    s_waitcnt vmcnt(14)
    s_barrier
    s_mul_i32 s58, s50, 7168
    s_add_u32 s58, s58, 32768
    s_lshr_b32 s59, s50, 1
    s_mul_i32 s59, s59, 896
    s_and_b32 s60, s50, 1
    s_mul_i32 s60, s60, 56
    s_add_u32 s59, s59, s60
    s_add_u32 s59, s59, 784
    s_lshl_b32 s59, s59, 10
    s_add_u32 s59, s59, s51
    s_mov_b32 m0, s58
    s_nop 0
    buffer_load_dwordx4 v2, s[28:31], s59 offen lds
    s_add_u32 s58, s58, 1024
    s_add_u32 s59, s59, 8192
    s_mov_b32 m0, s58
    s_nop 0
    buffer_load_dwordx4 v2, s[28:31], s59 offen lds
    s_add_u32 s58, s58, 1024
    s_add_u32 s59, s59, 8192
    s_mov_b32 m0, s58
    s_nop 0
    buffer_load_dwordx4 v2, s[28:31], s59 offen lds
    s_add_u32 s58, s58, 1024
    s_add_u32 s59, s59, 8192
    s_mov_b32 m0, s58
    s_nop 0
    buffer_load_dwordx4 v2, s[28:31], s59 offen lds
    s_add_u32 s58, s58, 1024
    s_add_u32 s59, s59, 8192
    s_mov_b32 m0, s58
    s_nop 0
    buffer_load_dwordx4 v2, s[28:31], s59 offen lds
    s_add_u32 s58, s58, 1024
    s_add_u32 s59, s59, 8192
    s_mov_b32 m0, s58
    s_nop 0
    buffer_load_dwordx4 v2, s[28:31], s59 offen lds
    s_add_u32 s58, s58, 1024
    s_add_u32 s59, s59, 8192
    s_mov_b32 m0, s58
    s_nop 0
    buffer_load_dwordx4 v2, s[28:31], s59 offen lds
    s_waitcnt vmcnt(14)
    s_barrier
    s_waitcnt vmcnt(7)
    s_barrier
    s_waitcnt vmcnt(0)
    s_barrier
    s_barrier
    s_lshl_b32 s58, s50, 10
    v_add_u32 v13, s58, v1
    ds_write_b128 v13, v[16:19] offset:0
    ds_write_b128 v13, v[20:23] offset:4096
    ds_write_b128 v13, v[48:51] offset:32768
    ds_write_b128 v13, v[24:27] offset:8192
    ds_write_b128 v13, v[28:31] offset:12288
    ds_write_b128 v13, v[52:55] offset:36864
    ds_write_b128 v13, v[32:35] offset:16384
    ds_write_b128 v13, v[36:39] offset:20480
    ds_write_b128 v13, v[40:43] offset:24576
    ds_write_b128 v13, v[44:47] offset:28672
    ds_write_b128 v13, v[56:59] offset:40960
    ds_write_b128 v13, v[60:63] offset:45056
    s_waitcnt lgkmcnt(0)
    s_barrier
    s_waitcnt lgkmcnt(0)
    s_barrier
    s_barrier
    s_barrier
    v_lshrrev_b32 v7, 3, v0
    s_mov_b32 s58, 32768
    v_mul_lo_u32 v7, v7, s58
    v_and_b32 v6, 7, v0
    v_lshl_add_u32 v7, v6, 7, v7
    s_lshl_b32 s58, s40, 3
    s_lshl_b32 s59, s50, 1
    s_add_u32 s58, s58, s59
    s_mul_i32 s58, s58, 32768
    s_lshl_b32 s59, s41, 10
    s_add_u32 s58, s58, s59
    s_add_u32 s58, s58, 4718592
    s_add_u32 s58, s58, s93
    s_mov_b32 exec_lo, 0xffff
    s_mov_b32 exec_hi, 0x0
    buffer_load_dword v255, v7, s[4:7], s58 offen sc1
    s_mov_b64 exec, -1
    s_barrier
    s_barrier
    s_waitcnt vmcnt(0)
    s_cmp_eq_u32 s40, 7
    s_cbranch_scc1 L_nokv_62
    s_lshl_b32 s58, s50, 12
    s_add_u32 s59, s58, 131072
    v_add_u32 v10, s59, v1
    ds_read_b128 v[192:195], v10 offset:0
    ds_read_b128 v[196:199], v10 offset:1024
    ds_read_b128 v[200:203], v10 offset:2048
    ds_read_b128 v[204:207], v10 offset:3072
    s_lshl_b32 s59, s40, 5
    s_add_u32 s59, s59, s41
    s_lshl_b32 s60, s59, 14
    s_add_u32 s60, s60, s58
    s_add_u32 s60, s60, 37748736
    s_waitcnt lgkmcnt(3)
    buffer_store_dwordx4 v[192:195], v1, s[4:7], s60 offen offset:0 sc1
    s_waitcnt lgkmcnt(2)
    buffer_store_dwordx4 v[196:199], v1, s[4:7], s60 offen offset:1024 sc1
    s_waitcnt lgkmcnt(1)
    buffer_store_dwordx4 v[200:203], v1, s[4:7], s60 offen offset:2048 sc1
    s_waitcnt lgkmcnt(0)
    buffer_store_dwordx4 v[204:207], v1, s[4:7], s60 offen offset:3072 sc1
    s_lshl_b32 s59, s59, 7
    s_lshl_b32 s60, s50, 2
    s_add_u32 s59, s59, s60
    s_add_u32 s59, s59, 42369024
    v_mov_b32 v10, 0
    v_mov_b32 v11, s98
    s_waitcnt vmcnt(0)
    s_mov_b64 exec, 1
    buffer_store_dword v11, v10, s[4:7], s59 offen sc1
    s_mov_b64 exec, -1
L_nokv_62:
    s_cmp_eq_u32 s40, 0
    s_cbranch_scc1 L_nohalo_63
    s_sub_u32 s59, s40, 1
    s_lshl_b32 s59, s59, 5
    s_add_u32 s59, s59, s41
    s_lshl_b32 s46, s59, 7
    s_lshl_b32 s60, s50, 2
    s_add_u32 s46, s46, s60
    s_add_u32 s46, s46, 42369024
    v_lshlrev_b32 v5, 2, v0
    s_mov_b32 exec_lo, 0x1
    s_mov_b32 exec_hi, 0x0
    s_mov_b32 s45, 0
L_poll_65:
    buffer_load_dword v6, v5, s[4:7], s46 offen sc1
    s_waitcnt vmcnt(0)
    v_subrev_u32 v6, s97, v6
    v_cmp_gt_u32 vcc, 2, v6
    s_cmp_eq_u64 vcc, exec
    s_cbranch_scc1 L_polldone_66
    s_add_u32 s45, s45, 1
    s_cmp_lt_u32 s45, 200000
    s_cbranch_scc1 L_poll_65
    v_mov_b32 v6, 111
    v_mov_b32 v7, 20
    buffer_store_dword v6, v7, s[36:39], 0 offen
    s_waitcnt vmcnt(0)
L_polldone_66:
    s_mov_b64 exec, -1
    s_lshl_b32 s60, s59, 14
    s_lshl_b32 s58, s50, 12
    s_add_u32 s60, s60, s58
    s_add_u32 s60, s60, 37748736
    s_add_u32 s58, s58, 49152
    s_mov_b32 m0, s58
    s_nop 0
    buffer_load_dwordx4 v1, s[4:7], s60 offen offset:0 sc1 lds
    buffer_load_dwordx4 v1, s[4:7], s60 offen offset:1024 sc1 lds
    buffer_load_dwordx4 v1, s[4:7], s60 offen offset:2048 sc1 lds
    buffer_load_dwordx4 v1, s[4:7], s60 offen offset:3072 sc1 lds
    s_branch L_halod_64
L_nohalo_63:
    s_waitcnt vmcnt(0)
L_halod_64:
    s_waitcnt vmcnt(0)
    s_barrier
    s_lshl_b32 s58, s50, 14
    s_add_u32 s58, s58, 65536
    s_lshl_b32 s59, s50, 17
    s_add_u32 s59, s59, s51
    s_mov_b32 m0, s58
    s_nop 0
    buffer_load_dwordx4 v2, s[16:19], s59 offen lds
    s_add_u32 s58, s58, 1024
    s_add_u32 s59, s59, 8192
    s_mov_b32 m0, s58
    s_nop 0
    buffer_load_dwordx4 v2, s[16:19], s59 offen lds
    s_add_u32 s58, s58, 1024
    s_add_u32 s59, s59, 8192
    s_mov_b32 m0, s58
    s_nop 0
    buffer_load_dwordx4 v2, s[16:19], s59 offen lds
    s_add_u32 s58, s58, 1024
    s_add_u32 s59, s59, 8192
    s_mov_b32 m0, s58
    s_nop 0
    buffer_load_dwordx4 v2, s[16:19], s59 offen lds
    s_add_u32 s58, s58, 1024
    s_add_u32 s59, s59, 8192
    s_mov_b32 m0, s58
    s_nop 0
    buffer_load_dwordx4 v2, s[16:19], s59 offen lds
    s_add_u32 s58, s58, 1024
    s_add_u32 s59, s59, 8192
    s_mov_b32 m0, s58
    s_nop 0
    buffer_load_dwordx4 v2, s[16:19], s59 offen lds
    s_add_u32 s58, s58, 1024
    s_add_u32 s59, s59, 8192
    s_mov_b32 m0, s58
    s_nop 0
    buffer_load_dwordx4 v2, s[16:19], s59 offen lds
    s_add_u32 s58, s58, 1024
    s_add_u32 s59, s59, 8192
    s_mov_b32 m0, s58
    s_nop 0
    buffer_load_dwordx4 v2, s[16:19], s59 offen lds
    s_add_u32 s58, s58, 1024
    s_add_u32 s59, s59, 8192
    s_mov_b32 m0, s58
    s_nop 0
    buffer_load_dwordx4 v2, s[16:19], s59 offen lds
    s_add_u32 s58, s58, 1024
    s_add_u32 s59, s59, 8192
    s_mov_b32 m0, s58
    s_nop 0
    buffer_load_dwordx4 v2, s[16:19], s59 offen lds
    s_add_u32 s58, s58, 1024
    s_add_u32 s59, s59, 8192
    s_mov_b32 m0, s58
    s_nop 0
    buffer_load_dwordx4 v2, s[16:19], s59 offen lds
    s_add_u32 s58, s58, 1024
    s_add_u32 s59, s59, 8192
    s_mov_b32 m0, s58
    s_nop 0
    buffer_load_dwordx4 v2, s[16:19], s59 offen lds
    s_add_u32 s58, s58, 1024
    s_add_u32 s59, s59, 8192
    s_mov_b32 m0, s58
    s_nop 0
    buffer_load_dwordx4 v2, s[16:19], s59 offen lds
    s_add_u32 s58, s58, 1024
    s_add_u32 s59, s59, 8192
    s_mov_b32 m0, s58
    s_nop 0
    buffer_load_dwordx4 v2, s[16:19], s59 offen lds
    s_add_u32 s58, s58, 1024
    s_add_u32 s59, s59, 8192
    s_mov_b32 m0, s58
    s_nop 0
    buffer_load_dwordx4 v2, s[16:19], s59 offen lds
    s_add_u32 s58, s58, 1024
    s_add_u32 s59, s59, 8192
    s_mov_b32 m0, s58
    s_nop 0
    buffer_load_dwordx4 v2, s[16:19], s59 offen lds
    v_lshlrev_b32 v7, 7, v0
    s_lshr_b32 s58, s41, 3
    s_lshl_b32 s58, s58, 1
    s_lshr_b32 s59, s50, 1
    s_add_u32 s58, s58, s59
    s_lshl_b32 s59, s40, 3
    s_add_u32 s58, s58, s59
    s_and_b32 s59, s41, 7
    s_lshl_b32 s59, s59, 1
    s_and_b32 s60, s50, 1
    s_add_u32 s59, s59, s60
    s_mul_i32 s60, s58, 32768
    s_lshl_b32 s61, s59, 11
    s_add_u32 s60, s60, s61
    s_add_u32 s60, s60, 2359296
    s_add_u32 s60, s60, s93
    s_mov_b32 exec_lo, 0xffff
    s_mov_b32 exec_hi, 0x0
    buffer_load_dword v255, v7, s[4:7], s60 offen sc1
    s_mov_b64 exec, -1
    s_lshl_b32 s60, s58, 12
    s_lshl_b32 s61, s59, 8
    s_add_u32 s60, s60, s61
    s_add_u32 s60, s60, 14942208
    s_add_u32 s60, s60, s93
    s_mov_b32 exec_lo, 0x3
    s_mov_b32 exec_hi, 0x0
    buffer_load_dword v255, v7, s[4:7], s60 offen sc1
    s_mov_b64 exec, -1
    s_waitcnt vmcnt(2)
    s_barrier
    ds_write_b128 v4, v[64:67] offset:0
    ds_write_b128 v4, v[68:71] offset:1024
    ds_write_b128 v4, v[72:75] offset:2048
    ds_write_b128 v4, v[76:79] offset:3072
    ds_write_b128 v4, v[80:83] offset:4096
    ds_write_b128 v4, v[84:87] offset:5120
    ds_write_b128 v4, v[88:91] offset:6144
    ds_write_b128 v4, v[92:95] offset:7168
    ds_write_b128 v4, v[96:99] offset:32768
    ds_write_b128 v4, v[100:103] offset:33792
    ds_write_b128 v4, v[104:107] offset:34816
    ds_write_b128 v4, v[108:111] offset:35840
    ds_write_b128 v4, v[112:115] offset:36864
    ds_write_b128 v4, v[116:119] offset:37888
    ds_write_b128 v4, v[120:123] offset:38912
    ds_write_b128 v4, v[124:127] offset:39936
    s_waitcnt lgkmcnt(0)
    s_barrier
    s_barrier
    ds_write_b128 v8, v[128:131] offset:0
    ds_write_b128 v8, v[132:135] offset:1024
    ds_write_b128 v8, v[136:139] offset:2048
    ds_write_b128 v8, v[140:143] offset:3072
    ds_write_b128 v8, v[144:147] offset:4096
    ds_write_b128 v8, v[148:151] offset:5120
    ds_write_b128 v8, v[152:155] offset:6144
    ds_write_b128 v8, v[156:159] offset:7168
    s_waitcnt lgkmcnt(0)
    s_barrier
    v_lshlrev_b32 v7, 7, v0
    s_and_b32 s58, s41, 1
    s_lshr_b32 s59, s41, 1
    s_mul_i32 s59, s59, 7
    s_lshl_b32 s60, s40, 3
    s_add_u32 s60, s60, s50
    s_lshl_b32 s61, s58, 2
    s_add_u32 s61, s61, s60
    s_mul_i32 s61, s61, 112
    s_add_u32 s61, s61, s59
    s_mul_i32 s62, s58, 3
    s_add_u32 s61, s61, s62
    s_lshl_b32 s61, s61, 10
    s_add_u32 s61, s61, 7077888
    s_add_u32 s61, s61, s93
    s_mov_b32 exec_lo, 0xffffffff
    s_mov_b32 exec_hi, 0x0
    buffer_load_dword v255, v7, s[4:7], s61 offen sc1
    s_mov_b64 exec, -1
    s_xor_b32 s61, s58, 1
    s_lshl_b32 s61, s61, 2
    s_add_u32 s61, s61, s60
    s_mul_i32 s61, s61, 112
    s_add_u32 s61, s61, s59
    s_lshl_b32 s62, s58, 2
    s_add_u32 s61, s61, s62
    s_lshl_b32 s61, s61, 10
    s_add_u32 s61, s61, 7077888
    s_add_u32 s61, s61, s93
    s_mov_b32 exec_lo, 0xffffff
    s_mov_b32 exec_hi, 0x0
    buffer_load_dword v255, v7, s[4:7], s61 offen sc1
    s_mov_b64 exec, -1
    ds_write_b128 v8, v[160:163] offset:32768
    ds_write_b128 v8, v[164:167] offset:33792
    ds_write_b128 v8, v[168:171] offset:34816
    ds_write_b128 v8, v[172:175] offset:35840
    ds_write_b128 v8, v[176:179] offset:36864
    ds_write_b128 v8, v[180:183] offset:37888
    ds_write_b128 v8, v[184:187] offset:38912
    ds_write_b128 v8, v[188:191] offset:39936
    s_mul_i32 s58, s50, 7168
    s_add_u32 s58, s58, 131072
    s_lshr_b32 s59, s50, 1
    s_mul_i32 s59, s59, 896
    s_and_b32 s60, s50, 1
    s_mul_i32 s60, s60, 56
    s_add_u32 s59, s59, s60
    s_add_u32 s59, s59, 0
    s_lshl_b32 s59, s59, 10
    s_add_u32 s59, s59, s51
    s_mov_b32 m0, s58
    s_nop 0
    buffer_load_dwordx4 v2, s[28:31], s59 offen lds
    s_add_u32 s58, s58, 1024
    s_add_u32 s59, s59, 8192
    s_mov_b32 m0, s58
    s_nop 0
    buffer_load_dwordx4 v2, s[28:31], s59 offen lds
    s_add_u32 s58, s58, 1024
    s_add_u32 s59, s59, 8192
    s_mov_b32 m0, s58
    s_nop 0
    buffer_load_dwordx4 v2, s[28:31], s59 offen lds
    s_add_u32 s58, s58, 1024
    s_add_u32 s59, s59, 8192
    s_mov_b32 m0, s58
    s_nop 0
    buffer_load_dwordx4 v2, s[28:31], s59 offen lds
    s_add_u32 s58, s58, 1024
    s_add_u32 s59, s59, 8192
    s_mov_b32 m0, s58
    s_nop 0
    buffer_load_dwordx4 v2, s[28:31], s59 offen lds
    s_add_u32 s58, s58, 1024
    s_add_u32 s59, s59, 8192
    s_mov_b32 m0, s58
    s_nop 0
    buffer_load_dwordx4 v2, s[28:31], s59 offen lds
    s_add_u32 s58, s58, 1024
    s_add_u32 s59, s59, 8192
    s_mov_b32 m0, s58
    s_nop 0
    buffer_load_dwordx4 v2, s[28:31], s59 offen lds
    s_mul_i32 s58, s50, 7168
    s_add_u32 s58, s58, 0
    s_lshr_b32 s59, s50, 1
    s_mul_i32 s59, s59, 896
    s_and_b32 s60, s50, 1
    s_mul_i32 s60, s60, 56
    s_add_u32 s59, s59, s60
    s_add_u32 s59, s59, 112
    s_lshl_b32 s59, s59, 10
    s_add_u32 s59, s59, s51
    s_mov_b32 m0, s58
    s_nop 0
    buffer_load_dwordx4 v2, s[28:31], s59 offen lds
    s_add_u32 s58, s58, 1024
    s_add_u32 s59, s59, 8192
    s_mov_b32 m0, s58
    s_nop 0
    buffer_load_dwordx4 v2, s[28:31], s59 offen lds
    s_add_u32 s58, s58, 1024
    s_add_u32 s59, s59, 8192
    s_mov_b32 m0, s58
    s_nop 0
    buffer_load_dwordx4 v2, s[28:31], s59 offen lds
    s_add_u32 s58, s58, 1024
    s_add_u32 s59, s59, 8192
    s_mov_b32 m0, s58
    s_nop 0
    buffer_load_dwordx4 v2, s[28:31], s59 offen lds
    s_add_u32 s58, s58, 1024
    s_add_u32 s59, s59, 8192
    s_mov_b32 m0, s58
    s_nop 0
    buffer_load_dwordx4 v2, s[28:31], s59 offen lds
    s_add_u32 s58, s58, 1024
    s_add_u32 s59, s59, 8192
    s_mov_b32 m0, s58
    s_nop 0
    buffer_load_dwordx4 v2, s[28:31], s59 offen lds
    s_add_u32 s58, s58, 1024
    s_add_u32 s59, s59, 8192
    s_mov_b32 m0, s58
    s_nop 0
    buffer_load_dwordx4 v2, s[28:31], s59 offen lds
    s_waitcnt lgkmcnt(0)
    s_barrier
    s_mul_i32 s58, s50, 7168
    s_add_u32 s58, s58, 32768
    s_lshr_b32 s59, s50, 1
    s_mul_i32 s59, s59, 896
    s_and_b32 s60, s50, 1
    s_mul_i32 s60, s60, 56
    s_add_u32 s59, s59, s60
    s_add_u32 s59, s59, 224
    s_lshl_b32 s59, s59, 10
    s_add_u32 s59, s59, s51
    s_mov_b32 m0, s58
    s_nop 0
    buffer_load_dwordx4 v2, s[28:31], s59 offen lds
    s_add_u32 s58, s58, 1024
    s_add_u32 s59, s59, 8192
    s_mov_b32 m0, s58
    s_nop 0
    buffer_load_dwordx4 v2, s[28:31], s59 offen lds
    s_add_u32 s58, s58, 1024
    s_add_u32 s59, s59, 8192
    s_mov_b32 m0, s58
    s_nop 0
    buffer_load_dwordx4 v2, s[28:31], s59 offen lds
    s_add_u32 s58, s58, 1024
    s_add_u32 s59, s59, 8192
    s_mov_b32 m0, s58
    s_nop 0
    buffer_load_dwordx4 v2, s[28:31], s59 offen lds
    s_add_u32 s58, s58, 1024
    s_add_u32 s59, s59, 8192
    s_mov_b32 m0, s58
    s_nop 0
    buffer_load_dwordx4 v2, s[28:31], s59 offen lds
    s_add_u32 s58, s58, 1024
    s_add_u32 s59, s59, 8192
    s_mov_b32 m0, s58
    s_nop 0
    buffer_load_dwordx4 v2, s[28:31], s59 offen lds
    s_add_u32 s58, s58, 1024
    s_add_u32 s59, s59, 8192
    s_mov_b32 m0, s58
    s_nop 0
    buffer_load_dwordx4 v2, s[28:31], s59 offen lds
    s_barrier
    s_mul_i32 s58, s50, 7168
    s_add_u32 s58, s58, 65536
    s_lshr_b32 s59, s50, 1
    s_mul_i32 s59, s59, 896
    s_and_b32 s60, s50, 1
    s_mul_i32 s60, s60, 56
    s_add_u32 s59, s59, s60
    s_add_u32 s59, s59, 336
    s_lshl_b32 s59, s59, 10
    s_add_u32 s59, s59, s51
    s_mov_b32 m0, s58
    s_nop 0
    buffer_load_dwordx4 v2, s[28:31], s59 offen lds
    s_add_u32 s58, s58, 1024
    s_add_u32 s59, s59, 8192
    s_mov_b32 m0, s58
    s_nop 0
    buffer_load_dwordx4 v2, s[28:31], s59 offen lds
    s_add_u32 s58, s58, 1024
    s_add_u32 s59, s59, 8192
    s_mov_b32 m0, s58
    s_nop 0
    buffer_load_dwordx4 v2, s[28:31], s59 offen lds
    s_add_u32 s58, s58, 1024
    s_add_u32 s59, s59, 8192
    s_mov_b32 m0, s58
    s_nop 0
    buffer_load_dwordx4 v2, s[28:31], s59 offen lds
    s_add_u32 s58, s58, 1024
    s_add_u32 s59, s59, 8192
    s_mov_b32 m0, s58
    s_nop 0
    buffer_load_dwordx4 v2, s[28:31], s59 offen lds
    s_add_u32 s58, s58, 1024
    s_add_u32 s59, s59, 8192
    s_mov_b32 m0, s58
    s_nop 0
    buffer_load_dwordx4 v2, s[28:31], s59 offen lds
    s_add_u32 s58, s58, 1024
    s_add_u32 s59, s59, 8192
    s_mov_b32 m0, s58
    s_nop 0
    buffer_load_dwordx4 v2, s[28:31], s59 offen lds
    s_barrier
    s_mul_i32 s58, s50, 7168
    s_add_u32 s58, s58, 98304
    s_lshr_b32 s59, s50, 1
    s_mul_i32 s59, s59, 896
    s_and_b32 s60, s50, 1
    s_mul_i32 s60, s60, 56
    s_add_u32 s59, s59, s60
    s_add_u32 s59, s59, 448
    s_lshl_b32 s59, s59, 10
    s_add_u32 s59, s59, s51
    s_mov_b32 m0, s58
    s_nop 0
    buffer_load_dwordx4 v2, s[28:31], s59 offen lds
    s_add_u32 s58, s58, 1024
    s_add_u32 s59, s59, 8192
    s_mov_b32 m0, s58
    s_nop 0
    buffer_load_dwordx4 v2, s[28:31], s59 offen lds
    s_add_u32 s58, s58, 1024
    s_add_u32 s59, s59, 8192
    s_mov_b32 m0, s58
    s_nop 0
    buffer_load_dwordx4 v2, s[28:31], s59 offen lds
    s_add_u32 s58, s58, 1024
    s_add_u32 s59, s59, 8192
    s_mov_b32 m0, s58
    s_nop 0
    buffer_load_dwordx4 v2, s[28:31], s59 offen lds
    s_add_u32 s58, s58, 1024
    s_add_u32 s59, s59, 8192
    s_mov_b32 m0, s58
    s_nop 0
    buffer_load_dwordx4 v2, s[28:31], s59 offen lds
    s_add_u32 s58, s58, 1024
    s_add_u32 s59, s59, 8192
    s_mov_b32 m0, s58
    s_nop 0
    buffer_load_dwordx4 v2, s[28:31], s59 offen lds
    s_add_u32 s58, s58, 1024
    s_add_u32 s59, s59, 8192
    s_mov_b32 m0, s58
    s_nop 0
    buffer_load_dwordx4 v2, s[28:31], s59 offen lds
    s_waitcnt vmcnt(21)
    s_barrier
    s_waitcnt vmcnt(14)
    s_barrier
    s_mul_i32 s58, s50, 7168
    s_add_u32 s58, s58, 131072
    s_lshr_b32 s59, s50, 1
    s_mul_i32 s59, s59, 896
    s_and_b32 s60, s50, 1
    s_mul_i32 s60, s60, 56
    s_add_u32 s59, s59, s60
    s_add_u32 s59, s59, 560
    s_lshl_b32 s59, s59, 10
    s_add_u32 s59, s59, s51
    s_mov_b32 m0, s58
    s_nop 0
    buffer_load_dwordx4 v2, s[28:31], s59 offen lds
    s_add_u32 s58, s58, 1024
    s_add_u32 s59, s59, 8192
    s_mov_b32 m0, s58
    s_nop 0
    buffer_load_dwordx4 v2, s[28:31], s59 offen lds
    s_add_u32 s58, s58, 1024
    s_add_u32 s59, s59, 8192
    s_mov_b32 m0, s58
    s_nop 0
    buffer_load_dwordx4 v2, s[28:31], s59 offen lds
    s_add_u32 s58, s58, 1024
    s_add_u32 s59, s59, 8192
    s_mov_b32 m0, s58
    s_nop 0
    buffer_load_dwordx4 v2, s[28:31], s59 offen lds
    s_add_u32 s58, s58, 1024
    s_add_u32 s59, s59, 8192
    s_mov_b32 m0, s58
    s_nop 0
    buffer_load_dwordx4 v2, s[28:31], s59 offen lds
    s_add_u32 s58, s58, 1024
    s_add_u32 s59, s59, 8192
    s_mov_b32 m0, s58
    s_nop 0
    buffer_load_dwordx4 v2, s[28:31], s59 offen lds
    s_add_u32 s58, s58, 1024
    s_add_u32 s59, s59, 8192
    s_mov_b32 m0, s58
    s_nop 0
    buffer_load_dwordx4 v2, s[28:31], s59 offen lds
    s_waitcnt vmcnt(14)
    s_barrier
    s_mul_i32 s58, s50, 7168
    s_add_u32 s58, s58, 0
    s_lshr_b32 s59, s50, 1
    s_mul_i32 s59, s59, 896
    s_and_b32 s60, s50, 1
    s_mul_i32 s60, s60, 56
    s_add_u32 s59, s59, s60
    s_add_u32 s59, s59, 672
    s_lshl_b32 s59, s59, 10
    s_add_u32 s59, s59, s51
    s_mov_b32 m0, s58
    s_nop 0
    buffer_load_dwordx4 v2, s[28:31], s59 offen lds
    s_add_u32 s58, s58, 1024
    s_add_u32 s59, s59, 8192
    s_mov_b32 m0, s58
    s_nop 0
    buffer_load_dwordx4 v2, s[28:31], s59 offen lds
    s_add_u32 s58, s58, 1024
    s_add_u32 s59, s59, 8192
    s_mov_b32 m0, s58
    s_nop 0
    buffer_load_dwordx4 v2, s[28:31], s59 offen lds
    s_add_u32 s58, s58, 1024
    s_add_u32 s59, s59, 8192
    s_mov_b32 m0, s58
    s_nop 0
    buffer_load_dwordx4 v2, s[28:31], s59 offen lds
    s_add_u32 s58, s58, 1024
    s_add_u32 s59, s59, 8192
    s_mov_b32 m0, s58
    s_nop 0
    buffer_load_dwordx4 v2, s[28:31], s59 offen lds
    s_add_u32 s58, s58, 1024
    s_add_u32 s59, s59, 8192
    s_mov_b32 m0, s58
    s_nop 0
    buffer_load_dwordx4 v2, s[28:31], s59 offen lds
    s_add_u32 s58, s58, 1024
    s_add_u32 s59, s59, 8192
    s_mov_b32 m0, s58
    s_nop 0
    buffer_load_dwordx4 v2, s[28:31], s59 offen lds
    s_waitcnt vmcnt(14)
    s_barrier
    s_mul_i32 s58, s50, 7168
    s_add_u32 s58, s58, 32768
    s_lshr_b32 s59, s50, 1
    s_mul_i32 s59, s59, 896
    s_and_b32 s60, s50, 1
    s_mul_i32 s60, s60, 56
    s_add_u32 s59, s59, s60
    s_add_u32 s59, s59, 784
    s_lshl_b32 s59, s59, 10
    s_add_u32 s59, s59, s51
    s_mov_b32 m0, s58
    s_nop 0
    buffer_load_dwordx4 v2, s[28:31], s59 offen lds
    s_add_u32 s58, s58, 1024
    s_add_u32 s59, s59, 8192
    s_mov_b32 m0, s58
    s_nop 0
    buffer_load_dwordx4 v2, s[28:31], s59 offen lds
    s_add_u32 s58, s58, 1024
    s_add_u32 s59, s59, 8192
    s_mov_b32 m0, s58
    s_nop 0
    buffer_load_dwordx4 v2, s[28:31], s59 offen lds
    s_add_u32 s58, s58, 1024
    s_add_u32 s59, s59, 8192
    s_mov_b32 m0, s58
    s_nop 0
    buffer_load_dwordx4 v2, s[28:31], s59 offen lds
    s_add_u32 s58, s58, 1024
    s_add_u32 s59, s59, 8192
    s_mov_b32 m0, s58
    s_nop 0
    buffer_load_dwordx4 v2, s[28:31], s59 offen lds
    s_add_u32 s58, s58, 1024
    s_add_u32 s59, s59, 8192
    s_mov_b32 m0, s58
    s_nop 0
    buffer_load_dwordx4 v2, s[28:31], s59 offen lds
    s_add_u32 s58, s58, 1024
    s_add_u32 s59, s59, 8192
    s_mov_b32 m0, s58
    s_nop 0
    buffer_load_dwordx4 v2, s[28:31], s59 offen lds
    s_waitcnt vmcnt(14)
    s_barrier
    s_waitcnt vmcnt(7)
    s_barrier
    s_waitcnt vmcnt(0)
    s_barrier
    s_barrier
L_END:
    s_endpgm
.section .rodata,"a"
.p2align 6
.amdhsa_kernel interleave_layers__sliding_block__glu_gated_bilinear__prompt_kernel
  .amdhsa_next_free_vgpr 256
  .amdhsa_next_free_sgpr 102
  .amdhsa_accum_offset 256
  .amdhsa_group_segment_fixed_size 0
  .amdhsa_kernarg_size 80
  .amdhsa_user_sgpr_count 2
  .amdhsa_user_sgpr_kernarg_segment_ptr 1
  .amdhsa_system_sgpr_workgroup_id_x 1
.end_amdhsa_kernel
```
